```python
import torch

def _softmax(x, axis=-1):
    return torch.softmax(x, dim=axis)
def _gelu(x):
    return torch.nn.functional.gelu(x, approximate="tanh")
def _silu(x):
    return torch.nn.functional.silu(x)
def _sigmoid(x):
    return torch.sigmoid(x)
def _layernorm(x, axis=-1, eps=1e-5):
    m = x.mean(dim=axis, keepdim=True)
    v = x.var(dim=axis, keepdim=True, unbiased=False)
    return (x - m) / torch.sqrt(v + eps)
def _scatter_add(tgt, idx, src, axis=0):
    return tgt.clone().index_add_(axis, idx, src)
def _segment_sum(src, seg, n):
    out = torch.zeros((n,) + src.shape[1:], dtype=src.dtype)
    return out.index_add_(0, seg, src)
def _pad(x, pw):
    flat = tuple(v for pair in reversed(pw) for v in pair)
    return torch.nn.functional.pad(x, flat)

kernel_name = 'parallel_sum__softmax_full_mha__swiglu_ffn__prompt'

def setup_inputs():

    _w = (lambda a: (lambda t: t.to(torch.bfloat16) if t.is_floating_point() else t)(torch.as_tensor(a)))
    def _A_setup():
        B, S, D = 1, 2048, 576
        return {
            "x": _w((lambda *s: torch.randn(*s, dtype=torch.bfloat16) * 0.05)(B, S, D)),
            "wqkv": _w((lambda *s: torch.randn(*s, dtype=torch.bfloat16) * 0.2)(D, 3 * D)),
            "wo": _w((lambda *s: torch.randn(*s, dtype=torch.bfloat16) * 0.1)(D, D)),
        }
    _A_in = _A_setup()

    def _B_setup():
        B, S, D, F = 1, 2048, 576, 4608
        return {
            "x": _w((lambda *s: torch.randn(*s, dtype=torch.bfloat16) * 0.05)(B, S, D)),
            "w_gate": _w((lambda *s: torch.randn(*s, dtype=torch.bfloat16) * 0.1)(D, F)),
            "w_up": _w((lambda *s: torch.randn(*s, dtype=torch.bfloat16) * 0.1)(D, F)),
            "w_down": _w((lambda *s: torch.randn(*s, dtype=torch.bfloat16) * 0.1)(F, D)),
        }
    _B_in = _B_setup()

    return {
        "A_x": _A_in["x"],
        "A_wqkv": _A_in["wqkv"],
        "A_wo": _A_in["wo"],
        "B_x": _B_in["x"],
        "B_w_gate": _B_in["w_gate"],
        "B_w_up": _B_in["w_up"],
        "B_w_down": _B_in["w_down"],
    }

def reference(A_x, A_wqkv, A_wo, B_x, B_w_gate, B_w_up, B_w_down):
    def _A_ref(x, wqkv, wo):
        B, S, D = x.shape
        H = 32; Dh = D // H
        qkv = (lambda x, *d: x.permute(*d))((x @ wqkv).reshape(B, S, 3, H, Dh), 2, 0, 3, 1, 4)
        q, k, v = qkv[0], qkv[1], qkv[2]
        scale = Dh ** -0.5
        scores = torch.einsum("bhqd,bhkd->bhqk", q, k) * scale
        p = _softmax(scores, axis=-1)
        o = torch.einsum("bhqk,bhkd->bhqd", p, v)
        return (lambda x, *d: x.permute(*d))(o, 0, 2, 1, 3).reshape(B, S, D) @ wo

    def _B_ref(x, w_gate, w_up, w_down):
        g = _silu(x @ w_gate)
        u = x @ w_up
        return (g * u) @ w_down

    x = A_x
    xn = _layernorm(x, axis=-1)
    return x + _A_ref(xn, A_wqkv, A_wo) + _B_ref(xn, B_w_gate, B_w_up, B_w_down)
```

```asm
; @launch grid=(256,1,1) block=(256,1,1) lds=163840
.amdgcn_target "amdgcn-amd-amdhsa--gfx950"
.text
.globl parallel_sum__softmax_full_mha__swiglu_ffn__prompt_kernel
.p2align 8
.type parallel_sum__softmax_full_mha__swiglu_ffn__prompt_kernel,@function
parallel_sum__softmax_full_mha__swiglu_ffn__prompt_kernel:
    s_cmp_ge_u32 s2, 256
    s_cbranch_scc1 parallel_sum__softmax_full_mha__swiglu_ffn__prompt_kernel_end
    s_load_dwordx16 s[4:19], s[0:1], 0
    s_load_dwordx4 s[20:23], s[0:1], 64
    v_lshrrev_b32 v1, 6, v0
    v_and_b32 v0, 63, v0
    v_readfirstlane_b32 s42, v1
    s_and_b32 s43, s2, 7
    s_and_b32 s46, s2, 1
    s_lshl_b32 s46, s46, 2
    s_bfe_u32 s47, s2, 0x20003
    s_add_u32 s40, s46, s47
    s_bfe_u32 s46, s2, 0x20001
    s_lshl_b32 s46, s46, 3
    s_lshr_b32 s47, s2, 5
    s_add_u32 s41, s46, s47
    v_lshlrev_b32 v2, 4, v0
    s_waitcnt lgkmcnt(0)
    s_mov_b32 s24, s22
    s_and_b32 s25, s23, 0xffff
    s_mov_b32 s26, 49840128
    s_mov_b32 s27, 0x00020000
    s_cmp_ge_u32 s42, 2
    s_cbranch_scc1 L_w23_1
    s_cmp_eq_u32 s42, 0
    s_cbranch_scc1 L_w0_4
    s_mov_b32 s36, s20
    s_and_b32 s37, s21, 0xffff
    s_mov_b32 s38, 256
    s_mov_b32 s39, 0x00020000
    s_cmp_lg_u32 s2, 0
    s_cbranch_scc1 L_nn_5
    v_mov_b32 v6, 0
    s_memrealtime s[44:45]
    s_waitcnt lgkmcnt(0)
    s_or_b32 s44, s44, 1
    v_mov_b32 v4, s44
    v_mov_b32 v5, s45
    s_mov_b64 exec, 1
    buffer_store_dwordx2 v[4:5], v6, s[36:39], 0 offen sc1
    s_mov_b64 exec, -1
L_nn_5:
L_w0_4:
    s_mov_b32 s36, s4
    s_and_b32 s37, s5, 0xffff
    s_mov_b32 s38, 2359296
    s_mov_b32 s39, 0x00020000
    v_lshrrev_b32 v3, 4, v0
    v_and_b32 v6, 15, v0
    s_lshl_b32 s46, s2, 3
    s_lshl_b32 s47, s42, 2
    s_add_u32 s46, s46, s47
    v_add_u32 v4, s46, v3
    v_mul_u32_u24 v4, 1152, v4
    v_lshl_add_u32 v4, v6, 3, v4
    buffer_load_dwordx2 v[8:9], v4, s[36:39], 0 offen offset:0
    buffer_load_dwordx2 v[10:11], v4, s[36:39], 0 offen offset:128
    buffer_load_dwordx2 v[12:13], v4, s[36:39], 0 offen offset:256
    buffer_load_dwordx2 v[14:15], v4, s[36:39], 0 offen offset:384
    buffer_load_dwordx2 v[16:17], v4, s[36:39], 0 offen offset:512
    buffer_load_dwordx2 v[18:19], v4, s[36:39], 0 offen offset:640
    buffer_load_dwordx2 v[20:21], v4, s[36:39], 0 offen offset:768
    buffer_load_dwordx2 v[22:23], v4, s[36:39], 0 offen offset:896
    buffer_load_dwordx2 v[24:25], v4, s[36:39], 0 offen offset:1024
    v_add_u32 v3, s47, v3
    v_lshrrev_b32 v5, 1, v6
    v_lshl_add_u32 v5, v5, 3, v3
    v_lshlrev_b32 v5, 4, v5
    v_and_b32 v6, 1, v6
    v_lshl_add_u32 v5, v6, 3, v5
    v_add_u32 v5, 73728, v5
    s_mov_b32 s46, 0x3f803f80
    v_mov_b32 v30, 0
    v_mov_b32 v31, 0
    v_mov_b32 v32, 0
    v_mov_b32 v33, 0
    s_waitcnt vmcnt(8)
    v_dot2_f32_bf16 v30, v8, s46, v30
    v_dot2_f32_bf16 v32, v8, v8, v32
    v_dot2_f32_bf16 v31, v9, s46, v31
    v_dot2_f32_bf16 v33, v9, v9, v33
    s_waitcnt vmcnt(7)
    v_dot2_f32_bf16 v30, v10, s46, v30
    v_dot2_f32_bf16 v32, v10, v10, v32
    v_dot2_f32_bf16 v31, v11, s46, v31
    v_dot2_f32_bf16 v33, v11, v11, v33
    s_waitcnt vmcnt(6)
    v_dot2_f32_bf16 v30, v12, s46, v30
    v_dot2_f32_bf16 v32, v12, v12, v32
    v_dot2_f32_bf16 v31, v13, s46, v31
    v_dot2_f32_bf16 v33, v13, v13, v33
    s_waitcnt vmcnt(5)
    v_dot2_f32_bf16 v30, v14, s46, v30
    v_dot2_f32_bf16 v32, v14, v14, v32
    v_dot2_f32_bf16 v31, v15, s46, v31
    v_dot2_f32_bf16 v33, v15, v15, v33
    s_waitcnt vmcnt(4)
    v_dot2_f32_bf16 v30, v16, s46, v30
    v_dot2_f32_bf16 v32, v16, v16, v32
    v_dot2_f32_bf16 v31, v17, s46, v31
    v_dot2_f32_bf16 v33, v17, v17, v33
    s_waitcnt vmcnt(3)
    v_dot2_f32_bf16 v30, v18, s46, v30
    v_dot2_f32_bf16 v32, v18, v18, v32
    v_dot2_f32_bf16 v31, v19, s46, v31
    v_dot2_f32_bf16 v33, v19, v19, v33
    s_waitcnt vmcnt(2)
    v_dot2_f32_bf16 v30, v20, s46, v30
    v_dot2_f32_bf16 v32, v20, v20, v32
    v_dot2_f32_bf16 v31, v21, s46, v31
    v_dot2_f32_bf16 v33, v21, v21, v33
    s_waitcnt vmcnt(1)
    v_dot2_f32_bf16 v30, v22, s46, v30
    v_dot2_f32_bf16 v32, v22, v22, v32
    v_dot2_f32_bf16 v31, v23, s46, v31
    v_dot2_f32_bf16 v33, v23, v23, v33
    s_waitcnt vmcnt(0)
    v_dot2_f32_bf16 v30, v24, s46, v30
    v_dot2_f32_bf16 v32, v24, v24, v32
    v_dot2_f32_bf16 v31, v25, s46, v31
    v_dot2_f32_bf16 v33, v25, v25, v33
    s_nop 1
    v_add_f32 v30, v30, v31
    v_add_f32 v32, v32, v33
    s_nop 0
    v_add_f32_dpp v30, v30, v30 quad_perm:[1,0,3,2] row_mask:0xf bank_mask:0xf
    v_add_f32_dpp v32, v32, v32 quad_perm:[1,0,3,2] row_mask:0xf bank_mask:0xf
    s_nop 0
    v_add_f32_dpp v30, v30, v30 quad_perm:[2,3,0,1] row_mask:0xf bank_mask:0xf
    v_add_f32_dpp v32, v32, v32 quad_perm:[2,3,0,1] row_mask:0xf bank_mask:0xf
    s_nop 0
    v_add_f32_dpp v30, v30, v30 row_half_mirror row_mask:0xf bank_mask:0xf
    v_add_f32_dpp v32, v32, v32 row_half_mirror row_mask:0xf bank_mask:0xf
    s_nop 0
    v_add_f32_dpp v30, v30, v30 row_mirror row_mask:0xf bank_mask:0xf
    v_add_f32_dpp v32, v32, v32 row_mirror row_mask:0xf bank_mask:0xf
    v_mul_f32 v30, 0x3ae38e39, v30
    v_mul_f32 v32, 0x3ae38e39, v32
    v_fma_f32 v32, -v30, v30, v32
    v_max_f32 v32, 0, v32
    v_add_f32 v32, 0x3727c5ac, v32
    v_rsq_f32 v32, v32
    s_nop 0
    v_mul_f32 v30, v30, v32
    v_lshlrev_b32 v34, 16, v8
    v_and_b32 v35, 0xffff0000, v8
    v_fma_f32 v34, v34, v32, -v30
    v_fma_f32 v35, v35, v32, -v30
    v_cvt_pk_bf16_f32 v8, v34, v35
    v_lshlrev_b32 v34, 16, v9
    v_and_b32 v35, 0xffff0000, v9
    v_fma_f32 v34, v34, v32, -v30
    v_fma_f32 v35, v35, v32, -v30
    v_cvt_pk_bf16_f32 v9, v34, v35
    v_lshlrev_b32 v34, 16, v10
    v_and_b32 v35, 0xffff0000, v10
    v_fma_f32 v34, v34, v32, -v30
    v_fma_f32 v35, v35, v32, -v30
    v_cvt_pk_bf16_f32 v10, v34, v35
    v_lshlrev_b32 v34, 16, v11
    v_and_b32 v35, 0xffff0000, v11
    v_fma_f32 v34, v34, v32, -v30
    v_fma_f32 v35, v35, v32, -v30
    v_cvt_pk_bf16_f32 v11, v34, v35
    v_lshlrev_b32 v34, 16, v12
    v_and_b32 v35, 0xffff0000, v12
    v_fma_f32 v34, v34, v32, -v30
    v_fma_f32 v35, v35, v32, -v30
    v_cvt_pk_bf16_f32 v12, v34, v35
    v_lshlrev_b32 v34, 16, v13
    v_and_b32 v35, 0xffff0000, v13
    v_fma_f32 v34, v34, v32, -v30
    v_fma_f32 v35, v35, v32, -v30
    v_cvt_pk_bf16_f32 v13, v34, v35
    v_lshlrev_b32 v34, 16, v14
    v_and_b32 v35, 0xffff0000, v14
    v_fma_f32 v34, v34, v32, -v30
    v_fma_f32 v35, v35, v32, -v30
    v_cvt_pk_bf16_f32 v14, v34, v35
    v_lshlrev_b32 v34, 16, v15
    v_and_b32 v35, 0xffff0000, v15
    v_fma_f32 v34, v34, v32, -v30
    v_fma_f32 v35, v35, v32, -v30
    v_cvt_pk_bf16_f32 v15, v34, v35
    v_lshlrev_b32 v34, 16, v16
    v_and_b32 v35, 0xffff0000, v16
    v_fma_f32 v34, v34, v32, -v30
    v_fma_f32 v35, v35, v32, -v30
    v_cvt_pk_bf16_f32 v16, v34, v35
    v_lshlrev_b32 v34, 16, v17
    v_and_b32 v35, 0xffff0000, v17
    v_fma_f32 v34, v34, v32, -v30
    v_fma_f32 v35, v35, v32, -v30
    v_cvt_pk_bf16_f32 v17, v34, v35
    v_lshlrev_b32 v34, 16, v18
    v_and_b32 v35, 0xffff0000, v18
    v_fma_f32 v34, v34, v32, -v30
    v_fma_f32 v35, v35, v32, -v30
    v_cvt_pk_bf16_f32 v18, v34, v35
    v_lshlrev_b32 v34, 16, v19
    v_and_b32 v35, 0xffff0000, v19
    v_fma_f32 v34, v34, v32, -v30
    v_fma_f32 v35, v35, v32, -v30
    v_cvt_pk_bf16_f32 v19, v34, v35
    v_lshlrev_b32 v34, 16, v20
    v_and_b32 v35, 0xffff0000, v20
    v_fma_f32 v34, v34, v32, -v30
    v_fma_f32 v35, v35, v32, -v30
    v_cvt_pk_bf16_f32 v20, v34, v35
    v_lshlrev_b32 v34, 16, v21
    v_and_b32 v35, 0xffff0000, v21
    v_fma_f32 v34, v34, v32, -v30
    v_fma_f32 v35, v35, v32, -v30
    v_cvt_pk_bf16_f32 v21, v34, v35
    v_lshlrev_b32 v34, 16, v22
    v_and_b32 v35, 0xffff0000, v22
    v_fma_f32 v34, v34, v32, -v30
    v_fma_f32 v35, v35, v32, -v30
    v_cvt_pk_bf16_f32 v22, v34, v35
    v_lshlrev_b32 v34, 16, v23
    v_and_b32 v35, 0xffff0000, v23
    v_fma_f32 v34, v34, v32, -v30
    v_fma_f32 v35, v35, v32, -v30
    v_cvt_pk_bf16_f32 v23, v34, v35
    v_lshlrev_b32 v34, 16, v24
    v_and_b32 v35, 0xffff0000, v24
    v_fma_f32 v34, v34, v32, -v30
    v_fma_f32 v35, v35, v32, -v30
    v_cvt_pk_bf16_f32 v24, v34, v35
    v_lshlrev_b32 v34, 16, v25
    v_and_b32 v35, 0xffff0000, v25
    v_fma_f32 v34, v34, v32, -v30
    v_fma_f32 v35, v35, v32, -v30
    v_cvt_pk_bf16_f32 v25, v34, v35
    ds_write_b64 v5, v[8:9] offset:0
    ds_write_b64 v5, v[10:11] offset:1024
    ds_write_b64 v5, v[12:13] offset:2048
    ds_write_b64 v5, v[14:15] offset:3072
    ds_write_b64 v5, v[16:17] offset:4096
    ds_write_b64 v5, v[18:19] offset:5120
    ds_write_b64 v5, v[20:21] offset:6144
    ds_write_b64 v5, v[22:23] offset:7168
    ds_write_b64 v5, v[24:25] offset:8192
    v_mov_b32 v6, 163584
    v_mov_b32 v8, 0
    v_mov_b32 v9, 0
    ds_write_b64 v6, v[8:9]
    s_waitcnt lgkmcnt(0)
    s_mov_b32 s28, s6
    s_and_b32 s29, s7, 0xffff
    s_mov_b32 s30, 1990656
    s_mov_b32 s31, 0x00020000
    s_and_b32 s64, s41, 1
    s_lshl_b32 s50, s40, 3
    s_lshl_b32 s46, s42, 1
    s_add_u32 s50, s50, s46
    s_mul_i32 s46, s41, 36
    s_mov_b32 s47, 477218589
    v_mul_hi_u32 v24, v0, s47
    v_mul_u32_u24 v25, 9, v24
    v_sub_u32 v25, v0, v25
    v_mul_u32_u24 v26, 86, v25
    v_lshrrev_b32 v26, 8, v26
    v_mul_u32_u24 v27, 3, v26
    v_sub_u32 v27, v25, v27
    v_mul_u32_u24 v24, 3456, v24
    v_mul_u32_u24 v26, 1152, v26
    v_lshl_add_u32 v24, v27, 4, v24
    v_add3_u32 v210, v24, v26, s46
    s_mov_b32 s32, s12
    s_and_b32 s33, s13, 0xffff
    s_mov_b32 s34, 5308416
    s_mov_b32 s35, 0x00020000
    s_mov_b32 s59, 0xbfb8aa3b
    s_mov_b32 s60, 0x3eae1a93
    v_lshrrev_b32 v24, 2, v0
    v_and_b32 v25, 3, v0
    v_mul_u32_u24 v26, 9216, v24
    v_lshl_add_u32 v208, v25, 4, v26
    v_xor_b32 v27, 2, v25
    v_lshl_add_u32 v209, v27, 4, v26
    v_lshrrev_b32 v24, 4, v0
    v_bfe_u32 v25, v0, 2, 2
    v_and_b32 v26, 3, v0
    v_lshrrev_b32 v27, 1, v24
    v_lshl_add_u32 v27, v27, 3, v25
    v_and_b32 v28, 1, v24
    v_mul_u32_u24 v29, 144, v27
    v_mul_u32_u24 v30, 48, v28
    v_lshl_add_u32 v30, v26, 3, v30
    v_add_u32 v212, v29, v30
    v_mov_b32 v30, 80
    v_mov_b32 v31, 128
    v_cmp_eq_u32 vcc, 0, v26
    s_nop 1
    v_cndmask_b32 v30, v30, v31, vcc
    v_mov_b32 v31, 32
    v_cmp_eq_u32 vcc, 1, v26
    s_nop 1
    v_cndmask_b32 v30, v30, v31, vcc
    v_lshlrev_b32 v31, 3, v26
    v_add_u32 v31, 96, v31
    v_cmp_eq_u32 vcc, 1, v28
    s_nop 1
    v_cndmask_b32 v30, v31, v30, vcc
    v_add_u32 v213, v29, v30
    v_add_u32 v222, 41472, v212
    v_add_u32 v223, 41472, v213
    v_lshlrev_b32 v27, 6, v27
    v_lshl_add_u32 v27, v26, 3, v27
    v_mul_u32_u24 v29, 36864, v28
    v_add_u32 v29, v29, v27
    v_lshl_add_u32 v214, v28, 5, v29
    v_xor_b32 v215, 32, v214
    v_and_b32 v24, 31, v0
    v_lshrrev_b32 v25, 5, v0
    v_mov_b32 v218, 1.0
    v_mov_b32 v26, s60
    v_and_b32 v27, 30, v24
    v_cmp_eq_u32 vcc, 20, v27
    s_nop 1
    v_cndmask_b32 v218, v218, v26, vcc
    v_mov_b32 v26, 0
    v_cmp_eq_u32 vcc, 18, v27
    s_nop 1
    v_cndmask_b32 v218, v218, v26, vcc
    v_mov_b32 v219, 0
    v_mov_b32 v26, 1.0
    v_cmp_eq_u32 vcc, 18, v24
    s_nop 1
    v_cndmask_b32 v219, v219, v26, vcc
    v_mul_u32_u24 v26, 320, v25
    v_lshl_add_u32 v26, v24, 4, v26
    v_mov_b32 v220, 0x7ff00000
    v_cmp_ge_u32 vcc, 19, v24
    s_nop 1
    v_cndmask_b32 v220, v220, v26, vcc
    v_lshlrev_b32 v26, 4, v25
    v_add_u32 v27, 6586368, v26
    v_add_u32 v26, 6848512, v26
    v_mov_b32 v221, 0x7ff00000
    v_cmp_eq_u32 vcc, 20, v24
    s_nop 1
    v_cndmask_b32 v221, v221, v27, vcc
    v_cmp_eq_u32 vcc, 24, v24
    s_nop 1
    v_cndmask_b32 v221, v221, v26, vcc
    s_mul_i32 s61, s41, 288
    s_lshl_b32 s46, s64, 5
    s_add_u32 s62, s61, 256
    s_sub_u32 s47, s61, 32
    s_cmp_eq_u32 s64, 0
    s_cselect_b32 s62, s62, s47
    s_add_u32 s61, s61, s46
    s_mul_i32 s58, s41, 9
    s_add_u32 s63, s58, 8
    s_cmp_eq_u32 s64, 0
    s_cselect_b32 s63, s63, s58
    s_add_u32 s58, s58, s64
    s_mul_i32 s56, s50, 294912
    s_add_u32 s56, s56, 9732096
    s_add_u32 s57, s56, 294912
    s_mov_b32 s36, s14
    s_and_b32 s37, s15, 0xffff
    s_mov_b32 s38, 5308416
    s_mov_b32 s39, 0x00020000
    s_branch L_join_2
L_w23_1:
    s_cmp_eq_u32 s42, 2
    s_cbranch_scc0 L_w3_3
    s_mov_b32 s32, s12
    s_and_b32 s33, s13, 0xffff
    s_mov_b32 s34, 5308416
    s_mov_b32 s35, 0x00020000
    s_mov_b32 s36, s14
    s_and_b32 s37, s15, 0xffff
    s_mov_b32 s38, 5308416
    s_mov_b32 s39, 0x00020000
    v_lshrrev_b32 v24, 2, v0
    v_and_b32 v25, 3, v0
    v_mul_u32_u24 v26, 9216, v24
    v_lshl_add_u32 v208, v25, 4, v26
    v_xor_b32 v27, 2, v25
    v_lshl_add_u32 v209, v27, 4, v26
    s_and_b32 s64, s41, 1
    s_mul_i32 s61, s41, 288
    s_lshl_b32 s46, s64, 5
    s_add_u32 s61, s61, s46
    s_mov_b32 m0, 0
    s_add_u32 s52, s61, 0
    buffer_load_dwordx4 v208, s[32:35], s52 offen lds
    s_mov_b32 m0, 36864
    s_nop 0
    buffer_load_dwordx4 v209, s[36:39], s52 offen lds
    s_mov_b32 m0, 1024
    s_add_u32 s52, s61, 147456
    buffer_load_dwordx4 v208, s[32:35], s52 offen lds
    s_mov_b32 m0, 37888
    s_nop 0
    buffer_load_dwordx4 v209, s[36:39], s52 offen lds
    s_mov_b32 m0, 2048
    s_add_u32 s52, s61, 294912
    buffer_load_dwordx4 v208, s[32:35], s52 offen lds
    s_mov_b32 m0, 38912
    s_nop 0
    buffer_load_dwordx4 v209, s[36:39], s52 offen lds
    s_mov_b32 m0, 3072
    s_add_u32 s52, s61, 442368
    buffer_load_dwordx4 v208, s[32:35], s52 offen lds
    s_mov_b32 m0, 39936
    s_nop 0
    buffer_load_dwordx4 v209, s[36:39], s52 offen lds
    s_mov_b32 m0, 4096
    s_add_u32 s52, s61, 589824
    buffer_load_dwordx4 v208, s[32:35], s52 offen lds
    s_mov_b32 m0, 40960
    s_nop 0
    buffer_load_dwordx4 v209, s[36:39], s52 offen lds
    s_mov_b32 m0, 5120
    s_add_u32 s52, s61, 737280
    buffer_load_dwordx4 v208, s[32:35], s52 offen lds
    s_mov_b32 m0, 41984
    s_nop 0
    buffer_load_dwordx4 v209, s[36:39], s52 offen lds
    s_mov_b32 m0, 6144
    s_add_u32 s52, s61, 884736
    buffer_load_dwordx4 v208, s[32:35], s52 offen lds
    s_mov_b32 m0, 43008
    s_nop 0
    buffer_load_dwordx4 v209, s[36:39], s52 offen lds
    s_mov_b32 m0, 7168
    s_add_u32 s52, s61, 1032192
    buffer_load_dwordx4 v208, s[32:35], s52 offen lds
    s_mov_b32 m0, 44032
    s_nop 0
    buffer_load_dwordx4 v209, s[36:39], s52 offen lds
    s_mov_b32 m0, 8192
    s_add_u32 s52, s61, 1179648
    buffer_load_dwordx4 v208, s[32:35], s52 offen lds
    s_mov_b32 m0, 45056
    s_nop 0
    buffer_load_dwordx4 v209, s[36:39], s52 offen lds
    s_mov_b32 m0, 9216
    s_add_u32 s52, s61, 1327104
    buffer_load_dwordx4 v208, s[32:35], s52 offen lds
    s_mov_b32 m0, 46080
    s_nop 0
    buffer_load_dwordx4 v209, s[36:39], s52 offen lds
    s_mov_b32 m0, 10240
    s_add_u32 s52, s61, 1474560
    buffer_load_dwordx4 v208, s[32:35], s52 offen lds
    s_mov_b32 m0, 47104
    s_nop 0
    buffer_load_dwordx4 v209, s[36:39], s52 offen lds
    s_mov_b32 m0, 11264
    s_add_u32 s52, s61, 1622016
    buffer_load_dwordx4 v208, s[32:35], s52 offen lds
    s_mov_b32 m0, 48128
    s_nop 0
    buffer_load_dwordx4 v209, s[36:39], s52 offen lds
    s_mov_b32 m0, 12288
    s_add_u32 s52, s61, 1769472
    buffer_load_dwordx4 v208, s[32:35], s52 offen lds
    s_mov_b32 m0, 49152
    s_nop 0
    buffer_load_dwordx4 v209, s[36:39], s52 offen lds
    s_mov_b32 m0, 13312
    s_add_u32 s52, s61, 1916928
    buffer_load_dwordx4 v208, s[32:35], s52 offen lds
    s_mov_b32 m0, 50176
    s_nop 0
    buffer_load_dwordx4 v209, s[36:39], s52 offen lds
    s_mov_b32 m0, 14336
    s_add_u32 s52, s61, 2064384
    buffer_load_dwordx4 v208, s[32:35], s52 offen lds
    s_mov_b32 m0, 51200
    s_nop 0
    buffer_load_dwordx4 v209, s[36:39], s52 offen lds
    s_mov_b32 m0, 15360
    s_add_u32 s52, s61, 2211840
    buffer_load_dwordx4 v208, s[32:35], s52 offen lds
    s_mov_b32 m0, 52224
    s_nop 0
    buffer_load_dwordx4 v209, s[36:39], s52 offen lds
    s_mov_b32 m0, 16384
    s_add_u32 s52, s61, 2359296
    buffer_load_dwordx4 v208, s[32:35], s52 offen lds
    s_mov_b32 m0, 53248
    s_nop 0
    buffer_load_dwordx4 v209, s[36:39], s52 offen lds
    s_mov_b32 m0, 17408
    s_add_u32 s52, s61, 2506752
    buffer_load_dwordx4 v208, s[32:35], s52 offen lds
    s_mov_b32 m0, 54272
    s_nop 0
    buffer_load_dwordx4 v209, s[36:39], s52 offen lds
    s_mov_b32 s28, s6
    s_and_b32 s29, s7, 0xffff
    s_mov_b32 s30, 1990656
    s_mov_b32 s31, 0x00020000
    s_and_b32 s64, s41, 1
    s_lshl_b32 s50, s40, 3
    s_lshl_b32 s46, s42, 1
    s_add_u32 s50, s50, s46
    s_mul_i32 s46, s41, 36
    s_mov_b32 s47, 477218589
    v_mul_hi_u32 v24, v0, s47
    v_mul_u32_u24 v25, 9, v24
    v_sub_u32 v25, v0, v25
    v_mul_u32_u24 v26, 86, v25
    v_lshrrev_b32 v26, 8, v26
    v_mul_u32_u24 v27, 3, v26
    v_sub_u32 v27, v25, v27
    v_mul_u32_u24 v24, 3456, v24
    v_mul_u32_u24 v26, 1152, v26
    v_lshl_add_u32 v24, v27, 4, v24
    v_add3_u32 v210, v24, v26, s46
    s_mov_b32 s32, s12
    s_and_b32 s33, s13, 0xffff
    s_mov_b32 s34, 5308416
    s_mov_b32 s35, 0x00020000
    s_mov_b32 s59, 0xbfb8aa3b
    s_mov_b32 s60, 0x3eae1a93
    v_lshrrev_b32 v24, 2, v0
    v_and_b32 v25, 3, v0
    v_mul_u32_u24 v26, 9216, v24
    v_lshl_add_u32 v208, v25, 4, v26
    v_xor_b32 v27, 2, v25
    v_lshl_add_u32 v209, v27, 4, v26
    v_lshrrev_b32 v24, 4, v0
    v_bfe_u32 v25, v0, 2, 2
    v_and_b32 v26, 3, v0
    v_lshrrev_b32 v27, 1, v24
    v_lshl_add_u32 v27, v27, 3, v25
    v_and_b32 v28, 1, v24
    v_mul_u32_u24 v29, 144, v27
    v_mul_u32_u24 v30, 48, v28
    v_lshl_add_u32 v30, v26, 3, v30
    v_add_u32 v212, v29, v30
    v_mov_b32 v30, 80
    v_mov_b32 v31, 128
    v_cmp_eq_u32 vcc, 0, v26
    s_nop 1
    v_cndmask_b32 v30, v30, v31, vcc
    v_mov_b32 v31, 32
    v_cmp_eq_u32 vcc, 1, v26
    s_nop 1
    v_cndmask_b32 v30, v30, v31, vcc
    v_lshlrev_b32 v31, 3, v26
    v_add_u32 v31, 96, v31
    v_cmp_eq_u32 vcc, 1, v28
    s_nop 1
    v_cndmask_b32 v30, v31, v30, vcc
    v_add_u32 v213, v29, v30
    v_add_u32 v222, 41472, v212
    v_add_u32 v223, 41472, v213
    v_lshlrev_b32 v27, 6, v27
    v_lshl_add_u32 v27, v26, 3, v27
    v_mul_u32_u24 v29, 36864, v28
    v_add_u32 v29, v29, v27
    v_lshl_add_u32 v214, v28, 5, v29
    v_xor_b32 v215, 32, v214
    v_and_b32 v24, 31, v0
    v_lshrrev_b32 v25, 5, v0
    v_mov_b32 v218, 1.0
    v_mov_b32 v26, s60
    v_and_b32 v27, 30, v24
    v_cmp_eq_u32 vcc, 20, v27
    s_nop 1
    v_cndmask_b32 v218, v218, v26, vcc
    v_mov_b32 v26, 0
    v_cmp_eq_u32 vcc, 18, v27
    s_nop 1
    v_cndmask_b32 v218, v218, v26, vcc
    v_mov_b32 v219, 0
    v_mov_b32 v26, 1.0
    v_cmp_eq_u32 vcc, 18, v24
    s_nop 1
    v_cndmask_b32 v219, v219, v26, vcc
    v_mul_u32_u24 v26, 320, v25
    v_lshl_add_u32 v26, v24, 4, v26
    v_mov_b32 v220, 0x7ff00000
    v_cmp_ge_u32 vcc, 19, v24
    s_nop 1
    v_cndmask_b32 v220, v220, v26, vcc
    v_lshlrev_b32 v26, 4, v25
    v_add_u32 v27, 6586368, v26
    v_add_u32 v26, 6848512, v26
    v_mov_b32 v221, 0x7ff00000
    v_cmp_eq_u32 vcc, 20, v24
    s_nop 1
    v_cndmask_b32 v221, v221, v27, vcc
    v_cmp_eq_u32 vcc, 24, v24
    s_nop 1
    v_cndmask_b32 v221, v221, v26, vcc
    s_mul_i32 s61, s41, 288
    s_lshl_b32 s46, s64, 5
    s_add_u32 s62, s61, 256
    s_sub_u32 s47, s61, 32
    s_cmp_eq_u32 s64, 0
    s_cselect_b32 s62, s62, s47
    s_add_u32 s61, s61, s46
    s_mul_i32 s58, s41, 9
    s_add_u32 s63, s58, 8
    s_cmp_eq_u32 s64, 0
    s_cselect_b32 s63, s63, s58
    s_add_u32 s58, s58, s64
    s_mul_i32 s56, s50, 294912
    s_add_u32 s56, s56, 9732096
    s_add_u32 s57, s56, 294912
    s_mov_b32 s36, s14
    s_and_b32 s37, s15, 0xffff
    s_mov_b32 s38, 5308416
    s_mov_b32 s39, 0x00020000
    s_branch L_join_2
L_w3_3:
    s_mov_b32 s32, s12
    s_and_b32 s33, s13, 0xffff
    s_mov_b32 s34, 5308416
    s_mov_b32 s35, 0x00020000
    s_mov_b32 s36, s14
    s_and_b32 s37, s15, 0xffff
    s_mov_b32 s38, 5308416
    s_mov_b32 s39, 0x00020000
    v_lshrrev_b32 v24, 2, v0
    v_and_b32 v25, 3, v0
    v_mul_u32_u24 v26, 9216, v24
    v_lshl_add_u32 v208, v25, 4, v26
    v_xor_b32 v27, 2, v25
    v_lshl_add_u32 v209, v27, 4, v26
    s_and_b32 s64, s41, 1
    s_mul_i32 s61, s41, 288
    s_lshl_b32 s46, s64, 5
    s_add_u32 s61, s61, s46
    s_mov_b32 m0, 83968
    s_add_u32 s52, s61, 64
    buffer_load_dwordx4 v208, s[32:35], s52 offen lds
    s_mov_b32 m0, 120832
    s_nop 0
    buffer_load_dwordx4 v209, s[36:39], s52 offen lds
    s_mov_b32 m0, 84992
    s_add_u32 s52, s61, 147520
    buffer_load_dwordx4 v208, s[32:35], s52 offen lds
    s_mov_b32 m0, 121856
    s_nop 0
    buffer_load_dwordx4 v209, s[36:39], s52 offen lds
    s_mov_b32 m0, 86016
    s_add_u32 s52, s61, 294976
    buffer_load_dwordx4 v208, s[32:35], s52 offen lds
    s_mov_b32 m0, 122880
    s_nop 0
    buffer_load_dwordx4 v209, s[36:39], s52 offen lds
    s_mov_b32 m0, 87040
    s_add_u32 s52, s61, 442432
    buffer_load_dwordx4 v208, s[32:35], s52 offen lds
    s_mov_b32 m0, 123904
    s_nop 0
    buffer_load_dwordx4 v209, s[36:39], s52 offen lds
    s_mov_b32 m0, 88064
    s_add_u32 s52, s61, 589888
    buffer_load_dwordx4 v208, s[32:35], s52 offen lds
    s_mov_b32 m0, 124928
    s_nop 0
    buffer_load_dwordx4 v209, s[36:39], s52 offen lds
    s_mov_b32 m0, 89088
    s_add_u32 s52, s61, 737344
    buffer_load_dwordx4 v208, s[32:35], s52 offen lds
    s_mov_b32 m0, 125952
    s_nop 0
    buffer_load_dwordx4 v209, s[36:39], s52 offen lds
    s_mov_b32 m0, 90112
    s_add_u32 s52, s61, 884800
    buffer_load_dwordx4 v208, s[32:35], s52 offen lds
    s_mov_b32 m0, 126976
    s_nop 0
    buffer_load_dwordx4 v209, s[36:39], s52 offen lds
    s_mov_b32 m0, 91136
    s_add_u32 s52, s61, 1032256
    buffer_load_dwordx4 v208, s[32:35], s52 offen lds
    s_mov_b32 m0, 128000
    s_nop 0
    buffer_load_dwordx4 v209, s[36:39], s52 offen lds
    s_mov_b32 m0, 92160
    s_add_u32 s52, s61, 1179712
    buffer_load_dwordx4 v208, s[32:35], s52 offen lds
    s_mov_b32 m0, 129024
    s_nop 0
    buffer_load_dwordx4 v209, s[36:39], s52 offen lds
    s_mov_b32 m0, 93184
    s_add_u32 s52, s61, 1327168
    buffer_load_dwordx4 v208, s[32:35], s52 offen lds
    s_mov_b32 m0, 130048
    s_nop 0
    buffer_load_dwordx4 v209, s[36:39], s52 offen lds
    s_mov_b32 m0, 94208
    s_add_u32 s52, s61, 1474624
    buffer_load_dwordx4 v208, s[32:35], s52 offen lds
    s_mov_b32 m0, 131072
    s_nop 0
    buffer_load_dwordx4 v209, s[36:39], s52 offen lds
    s_mov_b32 m0, 95232
    s_add_u32 s52, s61, 1622080
    buffer_load_dwordx4 v208, s[32:35], s52 offen lds
    s_mov_b32 m0, 132096
    s_nop 0
    buffer_load_dwordx4 v209, s[36:39], s52 offen lds
    s_mov_b32 m0, 96256
    s_add_u32 s52, s61, 1769536
    buffer_load_dwordx4 v208, s[32:35], s52 offen lds
    s_mov_b32 m0, 133120
    s_nop 0
    buffer_load_dwordx4 v209, s[36:39], s52 offen lds
    s_mov_b32 m0, 97280
    s_add_u32 s52, s61, 1916992
    buffer_load_dwordx4 v208, s[32:35], s52 offen lds
    s_mov_b32 m0, 134144
    s_nop 0
    buffer_load_dwordx4 v209, s[36:39], s52 offen lds
    s_mov_b32 m0, 98304
    s_add_u32 s52, s61, 2064448
    buffer_load_dwordx4 v208, s[32:35], s52 offen lds
    s_mov_b32 m0, 135168
    s_nop 0
    buffer_load_dwordx4 v209, s[36:39], s52 offen lds
    s_mov_b32 m0, 99328
    s_add_u32 s52, s61, 2211904
    buffer_load_dwordx4 v208, s[32:35], s52 offen lds
    s_mov_b32 m0, 136192
    s_nop 0
    buffer_load_dwordx4 v209, s[36:39], s52 offen lds
    s_mov_b32 m0, 100352
    s_add_u32 s52, s61, 2359360
    buffer_load_dwordx4 v208, s[32:35], s52 offen lds
    s_mov_b32 m0, 137216
    s_nop 0
    buffer_load_dwordx4 v209, s[36:39], s52 offen lds
    s_mov_b32 m0, 101376
    s_add_u32 s52, s61, 2506816
    buffer_load_dwordx4 v208, s[32:35], s52 offen lds
    s_mov_b32 m0, 138240
    s_nop 0
    buffer_load_dwordx4 v209, s[36:39], s52 offen lds
    s_mov_b32 s28, s6
    s_and_b32 s29, s7, 0xffff
    s_mov_b32 s30, 1990656
    s_mov_b32 s31, 0x00020000
    s_and_b32 s64, s41, 1
    s_lshl_b32 s50, s40, 3
    s_lshl_b32 s46, s42, 1
    s_add_u32 s50, s50, s46
    s_mul_i32 s46, s41, 36
    s_mov_b32 s47, 477218589
    v_mul_hi_u32 v24, v0, s47
    v_mul_u32_u24 v25, 9, v24
    v_sub_u32 v25, v0, v25
    v_mul_u32_u24 v26, 86, v25
    v_lshrrev_b32 v26, 8, v26
    v_mul_u32_u24 v27, 3, v26
    v_sub_u32 v27, v25, v27
    v_mul_u32_u24 v24, 3456, v24
    v_mul_u32_u24 v26, 1152, v26
    v_lshl_add_u32 v24, v27, 4, v24
    v_add3_u32 v210, v24, v26, s46
    s_mov_b32 s32, s12
    s_and_b32 s33, s13, 0xffff
    s_mov_b32 s34, 5308416
    s_mov_b32 s35, 0x00020000
    s_mov_b32 s59, 0xbfb8aa3b
    s_mov_b32 s60, 0x3eae1a93
    v_lshrrev_b32 v24, 2, v0
    v_and_b32 v25, 3, v0
    v_mul_u32_u24 v26, 9216, v24
    v_lshl_add_u32 v208, v25, 4, v26
    v_xor_b32 v27, 2, v25
    v_lshl_add_u32 v209, v27, 4, v26
    v_lshrrev_b32 v24, 4, v0
    v_bfe_u32 v25, v0, 2, 2
    v_and_b32 v26, 3, v0
    v_lshrrev_b32 v27, 1, v24
    v_lshl_add_u32 v27, v27, 3, v25
    v_and_b32 v28, 1, v24
    v_mul_u32_u24 v29, 144, v27
    v_mul_u32_u24 v30, 48, v28
    v_lshl_add_u32 v30, v26, 3, v30
    v_add_u32 v212, v29, v30
    v_mov_b32 v30, 80
    v_mov_b32 v31, 128
    v_cmp_eq_u32 vcc, 0, v26
    s_nop 1
    v_cndmask_b32 v30, v30, v31, vcc
    v_mov_b32 v31, 32
    v_cmp_eq_u32 vcc, 1, v26
    s_nop 1
    v_cndmask_b32 v30, v30, v31, vcc
    v_lshlrev_b32 v31, 3, v26
    v_add_u32 v31, 96, v31
    v_cmp_eq_u32 vcc, 1, v28
    s_nop 1
    v_cndmask_b32 v30, v31, v30, vcc
    v_add_u32 v213, v29, v30
    v_add_u32 v222, 41472, v212
    v_add_u32 v223, 41472, v213
    v_lshlrev_b32 v27, 6, v27
    v_lshl_add_u32 v27, v26, 3, v27
    v_mul_u32_u24 v29, 36864, v28
    v_add_u32 v29, v29, v27
    v_lshl_add_u32 v214, v28, 5, v29
    v_xor_b32 v215, 32, v214
    v_and_b32 v24, 31, v0
    v_lshrrev_b32 v25, 5, v0
    v_mov_b32 v218, 1.0
    v_mov_b32 v26, s60
    v_and_b32 v27, 30, v24
    v_cmp_eq_u32 vcc, 20, v27
    s_nop 1
    v_cndmask_b32 v218, v218, v26, vcc
    v_mov_b32 v26, 0
    v_cmp_eq_u32 vcc, 18, v27
    s_nop 1
    v_cndmask_b32 v218, v218, v26, vcc
    v_mov_b32 v219, 0
    v_mov_b32 v26, 1.0
    v_cmp_eq_u32 vcc, 18, v24
    s_nop 1
    v_cndmask_b32 v219, v219, v26, vcc
    v_mul_u32_u24 v26, 320, v25
    v_lshl_add_u32 v26, v24, 4, v26
    v_mov_b32 v220, 0x7ff00000
    v_cmp_ge_u32 vcc, 19, v24
    s_nop 1
    v_cndmask_b32 v220, v220, v26, vcc
    v_lshlrev_b32 v26, 4, v25
    v_add_u32 v27, 6586368, v26
    v_add_u32 v26, 6848512, v26
    v_mov_b32 v221, 0x7ff00000
    v_cmp_eq_u32 vcc, 20, v24
    s_nop 1
    v_cndmask_b32 v221, v221, v27, vcc
    v_cmp_eq_u32 vcc, 24, v24
    s_nop 1
    v_cndmask_b32 v221, v221, v26, vcc
    s_mul_i32 s61, s41, 288
    s_lshl_b32 s46, s64, 5
    s_add_u32 s62, s61, 256
    s_sub_u32 s47, s61, 32
    s_cmp_eq_u32 s64, 0
    s_cselect_b32 s62, s62, s47
    s_add_u32 s61, s61, s46
    s_mul_i32 s58, s41, 9
    s_add_u32 s63, s58, 8
    s_cmp_eq_u32 s64, 0
    s_cselect_b32 s63, s63, s58
    s_add_u32 s58, s58, s64
    s_mul_i32 s56, s50, 294912
    s_add_u32 s56, s56, 9732096
    s_add_u32 s57, s56, 294912
    s_mov_b32 s36, s14
    s_and_b32 s37, s15, 0xffff
    s_mov_b32 s38, 5308416
    s_mov_b32 s39, 0x00020000
L_join_2:
    s_barrier
    s_cmp_lg_u32 s42, 0
    s_cbranch_scc1 L_lnp_6
    v_add_u32 v5, 73728, v2
    ds_read_b128 v[8:11], v5 offset:0
    ds_read_b128 v[12:15], v5 offset:1024
    ds_read_b128 v[16:19], v5 offset:2048
    ds_read_b128 v[20:23], v5 offset:3072
    ds_read_b128 v[24:27], v5 offset:4096
    ds_read_b128 v[28:31], v5 offset:5120
    ds_read_b128 v[32:35], v5 offset:6144
    ds_read_b128 v[36:39], v5 offset:7168
    ds_read_b128 v[40:43], v5 offset:8192
    s_lshr_b32 s46, s2, 2
    s_mul_i32 s46, s46, 36864
    s_and_b32 s47, s2, 3
    s_lshl_b32 s47, s47, 7
    s_add_u32 s46, s46, s47
    v_lshrrev_b32 v3, 4, v0
    v_lshlrev_b32 v3, 10, v3
    v_bfe_u32 v4, v0, 3, 1
    v_lshl_add_u32 v3, v4, 9, v3
    v_and_b32 v4, 7, v0
    v_lshl_add_u32 v3, v4, 4, v3
    v_add_u32 v3, s46, v3
    s_mov_b32 s46, 32768
    s_waitcnt lgkmcnt(8)
    buffer_store_dwordx4 v[8:11], v3, s[24:27], s46 offen sc1
    s_mov_b32 s46, 36864
    s_waitcnt lgkmcnt(7)
    buffer_store_dwordx4 v[12:15], v3, s[24:27], s46 offen sc1
    s_mov_b32 s46, 40960
    s_waitcnt lgkmcnt(6)
    buffer_store_dwordx4 v[16:19], v3, s[24:27], s46 offen sc1
    s_mov_b32 s46, 45056
    s_waitcnt lgkmcnt(5)
    buffer_store_dwordx4 v[20:23], v3, s[24:27], s46 offen sc1
    s_mov_b32 s46, 49152
    s_waitcnt lgkmcnt(4)
    buffer_store_dwordx4 v[24:27], v3, s[24:27], s46 offen sc1
    s_mov_b32 s46, 53248
    s_waitcnt lgkmcnt(3)
    buffer_store_dwordx4 v[28:31], v3, s[24:27], s46 offen sc1
    s_mov_b32 s46, 57344
    s_waitcnt lgkmcnt(2)
    buffer_store_dwordx4 v[32:35], v3, s[24:27], s46 offen sc1
    s_mov_b32 s46, 61440
    s_waitcnt lgkmcnt(1)
    buffer_store_dwordx4 v[36:39], v3, s[24:27], s46 offen sc1
    s_mov_b32 s46, 65536
    s_waitcnt lgkmcnt(0)
    buffer_store_dwordx4 v[40:43], v3, s[24:27], s46 offen sc1
    s_waitcnt vmcnt(0)
    v_mov_b32 v6, 163584
    s_mov_b32 s69, 400000
L_nspin_8:
    s_sub_u32 s69, s69, 1
    s_cbranch_scc1 L_nspinok_9
    ds_read_b64 v[4:5], v6
    s_waitcnt lgkmcnt(0)
    v_readfirstlane_b32 s44, v4
    v_readfirstlane_b32 s45, v5
    s_nop 3
    s_cmp_eq_u32 s44, 0
    s_cbranch_scc1 L_nspin_8
L_nspinok_9:
    s_cmp_lg_u32 s42, 0
    s_cbranch_scc1 L_pub_10
    s_lshl_b32 s49, s2, 7
    s_add_u32 s49, s49, 0
    v_mov_b32 v4, s44
    v_mov_b32 v5, s45
    v_mov_b32 v6, 0
    s_mov_b64 exec, 1
    buffer_store_dwordx2 v[4:5], v6, s[24:27], s49 offen sc1
    s_mov_b64 exec, -1
L_pub_10:
    v_and_b32 v3, 31, v0
    s_lshl_b32 s46, s40, 5
    v_add_u32 v3, s46, v3
    v_lshlrev_b32 v6, 7, v3
    v_add_u32 v6, 0, v6
    s_mov_b64 exec, 0xffffffff
    s_mov_b32 s69, 400000
L_poll_11:
    s_sub_u32 s69, s69, 1
    s_cbranch_scc1 L_pollok_12
    buffer_load_dwordx2 v[4:5], v6, s[24:27], 0 offen sc1
    s_waitcnt vmcnt(0)
    v_cmp_ne_u32 vcc, s44, v4
    v_cmp_ne_u32 s[48:49], s45, v5
    s_nop 4
    s_or_b64 vcc, vcc, s[48:49]
    s_nop 4
    s_cbranch_vccz L_pollok_12
    s_sleep 1
    s_branch L_poll_11
L_pollok_12:
    s_mov_b64 exec, -1
    s_branch L_lnq_7
L_lnp_6:
    s_cmp_eq_u32 s42, 1
    s_cbranch_scc0 L_lnq_7
    s_mov_b32 s36, s20
    s_and_b32 s37, s21, 0xffff
    s_mov_b32 s38, 256
    s_mov_b32 s39, 0x00020000
    v_mov_b32 v6, 0
    buffer_load_dwordx2 v[4:5], v6, s[36:39], 0 offen sc1
    s_mov_b32 s36, s20
    s_and_b32 s37, s21, 0xffff
    s_mov_b32 s38, 256
    s_mov_b32 s39, 0x00020000
    v_mov_b32 v6, 0
    s_mov_b32 s69, 400000
L_npoll_13:
    s_waitcnt vmcnt(0)
    v_cmp_eq_u32 vcc, 0, v4
    s_nop 4
    s_cbranch_vccz L_nok_14
    s_sub_u32 s69, s69, 1
    s_cbranch_scc1 L_nok_14
    buffer_load_dwordx2 v[4:5], v6, s[36:39], 0 offen sc1
    s_branch L_npoll_13
L_nok_14:
    v_mov_b32 v6, 163584
    ds_write_b64 v6, v[4:5]
    s_waitcnt lgkmcnt(0)
    s_mov_b32 s36, s14
    s_and_b32 s37, s15, 0xffff
    s_mov_b32 s38, 5308416
    s_mov_b32 s39, 0x00020000
    s_bfe_u32 s48, s2, 0x20003
    s_mul_i32 s48, s48, 288
    s_mov_b32 s49, 14913081
    v_add_u32 v8, 0, v2
    v_mul_hi_u32 v9, v8, s49
    v_mul_u32_u24 v10, 288, v9
    v_sub_u32 v8, v8, v10
    v_add_u32 v8, s48, v8
    v_mul_u32_u24 v10, 1152, v9
    v_add_u32 v16, v8, v10
    v_bfe_u32 v10, v9, 2, 1
    v_lshlrev_b32 v10, 2, v10
    v_bfe_u32 v11, v9, 1, 1
    v_add_u32 v10, v10, v11
    v_bfe_u32 v11, v9, 3, 1
    v_lshl_add_u32 v10, v11, 1, v10
    v_mul_u32_u24 v10, 18, v10
    v_and_b32 v11, 1, v9
    v_add3_u32 v10, v10, v11, 16
    v_mul_u32_u24 v10, 1152, v10
    v_add_u32 v26, v8, v10
    v_add_u32 v8, 1024, v2
    v_mul_hi_u32 v9, v8, s49
    v_mul_u32_u24 v10, 288, v9
    v_sub_u32 v8, v8, v10
    v_add_u32 v8, s48, v8
    v_mul_u32_u24 v10, 1152, v9
    v_add_u32 v17, v8, v10
    v_bfe_u32 v10, v9, 2, 1
    v_lshlrev_b32 v10, 2, v10
    v_bfe_u32 v11, v9, 1, 1
    v_add_u32 v10, v10, v11
    v_bfe_u32 v11, v9, 3, 1
    v_lshl_add_u32 v10, v11, 1, v10
    v_mul_u32_u24 v10, 18, v10
    v_and_b32 v11, 1, v9
    v_add3_u32 v10, v10, v11, 16
    v_mul_u32_u24 v10, 1152, v10
    v_add_u32 v27, v8, v10
    v_add_u32 v8, 2048, v2
    v_mul_hi_u32 v9, v8, s49
    v_mul_u32_u24 v10, 288, v9
    v_sub_u32 v8, v8, v10
    v_add_u32 v8, s48, v8
    v_mul_u32_u24 v10, 1152, v9
    v_add_u32 v18, v8, v10
    v_bfe_u32 v10, v9, 2, 1
    v_lshlrev_b32 v10, 2, v10
    v_bfe_u32 v11, v9, 1, 1
    v_add_u32 v10, v10, v11
    v_bfe_u32 v11, v9, 3, 1
    v_lshl_add_u32 v10, v11, 1, v10
    v_mul_u32_u24 v10, 18, v10
    v_and_b32 v11, 1, v9
    v_add3_u32 v10, v10, v11, 16
    v_mul_u32_u24 v10, 1152, v10
    v_add_u32 v28, v8, v10
    v_add_u32 v8, 3072, v2
    v_mul_hi_u32 v9, v8, s49
    v_mul_u32_u24 v10, 288, v9
    v_sub_u32 v8, v8, v10
    v_add_u32 v8, s48, v8
    v_mul_u32_u24 v10, 1152, v9
    v_add_u32 v19, v8, v10
    v_bfe_u32 v10, v9, 2, 1
    v_lshlrev_b32 v10, 2, v10
    v_bfe_u32 v11, v9, 1, 1
    v_add_u32 v10, v10, v11
    v_bfe_u32 v11, v9, 3, 1
    v_lshl_add_u32 v10, v11, 1, v10
    v_mul_u32_u24 v10, 18, v10
    v_and_b32 v11, 1, v9
    v_add3_u32 v10, v10, v11, 16
    v_mul_u32_u24 v10, 1152, v10
    v_add_u32 v29, v8, v10
    v_add_u32 v8, 4096, v2
    v_mul_hi_u32 v9, v8, s49
    v_mul_u32_u24 v10, 288, v9
    v_sub_u32 v8, v8, v10
    v_add_u32 v8, s48, v8
    v_mul_u32_u24 v10, 1152, v9
    v_add_u32 v20, v8, v10
    v_lshrrev_b32 v10, 4, v9
    v_mul_u32_u24 v10, 2304, v10
    v_add_u32 v25, v20, v10
    v_bfe_u32 v10, v9, 2, 1
    v_lshlrev_b32 v10, 2, v10
    v_bfe_u32 v11, v9, 1, 1
    v_add_u32 v10, v10, v11
    v_bfe_u32 v11, v9, 3, 1
    v_lshl_add_u32 v10, v11, 1, v10
    v_mul_u32_u24 v10, 18, v10
    v_and_b32 v11, 1, v9
    v_add3_u32 v10, v10, v11, 16
    v_mul_u32_u24 v10, 1152, v10
    v_add_u32 v30, v8, v10
    v_add_u32 v8, 5120, v2
    v_mul_hi_u32 v9, v8, s49
    v_mul_u32_u24 v10, 288, v9
    v_sub_u32 v8, v8, v10
    v_add_u32 v8, s48, v8
    v_mul_u32_u24 v10, 1152, v9
    v_add_u32 v21, v8, v10
    v_bfe_u32 v10, v9, 2, 1
    v_lshlrev_b32 v10, 2, v10
    v_bfe_u32 v11, v9, 1, 1
    v_add_u32 v10, v10, v11
    v_bfe_u32 v11, v9, 3, 1
    v_lshl_add_u32 v10, v11, 1, v10
    v_mul_u32_u24 v10, 18, v10
    v_and_b32 v11, 1, v9
    v_add3_u32 v10, v10, v11, 16
    v_mul_u32_u24 v10, 1152, v10
    v_add_u32 v31, v8, v10
    v_add_u32 v8, 6144, v2
    v_mul_hi_u32 v9, v8, s49
    v_mul_u32_u24 v10, 288, v9
    v_sub_u32 v8, v8, v10
    v_add_u32 v8, s48, v8
    v_mul_u32_u24 v10, 1152, v9
    v_add_u32 v22, v8, v10
    v_bfe_u32 v10, v9, 2, 1
    v_lshlrev_b32 v10, 2, v10
    v_bfe_u32 v11, v9, 1, 1
    v_add_u32 v10, v10, v11
    v_bfe_u32 v11, v9, 3, 1
    v_lshl_add_u32 v10, v11, 1, v10
    v_mul_u32_u24 v10, 18, v10
    v_and_b32 v11, 1, v9
    v_add3_u32 v10, v10, v11, 16
    v_mul_u32_u24 v10, 1152, v10
    v_add_u32 v32, v8, v10
    v_add_u32 v8, 7168, v2
    v_mul_hi_u32 v9, v8, s49
    v_mul_u32_u24 v10, 288, v9
    v_sub_u32 v8, v8, v10
    v_add_u32 v8, s48, v8
    v_mul_u32_u24 v10, 1152, v9
    v_add_u32 v23, v8, v10
    v_bfe_u32 v10, v9, 2, 1
    v_lshlrev_b32 v10, 2, v10
    v_bfe_u32 v11, v9, 1, 1
    v_add_u32 v10, v10, v11
    v_bfe_u32 v11, v9, 3, 1
    v_lshl_add_u32 v10, v11, 1, v10
    v_mul_u32_u24 v10, 18, v10
    v_and_b32 v11, 1, v9
    v_add3_u32 v10, v10, v11, 16
    v_mul_u32_u24 v10, 1152, v10
    v_add_u32 v33, v8, v10
    v_add_u32 v8, 8192, v2
    v_mul_hi_u32 v9, v8, s49
    v_mul_u32_u24 v10, 288, v9
    v_sub_u32 v8, v8, v10
    v_add_u32 v8, s48, v8
    v_mul_u32_u24 v10, 1152, v9
    v_add_u32 v24, v8, v10
    v_bfe_u32 v10, v9, 2, 1
    v_lshlrev_b32 v10, 2, v10
    v_bfe_u32 v11, v9, 1, 1
    v_add_u32 v10, v10, v11
    v_bfe_u32 v11, v9, 3, 1
    v_lshl_add_u32 v10, v11, 1, v10
    v_mul_u32_u24 v10, 18, v10
    v_and_b32 v11, 1, v9
    v_add3_u32 v10, v10, v11, 16
    v_mul_u32_u24 v10, 1152, v10
    v_add_u32 v34, v8, v10
    v_lshrrev_b32 v8, 5, v0
    v_lshlrev_b32 v8, 4, v8
    v_bfe_u32 v9, v0, 4, 1
    v_lshl_add_u32 v8, v9, 2, v8
    v_bfe_u32 v9, v0, 2, 2
    v_add_u32 v8, v8, v9
    v_mul_u32_u24 v8, 288, v8
    v_and_b32 v9, 3, v0
    v_lshl_add_u32 v35, v9, 3, v8
    v_lshrrev_b32 v8, 5, v0
    v_lshlrev_b32 v8, 10, v8
    v_bfe_u32 v9, v0, 4, 1
    v_lshl_add_u32 v8, v9, 9, v8
    v_and_b32 v9, 15, v0
    v_lshl_add_u32 v36, v9, 4, v8
    v_lshlrev_b32 v8, 2, v0
    v_add_u32 v8, 157696, v8
    ds_write_b32 v8, v16 offset:0
    ds_write_b32 v8, v17 offset:256
    ds_write_b32 v8, v18 offset:512
    ds_write_b32 v8, v19 offset:768
    ds_write_b32 v8, v20 offset:1024
    ds_write_b32 v8, v21 offset:1280
    ds_write_b32 v8, v22 offset:1536
    ds_write_b32 v8, v23 offset:1792
    ds_write_b32 v8, v24 offset:2048
    ds_write_b32 v8, v25 offset:2304
    ds_write_b32 v8, v26 offset:2560
    ds_write_b32 v8, v27 offset:2816
    ds_write_b32 v8, v28 offset:3072
    ds_write_b32 v8, v29 offset:3328
    ds_write_b32 v8, v30 offset:3584
    ds_write_b32 v8, v31 offset:3840
    ds_write_b32 v8, v32 offset:4096
    ds_write_b32 v8, v33 offset:4352
    ds_write_b32 v8, v34 offset:4608
    ds_write_b32 v8, v35 offset:4864
    ds_write_b32 v8, v36 offset:5120
    s_waitcnt lgkmcnt(0)
L_lnq_7:
    s_waitcnt vmcnt(0)
    s_barrier
    v_mov_b32 v6, 163584
    ds_read_b64 v[4:5], v6
    s_waitcnt lgkmcnt(0)
    v_readfirstlane_b32 s44, v4
    v_readfirstlane_b32 s45, v5
    s_mov_b32 s36, s14
    s_and_b32 s37, s15, 0xffff
    s_mov_b32 s38, 5308416
    s_mov_b32 s39, 0x00020000
    s_mul_i32 s46, s50, 36864
    s_add_u32 s46, s46, 32768
    s_add_u32 s47, s46, 36864
    buffer_load_dwordx4 a[0:3], v2, s[24:27], s46 offen offset:0 sc1
    buffer_load_dwordx4 a[144:147], v2, s[24:27], s47 offen offset:0 sc1
    buffer_load_dwordx4 a[4:7], v2, s[24:27], s46 offen offset:1024 sc1
    buffer_load_dwordx4 a[148:151], v2, s[24:27], s47 offen offset:1024 sc1
    buffer_load_dwordx4 a[8:11], v2, s[24:27], s46 offen offset:2048 sc1
    buffer_load_dwordx4 a[152:155], v2, s[24:27], s47 offen offset:2048 sc1
    buffer_load_dwordx4 a[12:15], v2, s[24:27], s46 offen offset:3072 sc1
    buffer_load_dwordx4 a[156:159], v2, s[24:27], s47 offen offset:3072 sc1
    s_add_u32 s46, s46, 4096
    s_add_u32 s47, s47, 4096
    buffer_load_dwordx4 a[16:19], v2, s[24:27], s46 offen offset:0 sc1
    buffer_load_dwordx4 a[160:163], v2, s[24:27], s47 offen offset:0 sc1
    v_mov_b32 v216, v214
    v_mov_b32 v217, v215
    v_add_u32 v3, 83968, v214
    ds_read_b64_tr_b16 v[40:41], v216 offset:0
    ds_read_b64_tr_b16 v[42:43], v216 offset:256
    ds_read_b64_tr_b16 v[52:53], v217 offset:0
    ds_read_b64_tr_b16 v[54:55], v217 offset:256
    ds_read_b64_tr_b16 v[8:9], v3 offset:0
    ds_read_b64_tr_b16 v[10:11], v3 offset:256
    ds_read_b64_tr_b16 v[44:45], v216 offset:1024
    ds_read_b64_tr_b16 v[46:47], v216 offset:1280
    ds_read_b64_tr_b16 v[56:57], v217 offset:1024
    ds_read_b64_tr_b16 v[58:59], v217 offset:1280
    ds_read_b64_tr_b16 v[12:13], v3 offset:1024
    ds_read_b64_tr_b16 v[14:15], v3 offset:1280
    s_waitcnt vmcnt(9) lgkmcnt(10)
    v_mfma_f32_32x32x16_bf16 v[64:79], v[40:43], a[0:3], 0
    s_lshr_b32 s48, s42, 1
    s_mul_i32 s53, s48, 83968
    s_lshl_b32 s48, s48, 6
    s_add_u32 s52, s61, s48
    s_add_u32 s52, s52, 2654208
    s_and_b32 s48, s42, 1
    s_mul_i32 s48, s48, 36864
    s_add_u32 s53, s53, s48
    s_add_u32 s53, s53, 18432
    s_bitcmp1_b32 s42, 0
    s_cselect_b32 s76, s36, s32
    s_cselect_b32 s77, s37, s33
    s_mov_b32 s78, 5308416
    s_mov_b32 s79, 0x00020000
    s_cselect_b32 s48, 2, 0
    v_and_b32 v4, 3, v0
    v_xor_b32 v4, s48, v4
    v_lshrrev_b32 v5, 2, v0
    v_mul_u32_u24 v5, 9216, v5
    v_lshl_add_u32 v4, v4, 4, v5
    s_mov_b32 m0, s53
    ds_read_b64_tr_b16 v[48:49], v216 offset:2048
    buffer_load_dwordx4 v4, s[76:79], s52 offen lds
    s_waitcnt vmcnt(9)
    v_mfma_f32_32x32x16_bf16 v[80:95], v[40:43], a[144:147], 0
    ds_read_b64_tr_b16 v[50:51], v216 offset:2304
    s_waitcnt lgkmcnt(10)
    v_mfma_f32_32x32x16_bf16 v[96:111], v[52:55], a[0:3], 0
    ds_read_b64_tr_b16 v[60:61], v217 offset:2048
    buffer_load_dwordx4 a[20:23], v2, s[24:27], s46 offen offset:1024 sc1
    v_mfma_f32_32x32x16_bf16 v[112:127], v[52:55], a[144:147], 0
    ds_read_b64_tr_b16 v[62:63], v217 offset:2304
    s_waitcnt lgkmcnt(10)
    v_mfma_f32_32x32x16_bf16 v[176:191], v[8:11], a[0:3], 0
    ds_read_b64_tr_b16 v[16:17], v3 offset:2048
    buffer_load_dwordx4 a[164:167], v2, s[24:27], s47 offen offset:1024 sc1
    v_mfma_f32_32x32x16_bf16 v[192:207], v[8:11], a[144:147], 0
    ds_read_b64_tr_b16 v[18:19], v3 offset:2304
    s_waitcnt vmcnt(10) lgkmcnt(10)
    v_mfma_f32_32x32x16_bf16 v[64:79], v[44:47], a[4:7], v[64:79]
    s_add_u32 s52, s52, 147456
    s_add_u32 s53, s53, 1024
    s_mov_b32 m0, s53
    ds_read_b64_tr_b16 v[40:41], v216 offset:3072
    buffer_load_dwordx4 v4, s[76:79], s52 offen lds
    s_waitcnt vmcnt(10)
    v_mfma_f32_32x32x16_bf16 v[80:95], v[44:47], a[148:151], v[80:95]
    ds_read_b64_tr_b16 v[42:43], v216 offset:3328
    s_waitcnt lgkmcnt(10)
    v_mfma_f32_32x32x16_bf16 v[96:111], v[56:59], a[4:7], v[96:111]
    ds_read_b64_tr_b16 v[52:53], v217 offset:3072
    buffer_load_dwordx4 a[24:27], v2, s[24:27], s46 offen offset:2048 sc1
    v_mfma_f32_32x32x16_bf16 v[112:127], v[56:59], a[148:151], v[112:127]
    ds_read_b64_tr_b16 v[54:55], v217 offset:3328
    s_waitcnt lgkmcnt(10)
    v_mfma_f32_32x32x16_bf16 v[176:191], v[12:15], a[4:7], v[176:191]
    ds_read_b64_tr_b16 v[8:9], v3 offset:3072
    buffer_load_dwordx4 a[168:171], v2, s[24:27], s47 offen offset:2048 sc1
    v_mfma_f32_32x32x16_bf16 v[192:207], v[12:15], a[148:151], v[192:207]
    ds_read_b64_tr_b16 v[10:11], v3 offset:3328
    s_waitcnt vmcnt(11) lgkmcnt(10)
    v_mfma_f32_32x32x16_bf16 v[64:79], v[48:51], a[8:11], v[64:79]
    s_add_u32 s52, s52, 147456
    s_add_u32 s53, s53, 1024
    s_mov_b32 m0, s53
    ds_read_b64_tr_b16 v[44:45], v216 offset:4096
    buffer_load_dwordx4 v4, s[76:79], s52 offen lds
    s_waitcnt vmcnt(11)
    v_mfma_f32_32x32x16_bf16 v[80:95], v[48:51], a[152:155], v[80:95]
    ds_read_b64_tr_b16 v[46:47], v216 offset:4352
    s_waitcnt lgkmcnt(10)
    v_mfma_f32_32x32x16_bf16 v[96:111], v[60:63], a[8:11], v[96:111]
    ds_read_b64_tr_b16 v[56:57], v217 offset:4096
    buffer_load_dwordx4 a[28:31], v2, s[24:27], s46 offen offset:3072 sc1
    v_mfma_f32_32x32x16_bf16 v[112:127], v[60:63], a[152:155], v[112:127]
    ds_read_b64_tr_b16 v[58:59], v217 offset:4352
    s_waitcnt lgkmcnt(10)
    v_mfma_f32_32x32x16_bf16 v[176:191], v[16:19], a[8:11], v[176:191]
    ds_read_b64_tr_b16 v[12:13], v3 offset:4096
    buffer_load_dwordx4 a[172:175], v2, s[24:27], s47 offen offset:3072 sc1
    v_mfma_f32_32x32x16_bf16 v[192:207], v[16:19], a[152:155], v[192:207]
    ds_read_b64_tr_b16 v[14:15], v3 offset:4352
    s_waitcnt vmcnt(12) lgkmcnt(10)
    v_mfma_f32_32x32x16_bf16 v[64:79], v[40:43], a[12:15], v[64:79]
    s_add_u32 s52, s52, 147456
    s_add_u32 s53, s53, 1024
    s_mov_b32 m0, s53
    ds_read_b64_tr_b16 v[48:49], v216 offset:5120
    buffer_load_dwordx4 v4, s[76:79], s52 offen lds
    s_waitcnt vmcnt(12)
    v_mfma_f32_32x32x16_bf16 v[80:95], v[40:43], a[156:159], v[80:95]
    ds_read_b64_tr_b16 v[50:51], v216 offset:5376
    s_waitcnt lgkmcnt(10)
    v_mfma_f32_32x32x16_bf16 v[96:111], v[52:55], a[12:15], v[96:111]
    s_add_u32 s46, s46, 4096
    s_add_u32 s47, s47, 4096
    ds_read_b64_tr_b16 v[60:61], v217 offset:5120
    buffer_load_dwordx4 a[32:35], v2, s[24:27], s46 offen offset:0 sc1
    v_mfma_f32_32x32x16_bf16 v[112:127], v[52:55], a[156:159], v[112:127]
    ds_read_b64_tr_b16 v[62:63], v217 offset:5376
    s_waitcnt lgkmcnt(10)
    v_mfma_f32_32x32x16_bf16 v[176:191], v[8:11], a[12:15], v[176:191]
    ds_read_b64_tr_b16 v[16:17], v3 offset:5120
    buffer_load_dwordx4 a[176:179], v2, s[24:27], s47 offen offset:0 sc1
    v_mfma_f32_32x32x16_bf16 v[192:207], v[8:11], a[156:159], v[192:207]
    ds_read_b64_tr_b16 v[18:19], v3 offset:5376
    s_waitcnt vmcnt(13) lgkmcnt(10)
    v_mfma_f32_32x32x16_bf16 v[64:79], v[44:47], a[16:19], v[64:79]
    s_add_u32 s52, s52, 147456
    s_add_u32 s53, s53, 1024
    s_mov_b32 m0, s53
    ds_read_b64_tr_b16 v[40:41], v216 offset:6144
    buffer_load_dwordx4 v4, s[76:79], s52 offen lds
    s_waitcnt vmcnt(13)
    v_mfma_f32_32x32x16_bf16 v[80:95], v[44:47], a[160:163], v[80:95]
    ds_read_b64_tr_b16 v[42:43], v216 offset:6400
    s_waitcnt lgkmcnt(10)
    v_mfma_f32_32x32x16_bf16 v[96:111], v[56:59], a[16:19], v[96:111]
    ds_read_b64_tr_b16 v[52:53], v217 offset:6144
    buffer_load_dwordx4 a[36:39], v2, s[24:27], s46 offen offset:1024 sc1
    v_mfma_f32_32x32x16_bf16 v[112:127], v[56:59], a[160:163], v[112:127]
    ds_read_b64_tr_b16 v[54:55], v217 offset:6400
    s_waitcnt lgkmcnt(10)
    v_mfma_f32_32x32x16_bf16 v[176:191], v[12:15], a[16:19], v[176:191]
    ds_read_b64_tr_b16 v[8:9], v3 offset:6144
    buffer_load_dwordx4 a[180:183], v2, s[24:27], s47 offen offset:1024 sc1
    v_mfma_f32_32x32x16_bf16 v[192:207], v[12:15], a[160:163], v[192:207]
    ds_read_b64_tr_b16 v[10:11], v3 offset:6400
    s_waitcnt vmcnt(13) lgkmcnt(10)
    v_mfma_f32_32x32x16_bf16 v[64:79], v[48:51], a[20:23], v[64:79]
    s_add_u32 s52, s52, 147456
    s_add_u32 s53, s53, 1024
    s_mov_b32 m0, s53
    ds_read_b64_tr_b16 v[44:45], v216 offset:7168
    buffer_load_dwordx4 v4, s[76:79], s52 offen lds
    s_waitcnt vmcnt(13)
    v_mfma_f32_32x32x16_bf16 v[80:95], v[48:51], a[164:167], v[80:95]
    ds_read_b64_tr_b16 v[46:47], v216 offset:7424
    s_waitcnt lgkmcnt(10)
    v_mfma_f32_32x32x16_bf16 v[96:111], v[60:63], a[20:23], v[96:111]
    ds_read_b64_tr_b16 v[56:57], v217 offset:7168
    buffer_load_dwordx4 a[40:43], v2, s[24:27], s46 offen offset:2048 sc1
    v_mfma_f32_32x32x16_bf16 v[112:127], v[60:63], a[164:167], v[112:127]
    ds_read_b64_tr_b16 v[58:59], v217 offset:7424
    s_waitcnt lgkmcnt(10)
    v_mfma_f32_32x32x16_bf16 v[176:191], v[16:19], a[20:23], v[176:191]
    ds_read_b64_tr_b16 v[12:13], v3 offset:7168
    buffer_load_dwordx4 a[184:187], v2, s[24:27], s47 offen offset:2048 sc1
    v_mfma_f32_32x32x16_bf16 v[192:207], v[16:19], a[164:167], v[192:207]
    ds_read_b64_tr_b16 v[14:15], v3 offset:7424
    s_waitcnt vmcnt(13) lgkmcnt(10)
    v_mfma_f32_32x32x16_bf16 v[64:79], v[40:43], a[24:27], v[64:79]
    s_add_u32 s52, s52, 147456
    s_add_u32 s53, s53, 1024
    s_mov_b32 m0, s53
    ds_read_b64_tr_b16 v[48:49], v216 offset:8192
    buffer_load_dwordx4 v4, s[76:79], s52 offen lds
    s_waitcnt vmcnt(13)
    v_mfma_f32_32x32x16_bf16 v[80:95], v[40:43], a[168:171], v[80:95]
    ds_read_b64_tr_b16 v[50:51], v216 offset:8448
    s_waitcnt lgkmcnt(10)
    v_mfma_f32_32x32x16_bf16 v[96:111], v[52:55], a[24:27], v[96:111]
    ds_read_b64_tr_b16 v[60:61], v217 offset:8192
    buffer_load_dwordx4 a[44:47], v2, s[24:27], s46 offen offset:3072 sc1
    v_mfma_f32_32x32x16_bf16 v[112:127], v[52:55], a[168:171], v[112:127]
    ds_read_b64_tr_b16 v[62:63], v217 offset:8448
    s_waitcnt lgkmcnt(10)
    v_mfma_f32_32x32x16_bf16 v[176:191], v[8:11], a[24:27], v[176:191]
    ds_read_b64_tr_b16 v[16:17], v3 offset:8192
    buffer_load_dwordx4 a[188:191], v2, s[24:27], s47 offen offset:3072 sc1
    v_mfma_f32_32x32x16_bf16 v[192:207], v[8:11], a[168:171], v[192:207]
    ds_read_b64_tr_b16 v[18:19], v3 offset:8448
    s_waitcnt vmcnt(13) lgkmcnt(10)
    v_mfma_f32_32x32x16_bf16 v[64:79], v[44:47], a[28:31], v[64:79]
    s_add_u32 s52, s52, 147456
    s_add_u32 s53, s53, 1024
    s_mov_b32 m0, s53
    ds_read_b64_tr_b16 v[40:41], v216 offset:9216
    buffer_load_dwordx4 v4, s[76:79], s52 offen lds
    s_waitcnt vmcnt(13)
    v_mfma_f32_32x32x16_bf16 v[80:95], v[44:47], a[172:175], v[80:95]
    ds_read_b64_tr_b16 v[42:43], v216 offset:9472
    s_waitcnt lgkmcnt(10)
    v_mfma_f32_32x32x16_bf16 v[96:111], v[56:59], a[28:31], v[96:111]
    s_add_u32 s46, s46, 4096
    s_add_u32 s47, s47, 4096
    ds_read_b64_tr_b16 v[52:53], v217 offset:9216
    buffer_load_dwordx4 a[48:51], v2, s[24:27], s46 offen offset:0 sc1
    v_mfma_f32_32x32x16_bf16 v[112:127], v[56:59], a[172:175], v[112:127]
    ds_read_b64_tr_b16 v[54:55], v217 offset:9472
    s_waitcnt lgkmcnt(10)
    v_mfma_f32_32x32x16_bf16 v[176:191], v[12:15], a[28:31], v[176:191]
    ds_read_b64_tr_b16 v[8:9], v3 offset:9216
    buffer_load_dwordx4 a[192:195], v2, s[24:27], s47 offen offset:0 sc1
    v_mfma_f32_32x32x16_bf16 v[192:207], v[12:15], a[172:175], v[192:207]
    ds_read_b64_tr_b16 v[10:11], v3 offset:9472
    s_waitcnt vmcnt(13) lgkmcnt(10)
    v_mfma_f32_32x32x16_bf16 v[64:79], v[48:51], a[32:35], v[64:79]
    s_add_u32 s52, s52, 147456
    s_add_u32 s53, s53, 1024
    s_mov_b32 m0, s53
    ds_read_b64_tr_b16 v[44:45], v216 offset:10240
    buffer_load_dwordx4 v4, s[76:79], s52 offen lds
    s_waitcnt vmcnt(13)
    v_mfma_f32_32x32x16_bf16 v[80:95], v[48:51], a[176:179], v[80:95]
    ds_read_b64_tr_b16 v[46:47], v216 offset:10496
    s_waitcnt lgkmcnt(10)
    v_mfma_f32_32x32x16_bf16 v[96:111], v[60:63], a[32:35], v[96:111]
    ds_read_b64_tr_b16 v[56:57], v217 offset:10240
    buffer_load_dwordx4 a[52:55], v2, s[24:27], s46 offen offset:1024 sc1
    v_mfma_f32_32x32x16_bf16 v[112:127], v[60:63], a[176:179], v[112:127]
    ds_read_b64_tr_b16 v[58:59], v217 offset:10496
    s_waitcnt lgkmcnt(10)
    v_mfma_f32_32x32x16_bf16 v[176:191], v[16:19], a[32:35], v[176:191]
    ds_read_b64_tr_b16 v[12:13], v3 offset:10240
    buffer_load_dwordx4 a[196:199], v2, s[24:27], s47 offen offset:1024 sc1
    v_mfma_f32_32x32x16_bf16 v[192:207], v[16:19], a[176:179], v[192:207]
    ds_read_b64_tr_b16 v[14:15], v3 offset:10496
    s_waitcnt vmcnt(13) lgkmcnt(10)
    v_mfma_f32_32x32x16_bf16 v[64:79], v[40:43], a[36:39], v[64:79]
    s_add_u32 s52, s52, 147456
    s_add_u32 s53, s53, 1024
    s_mov_b32 m0, s53
    ds_read_b64_tr_b16 v[48:49], v216 offset:11264
    buffer_load_dwordx4 v4, s[76:79], s52 offen lds
    s_waitcnt vmcnt(13)
    v_mfma_f32_32x32x16_bf16 v[80:95], v[40:43], a[180:183], v[80:95]
    ds_read_b64_tr_b16 v[50:51], v216 offset:11520
    s_waitcnt lgkmcnt(10)
    v_mfma_f32_32x32x16_bf16 v[96:111], v[52:55], a[36:39], v[96:111]
    ds_read_b64_tr_b16 v[60:61], v217 offset:11264
    buffer_load_dwordx4 a[56:59], v2, s[24:27], s46 offen offset:2048 sc1
    v_mfma_f32_32x32x16_bf16 v[112:127], v[52:55], a[180:183], v[112:127]
    ds_read_b64_tr_b16 v[62:63], v217 offset:11520
    s_waitcnt lgkmcnt(10)
    v_mfma_f32_32x32x16_bf16 v[176:191], v[8:11], a[36:39], v[176:191]
    ds_read_b64_tr_b16 v[16:17], v3 offset:11264
    buffer_load_dwordx4 a[200:203], v2, s[24:27], s47 offen offset:2048 sc1
    v_mfma_f32_32x32x16_bf16 v[192:207], v[8:11], a[180:183], v[192:207]
    ds_read_b64_tr_b16 v[18:19], v3 offset:11520
    s_waitcnt vmcnt(13) lgkmcnt(10)
    v_mfma_f32_32x32x16_bf16 v[64:79], v[44:47], a[40:43], v[64:79]
    s_add_u32 s52, s52, 147456
    s_add_u32 s53, s53, 1024
    s_mov_b32 m0, s53
    ds_read_b64_tr_b16 v[40:41], v216 offset:12288
    buffer_load_dwordx4 v4, s[76:79], s52 offen lds
    s_waitcnt vmcnt(13)
    v_mfma_f32_32x32x16_bf16 v[80:95], v[44:47], a[184:187], v[80:95]
    ds_read_b64_tr_b16 v[42:43], v216 offset:12544
    s_waitcnt lgkmcnt(10)
    v_mfma_f32_32x32x16_bf16 v[96:111], v[56:59], a[40:43], v[96:111]
    ds_read_b64_tr_b16 v[52:53], v217 offset:12288
    buffer_load_dwordx4 a[60:63], v2, s[24:27], s46 offen offset:3072 sc1
    v_mfma_f32_32x32x16_bf16 v[112:127], v[56:59], a[184:187], v[112:127]
    ds_read_b64_tr_b16 v[54:55], v217 offset:12544
    s_waitcnt lgkmcnt(10)
    v_mfma_f32_32x32x16_bf16 v[176:191], v[12:15], a[40:43], v[176:191]
    ds_read_b64_tr_b16 v[8:9], v3 offset:12288
    buffer_load_dwordx4 a[204:207], v2, s[24:27], s47 offen offset:3072 sc1
    v_mfma_f32_32x32x16_bf16 v[192:207], v[12:15], a[184:187], v[192:207]
    ds_read_b64_tr_b16 v[10:11], v3 offset:12544
    s_waitcnt vmcnt(13) lgkmcnt(10)
    v_mfma_f32_32x32x16_bf16 v[64:79], v[48:51], a[44:47], v[64:79]
    s_add_u32 s52, s52, 147456
    s_add_u32 s53, s53, 1024
    s_mov_b32 m0, s53
    ds_read_b64_tr_b16 v[44:45], v216 offset:13312
    buffer_load_dwordx4 v4, s[76:79], s52 offen lds
    s_waitcnt vmcnt(13)
    v_mfma_f32_32x32x16_bf16 v[80:95], v[48:51], a[188:191], v[80:95]
    ds_read_b64_tr_b16 v[46:47], v216 offset:13568
    s_waitcnt lgkmcnt(10)
    v_mfma_f32_32x32x16_bf16 v[96:111], v[60:63], a[44:47], v[96:111]
    s_add_u32 s46, s46, 4096
    s_add_u32 s47, s47, 4096
    ds_read_b64_tr_b16 v[56:57], v217 offset:13312
    buffer_load_dwordx4 a[64:67], v2, s[24:27], s46 offen offset:0 sc1
    v_mfma_f32_32x32x16_bf16 v[112:127], v[60:63], a[188:191], v[112:127]
    ds_read_b64_tr_b16 v[58:59], v217 offset:13568
    s_waitcnt lgkmcnt(10)
    v_mfma_f32_32x32x16_bf16 v[176:191], v[16:19], a[44:47], v[176:191]
    ds_read_b64_tr_b16 v[12:13], v3 offset:13312
    buffer_load_dwordx4 a[208:211], v2, s[24:27], s47 offen offset:0 sc1
    v_mfma_f32_32x32x16_bf16 v[192:207], v[16:19], a[188:191], v[192:207]
    ds_read_b64_tr_b16 v[14:15], v3 offset:13568
    s_waitcnt vmcnt(13) lgkmcnt(10)
    v_mfma_f32_32x32x16_bf16 v[64:79], v[40:43], a[48:51], v[64:79]
    s_add_u32 s52, s52, 147456
    s_add_u32 s53, s53, 1024
    s_mov_b32 m0, s53
    ds_read_b64_tr_b16 v[48:49], v216 offset:14336
    buffer_load_dwordx4 v4, s[76:79], s52 offen lds
    s_waitcnt vmcnt(13)
    v_mfma_f32_32x32x16_bf16 v[80:95], v[40:43], a[192:195], v[80:95]
    ds_read_b64_tr_b16 v[50:51], v216 offset:14592
    s_waitcnt lgkmcnt(10)
    v_mfma_f32_32x32x16_bf16 v[96:111], v[52:55], a[48:51], v[96:111]
    ds_read_b64_tr_b16 v[60:61], v217 offset:14336
    buffer_load_dwordx4 a[68:71], v2, s[24:27], s46 offen offset:1024 sc1
    v_mfma_f32_32x32x16_bf16 v[112:127], v[52:55], a[192:195], v[112:127]
    ds_read_b64_tr_b16 v[62:63], v217 offset:14592
    s_waitcnt lgkmcnt(10)
    v_mfma_f32_32x32x16_bf16 v[176:191], v[8:11], a[48:51], v[176:191]
    ds_read_b64_tr_b16 v[16:17], v3 offset:14336
    buffer_load_dwordx4 a[212:215], v2, s[24:27], s47 offen offset:1024 sc1
    v_mfma_f32_32x32x16_bf16 v[192:207], v[8:11], a[192:195], v[192:207]
    ds_read_b64_tr_b16 v[18:19], v3 offset:14592
    s_waitcnt vmcnt(13) lgkmcnt(10)
    v_mfma_f32_32x32x16_bf16 v[64:79], v[44:47], a[52:55], v[64:79]
    s_add_u32 s52, s52, 147456
    s_add_u32 s53, s53, 1024
    s_mov_b32 m0, s53
    ds_read_b64_tr_b16 v[40:41], v216 offset:15360
    buffer_load_dwordx4 v4, s[76:79], s52 offen lds
    s_waitcnt vmcnt(13)
    v_mfma_f32_32x32x16_bf16 v[80:95], v[44:47], a[196:199], v[80:95]
    ds_read_b64_tr_b16 v[42:43], v216 offset:15616
    s_waitcnt lgkmcnt(10)
    v_mfma_f32_32x32x16_bf16 v[96:111], v[56:59], a[52:55], v[96:111]
    ds_read_b64_tr_b16 v[52:53], v217 offset:15360
    buffer_load_dwordx4 a[72:75], v2, s[24:27], s46 offen offset:2048 sc1
    v_mfma_f32_32x32x16_bf16 v[112:127], v[56:59], a[196:199], v[112:127]
    ds_read_b64_tr_b16 v[54:55], v217 offset:15616
    s_waitcnt lgkmcnt(10)
    v_mfma_f32_32x32x16_bf16 v[176:191], v[12:15], a[52:55], v[176:191]
    ds_read_b64_tr_b16 v[8:9], v3 offset:15360
    buffer_load_dwordx4 a[216:219], v2, s[24:27], s47 offen offset:2048 sc1
    v_mfma_f32_32x32x16_bf16 v[192:207], v[12:15], a[196:199], v[192:207]
    ds_read_b64_tr_b16 v[10:11], v3 offset:15616
    s_waitcnt vmcnt(13) lgkmcnt(10)
    v_mfma_f32_32x32x16_bf16 v[64:79], v[48:51], a[56:59], v[64:79]
    s_add_u32 s52, s52, 147456
    s_add_u32 s53, s53, 1024
    s_mov_b32 m0, s53
    ds_read_b64_tr_b16 v[44:45], v216 offset:16384
    buffer_load_dwordx4 v4, s[76:79], s52 offen lds
    s_waitcnt vmcnt(13)
    v_mfma_f32_32x32x16_bf16 v[80:95], v[48:51], a[200:203], v[80:95]
    ds_read_b64_tr_b16 v[46:47], v216 offset:16640
    s_waitcnt lgkmcnt(10)
    v_mfma_f32_32x32x16_bf16 v[96:111], v[60:63], a[56:59], v[96:111]
    ds_read_b64_tr_b16 v[56:57], v217 offset:16384
    buffer_load_dwordx4 a[76:79], v2, s[24:27], s46 offen offset:3072 sc1
    v_mfma_f32_32x32x16_bf16 v[112:127], v[60:63], a[200:203], v[112:127]
    ds_read_b64_tr_b16 v[58:59], v217 offset:16640
    s_waitcnt lgkmcnt(10)
    v_mfma_f32_32x32x16_bf16 v[176:191], v[16:19], a[56:59], v[176:191]
    ds_read_b64_tr_b16 v[12:13], v3 offset:16384
    buffer_load_dwordx4 a[220:223], v2, s[24:27], s47 offen offset:3072 sc1
    v_mfma_f32_32x32x16_bf16 v[192:207], v[16:19], a[200:203], v[192:207]
    ds_read_b64_tr_b16 v[14:15], v3 offset:16640
    s_waitcnt vmcnt(2)
    s_barrier
    s_waitcnt lgkmcnt(10)
    v_mfma_f32_32x32x16_bf16 v[64:79], v[40:43], a[60:63], v[64:79]
    s_add_u32 s52, s52, 147456
    s_add_u32 s53, s53, 1024
    s_mov_b32 m0, s53
    ds_read_b64_tr_b16 v[48:49], v216 offset:17408
    buffer_load_dwordx4 v4, s[76:79], s52 offen lds
    v_mfma_f32_32x32x16_bf16 v[80:95], v[40:43], a[204:207], v[80:95]
    ds_read_b64_tr_b16 v[50:51], v216 offset:17664
    s_waitcnt lgkmcnt(10)
    v_mfma_f32_32x32x16_bf16 v[96:111], v[52:55], a[60:63], v[96:111]
    s_add_u32 s46, s46, 4096
    s_add_u32 s47, s47, 4096
    ds_read_b64_tr_b16 v[60:61], v217 offset:17408
    buffer_load_dwordx4 a[80:83], v2, s[24:27], s46 offen offset:0 sc1
    v_mfma_f32_32x32x16_bf16 v[112:127], v[52:55], a[204:207], v[112:127]
    ds_read_b64_tr_b16 v[62:63], v217 offset:17664
    s_waitcnt lgkmcnt(10)
    v_mfma_f32_32x32x16_bf16 v[176:191], v[8:11], a[60:63], v[176:191]
    ds_read_b64_tr_b16 v[16:17], v3 offset:17408
    buffer_load_dwordx4 a[224:227], v2, s[24:27], s47 offen offset:0 sc1
    v_mfma_f32_32x32x16_bf16 v[192:207], v[8:11], a[204:207], v[192:207]
    ds_read_b64_tr_b16 v[18:19], v3 offset:17664
    s_waitcnt lgkmcnt(10)
    v_mfma_f32_32x32x16_bf16 v[64:79], v[44:47], a[64:67], v[64:79]
    s_add_u32 s52, s52, 147456
    s_add_u32 s53, s53, 1024
    s_mov_b32 m0, s53
    ds_read_b64_tr_b16 v[40:41], v216 offset:18432
    buffer_load_dwordx4 v4, s[76:79], s52 offen lds
    v_mfma_f32_32x32x16_bf16 v[80:95], v[44:47], a[208:211], v[80:95]
    ds_read_b64_tr_b16 v[42:43], v216 offset:18688
    s_waitcnt lgkmcnt(10)
    v_mfma_f32_32x32x16_bf16 v[96:111], v[56:59], a[64:67], v[96:111]
    ds_read_b64_tr_b16 v[52:53], v217 offset:18432
    buffer_load_dwordx4 a[84:87], v2, s[24:27], s46 offen offset:1024 sc1
    v_mfma_f32_32x32x16_bf16 v[112:127], v[56:59], a[208:211], v[112:127]
    ds_read_b64_tr_b16 v[54:55], v217 offset:18688
    s_waitcnt lgkmcnt(10)
    v_mfma_f32_32x32x16_bf16 v[176:191], v[12:15], a[64:67], v[176:191]
    ds_read_b64_tr_b16 v[8:9], v3 offset:18432
    buffer_load_dwordx4 a[228:231], v2, s[24:27], s47 offen offset:1024 sc1
    v_mfma_f32_32x32x16_bf16 v[192:207], v[12:15], a[208:211], v[192:207]
    ds_read_b64_tr_b16 v[10:11], v3 offset:18688
    s_waitcnt lgkmcnt(10)
    v_mfma_f32_32x32x16_bf16 v[64:79], v[48:51], a[68:71], v[64:79]
    s_add_u32 s52, s52, 147456
    s_add_u32 s53, s53, 1024
    s_mov_b32 m0, s53
    ds_read_b64_tr_b16 v[44:45], v216 offset:19456
    buffer_load_dwordx4 v4, s[76:79], s52 offen lds
    v_mfma_f32_32x32x16_bf16 v[80:95], v[48:51], a[212:215], v[80:95]
    ds_read_b64_tr_b16 v[46:47], v216 offset:19712
    s_waitcnt lgkmcnt(10)
    v_mfma_f32_32x32x16_bf16 v[96:111], v[60:63], a[68:71], v[96:111]
    ds_read_b64_tr_b16 v[56:57], v217 offset:19456
    buffer_load_dwordx4 a[88:91], v2, s[24:27], s46 offen offset:2048 sc1
    v_mfma_f32_32x32x16_bf16 v[112:127], v[60:63], a[212:215], v[112:127]
    ds_read_b64_tr_b16 v[58:59], v217 offset:19712
    s_waitcnt lgkmcnt(10)
    v_mfma_f32_32x32x16_bf16 v[176:191], v[16:19], a[68:71], v[176:191]
    ds_read_b64_tr_b16 v[12:13], v3 offset:19456
    buffer_load_dwordx4 a[232:235], v2, s[24:27], s47 offen offset:2048 sc1
    v_mfma_f32_32x32x16_bf16 v[192:207], v[16:19], a[212:215], v[192:207]
    ds_read_b64_tr_b16 v[14:15], v3 offset:19712
    s_waitcnt lgkmcnt(10)
    v_mfma_f32_32x32x16_bf16 v[64:79], v[40:43], a[72:75], v[64:79]
    ds_read_b64_tr_b16 v[48:49], v216 offset:20480
    buffer_load_dwordx4 a[92:95], v2, s[24:27], s46 offen offset:3072 sc1
    v_mfma_f32_32x32x16_bf16 v[80:95], v[40:43], a[216:219], v[80:95]
    ds_read_b64_tr_b16 v[50:51], v216 offset:20736
    s_waitcnt lgkmcnt(10)
    v_mfma_f32_32x32x16_bf16 v[96:111], v[52:55], a[72:75], v[96:111]
    ds_read_b64_tr_b16 v[60:61], v217 offset:20480
    buffer_load_dwordx4 a[236:239], v2, s[24:27], s47 offen offset:3072 sc1
    v_mfma_f32_32x32x16_bf16 v[112:127], v[52:55], a[216:219], v[112:127]
    ds_read_b64_tr_b16 v[62:63], v217 offset:20736
    s_waitcnt lgkmcnt(10)
    v_mfma_f32_32x32x16_bf16 v[176:191], v[8:11], a[72:75], v[176:191]
    s_add_u32 s46, s46, 4096
    s_add_u32 s47, s47, 4096
    ds_read_b64_tr_b16 v[16:17], v3 offset:20480
    buffer_load_dwordx4 a[96:99], v2, s[24:27], s46 offen offset:0 sc1
    v_mfma_f32_32x32x16_bf16 v[192:207], v[8:11], a[216:219], v[192:207]
    ds_read_b64_tr_b16 v[18:19], v3 offset:20736
    s_waitcnt vmcnt(13) lgkmcnt(10)
    v_mfma_f32_32x32x16_bf16 v[64:79], v[44:47], a[76:79], v[64:79]
    ds_read_b64_tr_b16 v[40:41], v216 offset:21504
    buffer_load_dwordx4 a[240:243], v2, s[24:27], s47 offen offset:0 sc1
    s_waitcnt vmcnt(13)
    v_mfma_f32_32x32x16_bf16 v[80:95], v[44:47], a[220:223], v[80:95]
    ds_read_b64_tr_b16 v[42:43], v216 offset:21760
    s_waitcnt lgkmcnt(10)
    v_mfma_f32_32x32x16_bf16 v[96:111], v[56:59], a[76:79], v[96:111]
    ds_read_b64_tr_b16 v[52:53], v217 offset:21504
    buffer_load_dwordx4 a[100:103], v2, s[24:27], s46 offen offset:1024 sc1
    v_mfma_f32_32x32x16_bf16 v[112:127], v[56:59], a[220:223], v[112:127]
    ds_read_b64_tr_b16 v[54:55], v217 offset:21760
    s_waitcnt lgkmcnt(10)
    v_mfma_f32_32x32x16_bf16 v[176:191], v[12:15], a[76:79], v[176:191]
    ds_read_b64_tr_b16 v[8:9], v3 offset:21504
    buffer_load_dwordx4 a[244:247], v2, s[24:27], s47 offen offset:1024 sc1
    v_mfma_f32_32x32x16_bf16 v[192:207], v[12:15], a[220:223], v[192:207]
    ds_read_b64_tr_b16 v[10:11], v3 offset:21760
    s_barrier
    s_waitcnt vmcnt(13) lgkmcnt(10)
    v_mfma_f32_32x32x16_bf16 v[64:79], v[48:51], a[80:83], v[64:79]
    ds_read_b64_tr_b16 v[44:45], v216 offset:22528
    buffer_load_dwordx4 a[104:107], v2, s[24:27], s46 offen offset:2048 sc1
    s_waitcnt vmcnt(13)
    v_mfma_f32_32x32x16_bf16 v[80:95], v[48:51], a[224:227], v[80:95]
    ds_read_b64_tr_b16 v[46:47], v216 offset:22784
    s_waitcnt lgkmcnt(10)
    v_mfma_f32_32x32x16_bf16 v[96:111], v[60:63], a[80:83], v[96:111]
    ds_read_b64_tr_b16 v[56:57], v217 offset:22528
    v_mfma_f32_32x32x16_bf16 v[112:127], v[60:63], a[224:227], v[112:127]
    ds_read_b64_tr_b16 v[58:59], v217 offset:22784
    buffer_load_dwordx4 a[248:251], v2, s[24:27], s47 offen offset:2048 sc1
    s_waitcnt lgkmcnt(10)
    v_mfma_f32_32x32x16_bf16 v[176:191], v[16:19], a[80:83], v[176:191]
    ds_read_b64_tr_b16 v[12:13], v3 offset:22528
    v_mfma_f32_32x32x16_bf16 v[192:207], v[16:19], a[224:227], v[192:207]
    ds_read_b64_tr_b16 v[14:15], v3 offset:22784
    s_waitcnt vmcnt(12) lgkmcnt(10)
    v_mfma_f32_32x32x16_bf16 v[64:79], v[40:43], a[84:87], v[64:79]
    ds_read_b64_tr_b16 v[48:49], v216 offset:23552
    buffer_load_dwordx4 a[108:111], v2, s[24:27], s46 offen offset:3072 sc1
    s_waitcnt vmcnt(12)
    v_mfma_f32_32x32x16_bf16 v[80:95], v[40:43], a[228:231], v[80:95]
    ds_read_b64_tr_b16 v[50:51], v216 offset:23808
    s_waitcnt lgkmcnt(10)
    v_mfma_f32_32x32x16_bf16 v[96:111], v[52:55], a[84:87], v[96:111]
    ds_read_b64_tr_b16 v[60:61], v217 offset:23552
    v_mfma_f32_32x32x16_bf16 v[112:127], v[52:55], a[228:231], v[112:127]
    ds_read_b64_tr_b16 v[62:63], v217 offset:23808
    buffer_load_dwordx4 a[252:255], v2, s[24:27], s47 offen offset:3072 sc1
    s_waitcnt lgkmcnt(10)
    v_mfma_f32_32x32x16_bf16 v[176:191], v[8:11], a[84:87], v[176:191]
    ds_read_b64_tr_b16 v[16:17], v3 offset:23552
    v_mfma_f32_32x32x16_bf16 v[192:207], v[8:11], a[228:231], v[192:207]
    ds_read_b64_tr_b16 v[18:19], v3 offset:23808
    s_waitcnt vmcnt(11) lgkmcnt(10)
    v_mfma_f32_32x32x16_bf16 v[64:79], v[44:47], a[88:91], v[64:79]
    s_add_u32 s46, s46, 4096
    s_add_u32 s47, s47, 4096
    ds_read_b64_tr_b16 v[40:41], v216 offset:24576
    buffer_load_dwordx4 a[112:115], v2, s[24:27], s46 offen offset:0 sc1
    s_waitcnt vmcnt(11)
    v_mfma_f32_32x32x16_bf16 v[80:95], v[44:47], a[232:235], v[80:95]
    ds_read_b64_tr_b16 v[42:43], v216 offset:24832
    s_waitcnt lgkmcnt(10)
    v_mfma_f32_32x32x16_bf16 v[96:111], v[56:59], a[88:91], v[96:111]
    ds_read_b64_tr_b16 v[52:53], v217 offset:24576
    v_mfma_f32_32x32x16_bf16 v[112:127], v[56:59], a[232:235], v[112:127]
    ds_read_b64_tr_b16 v[54:55], v217 offset:24832
    buffer_load_dwordx4 v[224:227], v2, s[24:27], s47 offen offset:0 sc1
    s_waitcnt lgkmcnt(10)
    v_mfma_f32_32x32x16_bf16 v[176:191], v[12:15], a[88:91], v[176:191]
    ds_read_b64_tr_b16 v[8:9], v3 offset:24576
    v_mfma_f32_32x32x16_bf16 v[192:207], v[12:15], a[232:235], v[192:207]
    ds_read_b64_tr_b16 v[10:11], v3 offset:24832
    s_waitcnt vmcnt(11) lgkmcnt(10)
    v_mfma_f32_32x32x16_bf16 v[64:79], v[48:51], a[92:95], v[64:79]
    ds_read_b64_tr_b16 v[44:45], v216 offset:25600
    buffer_load_dwordx4 a[116:119], v2, s[24:27], s46 offen offset:1024 sc1
    s_waitcnt vmcnt(11)
    v_mfma_f32_32x32x16_bf16 v[80:95], v[48:51], a[236:239], v[80:95]
    ds_read_b64_tr_b16 v[46:47], v216 offset:25856
    s_waitcnt lgkmcnt(10)
    v_mfma_f32_32x32x16_bf16 v[96:111], v[60:63], a[92:95], v[96:111]
    ds_read_b64_tr_b16 v[56:57], v217 offset:25600
    v_mfma_f32_32x32x16_bf16 v[112:127], v[60:63], a[236:239], v[112:127]
    ds_read_b64_tr_b16 v[58:59], v217 offset:25856
    buffer_load_dwordx4 v[228:231], v2, s[24:27], s47 offen offset:1024 sc1
    s_waitcnt lgkmcnt(10)
    v_mfma_f32_32x32x16_bf16 v[176:191], v[16:19], a[92:95], v[176:191]
    ds_read_b64_tr_b16 v[12:13], v3 offset:25600
    v_mfma_f32_32x32x16_bf16 v[192:207], v[16:19], a[236:239], v[192:207]
    ds_read_b64_tr_b16 v[14:15], v3 offset:25856
    s_waitcnt vmcnt(11) lgkmcnt(10)
    v_mfma_f32_32x32x16_bf16 v[64:79], v[40:43], a[96:99], v[64:79]
    ds_read_b64_tr_b16 v[48:49], v216 offset:26624
    buffer_load_dwordx4 a[120:123], v2, s[24:27], s46 offen offset:2048 sc1
    s_waitcnt vmcnt(11)
    v_mfma_f32_32x32x16_bf16 v[80:95], v[40:43], a[240:243], v[80:95]
    ds_read_b64_tr_b16 v[50:51], v216 offset:26880
    s_waitcnt lgkmcnt(10)
    v_mfma_f32_32x32x16_bf16 v[96:111], v[52:55], a[96:99], v[96:111]
    ds_read_b64_tr_b16 v[60:61], v217 offset:26624
    v_mfma_f32_32x32x16_bf16 v[112:127], v[52:55], a[240:243], v[112:127]
    ds_read_b64_tr_b16 v[62:63], v217 offset:26880
    buffer_load_dwordx4 v[232:235], v2, s[24:27], s47 offen offset:2048 sc1
    s_waitcnt lgkmcnt(10)
    v_mfma_f32_32x32x16_bf16 v[176:191], v[8:11], a[96:99], v[176:191]
    ds_read_b64_tr_b16 v[16:17], v3 offset:26624
    v_mfma_f32_32x32x16_bf16 v[192:207], v[8:11], a[240:243], v[192:207]
    ds_read_b64_tr_b16 v[18:19], v3 offset:26880
    s_waitcnt vmcnt(11) lgkmcnt(10)
    v_mfma_f32_32x32x16_bf16 v[64:79], v[44:47], a[100:103], v[64:79]
    ds_read_b64_tr_b16 v[40:41], v216 offset:27648
    buffer_load_dwordx4 a[124:127], v2, s[24:27], s46 offen offset:3072 sc1
    s_waitcnt vmcnt(11)
    v_mfma_f32_32x32x16_bf16 v[80:95], v[44:47], a[244:247], v[80:95]
    ds_read_b64_tr_b16 v[42:43], v216 offset:27904
    s_waitcnt lgkmcnt(10)
    v_mfma_f32_32x32x16_bf16 v[96:111], v[56:59], a[100:103], v[96:111]
    ds_read_b64_tr_b16 v[52:53], v217 offset:27648
    v_mfma_f32_32x32x16_bf16 v[112:127], v[56:59], a[244:247], v[112:127]
    ds_read_b64_tr_b16 v[54:55], v217 offset:27904
    buffer_load_dwordx4 v[236:239], v2, s[24:27], s47 offen offset:3072 sc1
    s_waitcnt lgkmcnt(10)
    v_mfma_f32_32x32x16_bf16 v[176:191], v[12:15], a[100:103], v[176:191]
    ds_read_b64_tr_b16 v[8:9], v3 offset:27648
    v_mfma_f32_32x32x16_bf16 v[192:207], v[12:15], a[244:247], v[192:207]
    ds_read_b64_tr_b16 v[10:11], v3 offset:27904
    s_waitcnt vmcnt(11) lgkmcnt(10)
    v_mfma_f32_32x32x16_bf16 v[64:79], v[48:51], a[104:107], v[64:79]
    s_add_u32 s46, s46, 4096
    s_add_u32 s47, s47, 4096
    ds_read_b64_tr_b16 v[44:45], v216 offset:28672
    buffer_load_dwordx4 a[128:131], v2, s[24:27], s46 offen offset:0 sc1
    s_waitcnt vmcnt(11)
    v_mfma_f32_32x32x16_bf16 v[80:95], v[48:51], a[248:251], v[80:95]
    ds_read_b64_tr_b16 v[46:47], v216 offset:28928
    s_waitcnt lgkmcnt(10)
    v_mfma_f32_32x32x16_bf16 v[96:111], v[60:63], a[104:107], v[96:111]
    ds_read_b64_tr_b16 v[56:57], v217 offset:28672
    v_mfma_f32_32x32x16_bf16 v[112:127], v[60:63], a[248:251], v[112:127]
    ds_read_b64_tr_b16 v[58:59], v217 offset:28928
    buffer_load_dwordx4 v[240:243], v2, s[24:27], s47 offen offset:0 sc1
    s_waitcnt lgkmcnt(10)
    v_mfma_f32_32x32x16_bf16 v[176:191], v[16:19], a[104:107], v[176:191]
    ds_read_b64_tr_b16 v[12:13], v3 offset:28672
    v_mfma_f32_32x32x16_bf16 v[192:207], v[16:19], a[248:251], v[192:207]
    ds_read_b64_tr_b16 v[14:15], v3 offset:28928
    s_waitcnt vmcnt(11) lgkmcnt(10)
    v_mfma_f32_32x32x16_bf16 v[64:79], v[40:43], a[108:111], v[64:79]
    ds_read_b64_tr_b16 v[48:49], v216 offset:29696
    buffer_load_dwordx4 a[132:135], v2, s[24:27], s46 offen offset:1024 sc1
    s_waitcnt vmcnt(11)
    v_mfma_f32_32x32x16_bf16 v[80:95], v[40:43], a[252:255], v[80:95]
    ds_read_b64_tr_b16 v[50:51], v216 offset:29952
    s_waitcnt lgkmcnt(10)
    v_mfma_f32_32x32x16_bf16 v[96:111], v[52:55], a[108:111], v[96:111]
    ds_read_b64_tr_b16 v[60:61], v217 offset:29696
    v_mfma_f32_32x32x16_bf16 v[112:127], v[52:55], a[252:255], v[112:127]
    ds_read_b64_tr_b16 v[62:63], v217 offset:29952
    buffer_load_dwordx4 v[244:247], v2, s[24:27], s47 offen offset:1024 sc1
    s_waitcnt lgkmcnt(10)
    v_mfma_f32_32x32x16_bf16 v[176:191], v[8:11], a[108:111], v[176:191]
    ds_read_b64_tr_b16 v[16:17], v3 offset:29696
    v_mfma_f32_32x32x16_bf16 v[192:207], v[8:11], a[252:255], v[192:207]
    ds_read_b64_tr_b16 v[18:19], v3 offset:29952
    s_waitcnt vmcnt(11) lgkmcnt(10)
    v_mfma_f32_32x32x16_bf16 v[64:79], v[44:47], a[112:115], v[64:79]
    ds_read_b64_tr_b16 v[40:41], v216 offset:30720
    buffer_load_dwordx4 a[136:139], v2, s[24:27], s46 offen offset:2048 sc1
    s_waitcnt vmcnt(11)
    v_mfma_f32_32x32x16_bf16 v[80:95], v[44:47], v[224:227], v[80:95]
    ds_read_b64_tr_b16 v[42:43], v216 offset:30976
    s_waitcnt lgkmcnt(10)
    v_mfma_f32_32x32x16_bf16 v[96:111], v[56:59], a[112:115], v[96:111]
    ds_read_b64_tr_b16 v[52:53], v217 offset:30720
    v_mfma_f32_32x32x16_bf16 v[112:127], v[56:59], v[224:227], v[112:127]
    ds_read_b64_tr_b16 v[54:55], v217 offset:30976
    buffer_load_dwordx4 v[248:251], v2, s[24:27], s47 offen offset:2048 sc1
    s_waitcnt lgkmcnt(10)
    v_mfma_f32_32x32x16_bf16 v[176:191], v[12:15], a[112:115], v[176:191]
    ds_read_b64_tr_b16 v[8:9], v3 offset:30720
    v_mfma_f32_32x32x16_bf16 v[192:207], v[12:15], v[224:227], v[192:207]
    ds_read_b64_tr_b16 v[10:11], v3 offset:30976
    s_waitcnt vmcnt(11) lgkmcnt(10)
    v_mfma_f32_32x32x16_bf16 v[64:79], v[48:51], a[116:119], v[64:79]
    ds_read_b64_tr_b16 v[44:45], v216 offset:31744
    buffer_load_dwordx4 a[140:143], v2, s[24:27], s46 offen offset:3072 sc1
    s_waitcnt vmcnt(11)
    v_mfma_f32_32x32x16_bf16 v[80:95], v[48:51], v[228:231], v[80:95]
    ds_read_b64_tr_b16 v[46:47], v216 offset:32000
    s_waitcnt lgkmcnt(10)
    v_mfma_f32_32x32x16_bf16 v[96:111], v[60:63], a[116:119], v[96:111]
    ds_read_b64_tr_b16 v[56:57], v217 offset:31744
    v_mfma_f32_32x32x16_bf16 v[112:127], v[60:63], v[228:231], v[112:127]
    ds_read_b64_tr_b16 v[58:59], v217 offset:32000
    buffer_load_dwordx4 v[252:255], v2, s[24:27], s47 offen offset:3072 sc1
    s_waitcnt lgkmcnt(10)
    v_mfma_f32_32x32x16_bf16 v[176:191], v[16:19], a[116:119], v[176:191]
    ds_read_b64_tr_b16 v[12:13], v3 offset:31744
    v_mfma_f32_32x32x16_bf16 v[192:207], v[16:19], v[228:231], v[192:207]
    ds_read_b64_tr_b16 v[14:15], v3 offset:32000
    s_waitcnt vmcnt(11) lgkmcnt(10)
    v_mfma_f32_32x32x16_bf16 v[64:79], v[40:43], a[120:123], v[64:79]
    s_add_u32 s53, s42, 0
    s_mul_i32 s52, s53, 24192
    s_mul_i32 s53, s53, 1008
    s_mov_b32 m0, s53
    ds_read_b64_tr_b16 v[48:49], v216 offset:32768
    s_mov_b32 exec_hi, 0x7fffffff
    buffer_load_dwordx4 v210, s[28:31], s52 offen lds
    s_mov_b32 exec_hi, -1
    s_waitcnt vmcnt(11)
    v_mfma_f32_32x32x16_bf16 v[80:95], v[40:43], v[232:235], v[80:95]
    ds_read_b64_tr_b16 v[50:51], v216 offset:33024
    s_waitcnt lgkmcnt(10)
    v_mfma_f32_32x32x16_bf16 v[96:111], v[52:55], a[120:123], v[96:111]
    ds_read_b64_tr_b16 v[60:61], v217 offset:32768
    v_mfma_f32_32x32x16_bf16 v[112:127], v[52:55], v[232:235], v[112:127]
    s_add_u32 s53, s42, 4
    s_mul_i32 s52, s53, 24192
    s_mul_i32 s53, s53, 1008
    s_mov_b32 m0, s53
    ds_read_b64_tr_b16 v[62:63], v217 offset:33024
    s_mov_b32 exec_hi, 0x7fffffff
    buffer_load_dwordx4 v210, s[28:31], s52 offen lds
    s_mov_b32 exec_hi, -1
    s_waitcnt lgkmcnt(10)
    v_mfma_f32_32x32x16_bf16 v[176:191], v[8:11], a[120:123], v[176:191]
    ds_read_b64_tr_b16 v[16:17], v3 offset:32768
    v_mfma_f32_32x32x16_bf16 v[192:207], v[8:11], v[232:235], v[192:207]
    ds_read_b64_tr_b16 v[18:19], v3 offset:33024
    s_waitcnt vmcnt(11) lgkmcnt(10)
    v_mfma_f32_32x32x16_bf16 v[64:79], v[44:47], a[124:127], v[64:79]
    s_add_u32 s53, s42, 8
    s_mul_i32 s52, s53, 24192
    s_mul_i32 s53, s53, 1008
    s_mov_b32 m0, s53
    ds_read_b64_tr_b16 v[40:41], v216 offset:33792
    s_mov_b32 exec_hi, 0x7fffffff
    buffer_load_dwordx4 v210, s[28:31], s52 offen lds
    s_mov_b32 exec_hi, -1
    s_waitcnt vmcnt(11)
    v_mfma_f32_32x32x16_bf16 v[80:95], v[44:47], v[236:239], v[80:95]
    ds_read_b64_tr_b16 v[42:43], v216 offset:34048
    s_waitcnt lgkmcnt(10)
    v_mfma_f32_32x32x16_bf16 v[96:111], v[56:59], a[124:127], v[96:111]
    ds_read_b64_tr_b16 v[52:53], v217 offset:33792
    v_mfma_f32_32x32x16_bf16 v[112:127], v[56:59], v[236:239], v[112:127]
    s_add_u32 s53, s42, 12
    s_mul_i32 s52, s53, 24192
    s_mul_i32 s53, s53, 1008
    s_mov_b32 m0, s53
    ds_read_b64_tr_b16 v[54:55], v217 offset:34048
    s_mov_b32 exec_hi, 0x7fffffff
    buffer_load_dwordx4 v210, s[28:31], s52 offen lds
    s_mov_b32 exec_hi, -1
    s_waitcnt lgkmcnt(10)
    v_mfma_f32_32x32x16_bf16 v[176:191], v[12:15], a[124:127], v[176:191]
    ds_read_b64_tr_b16 v[8:9], v3 offset:33792
    v_mfma_f32_32x32x16_bf16 v[192:207], v[12:15], v[236:239], v[192:207]
    ds_read_b64_tr_b16 v[10:11], v3 offset:34048
    s_waitcnt vmcnt(11) lgkmcnt(10)
    v_mfma_f32_32x32x16_bf16 v[64:79], v[48:51], a[128:131], v[64:79]
    s_mov_b32 s53, 16
    s_cmp_eq_u32 s42, 1
    s_cselect_b32 s53, 17, s53
    s_cmp_eq_u32 s42, 2
    s_cselect_b32 s53, 37, s53
    s_cmp_eq_u32 s42, 3
    s_cselect_b32 s53, 38, s53
    s_mul_i32 s52, s53, 24192
    s_mul_i32 s53, s53, 1008
    s_mov_b32 m0, s53
    ds_read_b64_tr_b16 v[44:45], v216 offset:34816
    s_mov_b32 exec_hi, 0x7fffffff
    buffer_load_dwordx4 v210, s[28:31], s52 offen lds
    s_mov_b32 exec_hi, -1
    s_waitcnt vmcnt(11)
    v_mfma_f32_32x32x16_bf16 v[80:95], v[48:51], v[240:243], v[80:95]
    ds_read_b64_tr_b16 v[46:47], v216 offset:35072
    s_waitcnt lgkmcnt(10)
    v_mfma_f32_32x32x16_bf16 v[96:111], v[60:63], a[128:131], v[96:111]
    ds_read_b64_tr_b16 v[56:57], v217 offset:34816
    v_mfma_f32_32x32x16_bf16 v[112:127], v[60:63], v[240:243], v[112:127]
    s_add_u32 s53, s42, 39
    s_mul_i32 s52, s53, 24192
    s_mul_i32 s53, s53, 1008
    s_mov_b32 m0, s53
    ds_read_b64_tr_b16 v[58:59], v217 offset:35072
    s_mov_b32 exec_hi, 0x7fffffff
    buffer_load_dwordx4 v210, s[28:31], s52 offen lds
    s_mov_b32 exec_hi, -1
    s_waitcnt lgkmcnt(10)
    v_mfma_f32_32x32x16_bf16 v[176:191], v[16:19], a[128:131], v[176:191]
    ds_read_b64_tr_b16 v[12:13], v3 offset:34816
    v_mfma_f32_32x32x16_bf16 v[192:207], v[16:19], v[240:243], v[192:207]
    ds_read_b64_tr_b16 v[14:15], v3 offset:35072
    s_waitcnt vmcnt(11) lgkmcnt(10)
    v_mfma_f32_32x32x16_bf16 v[64:79], v[40:43], a[132:135], v[64:79]
    s_add_u32 s53, s42, 43
    s_mul_i32 s52, s53, 24192
    s_mul_i32 s53, s53, 1008
    s_mov_b32 m0, s53
    ds_read_b64_tr_b16 v[48:49], v216 offset:35840
    s_mov_b32 exec_hi, 0x7fffffff
    buffer_load_dwordx4 v210, s[28:31], s52 offen lds
    s_mov_b32 exec_hi, -1
    s_waitcnt vmcnt(11)
    v_mfma_f32_32x32x16_bf16 v[80:95], v[40:43], v[244:247], v[80:95]
    ds_read_b64_tr_b16 v[50:51], v216 offset:36096
    s_waitcnt lgkmcnt(10)
    v_mfma_f32_32x32x16_bf16 v[96:111], v[52:55], a[132:135], v[96:111]
    ds_read_b64_tr_b16 v[60:61], v217 offset:35840
    v_mfma_f32_32x32x16_bf16 v[112:127], v[52:55], v[244:247], v[112:127]
    s_add_u32 s53, s42, 47
    s_mul_i32 s52, s53, 24192
    s_mul_i32 s53, s53, 1008
    s_mov_b32 m0, s53
    ds_read_b64_tr_b16 v[62:63], v217 offset:36096
    s_mov_b32 exec_hi, 0x7fffffff
    buffer_load_dwordx4 v210, s[28:31], s52 offen lds
    s_mov_b32 exec_hi, -1
    s_waitcnt lgkmcnt(10)
    v_mfma_f32_32x32x16_bf16 v[176:191], v[8:11], a[132:135], v[176:191]
    ds_read_b64_tr_b16 v[16:17], v3 offset:35840
    v_mfma_f32_32x32x16_bf16 v[192:207], v[8:11], v[244:247], v[192:207]
    ds_read_b64_tr_b16 v[18:19], v3 offset:36096
    s_waitcnt vmcnt(11) lgkmcnt(10)
    v_mfma_f32_32x32x16_bf16 v[64:79], v[44:47], a[136:139], v[64:79]
    s_mov_b32 s53, 51
    s_cmp_eq_u32 s42, 1
    s_cselect_b32 s53, 52, s53
    s_cmp_eq_u32 s42, 2
    s_cselect_b32 s53, 53, s53
    s_cmp_eq_u32 s42, 3
    s_cselect_b32 s53, 74, s53
    s_mul_i32 s52, s53, 24192
    s_mul_i32 s53, s53, 1008
    s_mov_b32 m0, s53
    s_mov_b32 exec_hi, 0x7fffffff
    buffer_load_dwordx4 v210, s[28:31], s52 offen lds
    s_mov_b32 exec_hi, -1
    s_waitcnt vmcnt(11)
    v_mfma_f32_32x32x16_bf16 v[80:95], v[44:47], v[248:251], v[80:95]
    s_waitcnt lgkmcnt(8)
    v_mfma_f32_32x32x16_bf16 v[96:111], v[56:59], a[136:139], v[96:111]
    v_mfma_f32_32x32x16_bf16 v[112:127], v[56:59], v[248:251], v[112:127]
    s_add_u32 s53, s42, 75
    s_mul_i32 s52, s53, 24192
    s_mul_i32 s53, s53, 1008
    s_mov_b32 m0, s53
    s_mov_b32 exec_hi, 0x7fffffff
    buffer_load_dwordx4 v210, s[28:31], s52 offen lds
    s_mov_b32 exec_hi, -1
    s_waitcnt lgkmcnt(6)
    v_mfma_f32_32x32x16_bf16 v[176:191], v[12:15], a[136:139], v[176:191]
    v_mfma_f32_32x32x16_bf16 v[192:207], v[12:15], v[248:251], v[192:207]
    s_add_u32 s53, s42, 79
    s_mul_i32 s52, s53, 24192
    s_mul_i32 s53, s53, 1008
    s_mov_b32 m0, s53
    s_mov_b32 exec_hi, 0x7fffffff
    buffer_load_dwordx4 v210, s[28:31], s52 offen lds
    s_mov_b32 exec_hi, -1
    s_waitcnt lgkmcnt(0)
    v_add_u32 v217, 83968, v215
    s_barrier
    ds_read_b64_tr_b16 v[40:41], v217 offset:0
    ds_read_b64_tr_b16 v[42:43], v217 offset:256
    ds_read_b64_tr_b16 v[44:45], v217 offset:1024
    ds_read_b64_tr_b16 v[46:47], v217 offset:1280
    s_waitcnt vmcnt(12)
    v_mfma_f32_32x32x16_bf16 v[64:79], v[48:51], a[140:143], v[64:79]
    s_waitcnt vmcnt(11)
    v_mfma_f32_32x32x16_bf16 v[80:95], v[48:51], v[252:255], v[80:95]
    v_mfma_f32_32x32x16_bf16 v[96:111], v[60:63], a[140:143], v[96:111]
    v_mfma_f32_32x32x16_bf16 v[112:127], v[60:63], v[252:255], v[112:127]
    v_mfma_f32_32x32x16_bf16 v[176:191], v[16:19], a[140:143], v[176:191]
    v_mfma_f32_32x32x16_bf16 v[192:207], v[16:19], v[252:255], v[192:207]
    ds_read_b64_tr_b16 v[48:49], v217 offset:2048
    ds_read_b64_tr_b16 v[50:51], v217 offset:2304
    v_mov_b32 v216, v212
    s_waitcnt lgkmcnt(2)
    v_mfma_f32_32x32x16_bf16 v[8:23], v[40:43], a[0:3], 0
    s_add_u32 s53, s42, 18
    s_mul_i32 s52, s53, 24192
    s_mul_i32 s53, s53, 1008
    s_mov_b32 m0, s53
    ds_read_b64_tr_b16 v[52:53], v217 offset:3072
    s_mov_b32 exec_hi, 0x7fffffff
    buffer_load_dwordx4 v210, s[28:31], s52 offen lds
    s_mov_b32 exec_hi, -1
    s_nop 0
    v_mfma_f32_32x32x16_bf16 v[24:39], v[40:43], a[144:147], 0
    ds_read_b64_tr_b16 v[54:55], v217 offset:3328
    v_mfma_f32_32x32x16_bf16 v[8:23], v[44:47], a[4:7], v[8:23]
    ds_read_b64_tr_b16 v[40:41], v217 offset:4096
    v_mfma_f32_32x32x16_bf16 v[24:39], v[44:47], a[148:151], v[24:39]
    ds_read_b64_tr_b16 v[42:43], v217 offset:4352
    v_mul_f32 v128, s59, v64
    v_mul_f32 v129, s59, v65
    v_mul_f32 v130, s59, v66
    s_waitcnt lgkmcnt(2)
    v_mfma_f32_32x32x16_bf16 v[8:23], v[48:51], a[8:11], v[8:23]
    ds_read_b64_tr_b16 v[44:45], v217 offset:5120
    v_mul_f32 v131, s59, v67
    v_mul_f32 v132, s59, v68
    v_mfma_f32_32x32x16_bf16 v[24:39], v[48:51], a[152:155], v[24:39]
    s_add_u32 s53, s42, 22
    s_mul_i32 s52, s53, 24192
    s_mul_i32 s53, s53, 1008
    s_mov_b32 m0, s53
    ds_read_b64_tr_b16 v[46:47], v217 offset:5376
    s_mov_b32 exec_hi, 0x7fffffff
    buffer_load_dwordx4 v210, s[28:31], s52 offen lds
    s_mov_b32 exec_hi, -1
    s_nop 0
    v_mfma_f32_32x32x16_bf16 v[8:23], v[52:55], a[12:15], v[8:23]
    ds_read_b64_tr_b16 v[48:49], v217 offset:6144
    v_mul_f32 v133, s59, v69
    v_mul_f32 v134, s59, v70
    v_mul_f32 v135, s59, v71
    v_mfma_f32_32x32x16_bf16 v[24:39], v[52:55], a[156:159], v[24:39]
    ds_read_b64_tr_b16 v[50:51], v217 offset:6400
    v_exp_f32 v128, v128
    v_exp_f32 v129, v129
    s_waitcnt lgkmcnt(2)
    v_mfma_f32_32x32x16_bf16 v[8:23], v[40:43], a[16:19], v[8:23]
    ds_read_b64_tr_b16 v[52:53], v217 offset:7168
    v_exp_f32 v130, v130
    v_exp_f32 v131, v131
    v_exp_f32 v132, v132
    v_mfma_f32_32x32x16_bf16 v[24:39], v[40:43], a[160:163], v[24:39]
    ds_read_b64_tr_b16 v[54:55], v217 offset:7424
    v_exp_f32 v133, v133
    v_exp_f32 v134, v134
    v_mfma_f32_32x32x16_bf16 v[8:23], v[44:47], a[20:23], v[8:23]
    s_add_u32 s53, s42, 26
    s_mul_i32 s52, s53, 24192
    s_mul_i32 s53, s53, 1008
    s_mov_b32 m0, s53
    ds_read_b64_tr_b16 v[40:41], v217 offset:8192
    s_mov_b32 exec_hi, 0x7fffffff
    buffer_load_dwordx4 v210, s[28:31], s52 offen lds
    s_mov_b32 exec_hi, -1
    s_nop 0
    v_mfma_f32_32x32x16_bf16 v[24:39], v[44:47], a[164:167], v[24:39]
    ds_read_b64_tr_b16 v[42:43], v217 offset:8448
    v_exp_f32 v135, v135
    v_mul_f32 v136, v64, v72
    v_mul_f32 v137, v65, v73
    s_waitcnt lgkmcnt(2)
    v_mfma_f32_32x32x16_bf16 v[8:23], v[48:51], a[24:27], v[8:23]
    ds_read_b64_tr_b16 v[44:45], v217 offset:9216
    v_mul_f32 v138, v66, v74
    v_mul_f32 v139, v67, v75
    v_mfma_f32_32x32x16_bf16 v[24:39], v[48:51], a[168:171], v[24:39]
    ds_read_b64_tr_b16 v[46:47], v217 offset:9472
    v_mul_f32 v140, v68, v76
    v_mul_f32 v141, v69, v77
    v_mul_f32 v142, v70, v78
    v_mfma_f32_32x32x16_bf16 v[8:23], v[52:55], a[28:31], v[8:23]
    ds_read_b64_tr_b16 v[48:49], v217 offset:10240
    v_mul_f32 v143, v71, v79
    v_add_f32 v128, 1.0, v128
    v_mfma_f32_32x32x16_bf16 v[24:39], v[52:55], a[172:175], v[24:39]
    s_add_u32 s53, s42, 30
    s_mul_i32 s52, s53, 24192
    s_mul_i32 s53, s53, 1008
    s_mov_b32 m0, s53
    ds_read_b64_tr_b16 v[50:51], v217 offset:10496
    s_mov_b32 exec_hi, 0x7fffffff
    buffer_load_dwordx4 v210, s[28:31], s52 offen lds
    s_mov_b32 exec_hi, -1
    s_waitcnt lgkmcnt(2)
    v_mfma_f32_32x32x16_bf16 v[8:23], v[40:43], a[32:35], v[8:23]
    ds_read_b64_tr_b16 v[52:53], v217 offset:11264
    v_add_f32 v129, 1.0, v129
    v_add_f32 v130, 1.0, v130
    v_add_f32 v131, 1.0, v131
    v_mfma_f32_32x32x16_bf16 v[24:39], v[40:43], a[176:179], v[24:39]
    ds_read_b64_tr_b16 v[54:55], v217 offset:11520
    v_add_f32 v132, 1.0, v132
    v_add_f32 v133, 1.0, v133
    v_mfma_f32_32x32x16_bf16 v[8:23], v[44:47], a[36:39], v[8:23]
    ds_read_b64_tr_b16 v[40:41], v217 offset:12288
    v_add_f32 v134, 1.0, v134
    v_add_f32 v135, 1.0, v135
    v_mfma_f32_32x32x16_bf16 v[24:39], v[44:47], a[180:183], v[24:39]
    ds_read_b64_tr_b16 v[42:43], v217 offset:12544
    v_rcp_f32 v128, v128
    v_rcp_f32 v129, v129
    v_rcp_f32 v130, v130
    s_waitcnt lgkmcnt(2)
    v_mfma_f32_32x32x16_bf16 v[8:23], v[48:51], a[40:43], v[8:23]
    s_mov_b32 s53, 34
    s_cmp_eq_u32 s42, 1
    s_cselect_b32 s53, 35, s53
    s_cmp_eq_u32 s42, 2
    s_cselect_b32 s53, 36, s53
    s_cmp_eq_u32 s42, 3
    s_cselect_b32 s53, 54, s53
    s_mul_i32 s52, s53, 24192
    s_mul_i32 s53, s53, 1008
    s_mov_b32 m0, s53
    ds_read_b64_tr_b16 v[44:45], v217 offset:13312
    s_mov_b32 exec_hi, 0x7fffffff
    buffer_load_dwordx4 v210, s[28:31], s52 offen lds
    s_mov_b32 exec_hi, -1
    s_nop 0
    v_mfma_f32_32x32x16_bf16 v[24:39], v[48:51], a[184:187], v[24:39]
    ds_read_b64_tr_b16 v[46:47], v217 offset:13568
    v_rcp_f32 v131, v131
    v_rcp_f32 v132, v132
    v_mfma_f32_32x32x16_bf16 v[8:23], v[52:55], a[44:47], v[8:23]
    ds_read_b64_tr_b16 v[48:49], v217 offset:14336
    v_rcp_f32 v133, v133
    v_rcp_f32 v134, v134
    v_rcp_f32 v135, v135
    v_mfma_f32_32x32x16_bf16 v[24:39], v[52:55], a[188:191], v[24:39]
    ds_read_b64_tr_b16 v[50:51], v217 offset:14592
    s_lshl_b32 s46, s58, 10
    s_add_u32 s46, s46, s56
    s_waitcnt lgkmcnt(2)
    v_mfma_f32_32x32x16_bf16 v[8:23], v[40:43], a[48:51], v[8:23]
    ds_read_b64_tr_b16 v[52:53], v217 offset:15360
    v_mul_f32 v136, v136, v128
    v_mul_f32 v137, v137, v129
    v_mul_f32 v138, v138, v130
    v_mfma_f32_32x32x16_bf16 v[24:39], v[40:43], a[192:195], v[24:39]
    s_add_u32 s53, s42, 55
    s_mul_i32 s52, s53, 24192
    s_mul_i32 s53, s53, 1008
    s_mov_b32 m0, s53
    ds_read_b64_tr_b16 v[54:55], v217 offset:15616
    s_mov_b32 exec_hi, 0x7fffffff
    buffer_load_dwordx4 v210, s[28:31], s52 offen lds
    s_mov_b32 exec_hi, -1
    s_nop 0
    v_mfma_f32_32x32x16_bf16 v[8:23], v[44:47], a[52:55], v[8:23]
    ds_read_b64_tr_b16 v[40:41], v217 offset:16384
    v_mul_f32 v139, v139, v131
    v_mul_f32 v140, v140, v132
    v_mfma_f32_32x32x16_bf16 v[24:39], v[44:47], a[196:199], v[24:39]
    ds_read_b64_tr_b16 v[42:43], v217 offset:16640
    v_mul_f32 v141, v141, v133
    v_mul_f32 v142, v142, v134
    v_mul_f32 v143, v143, v135
    s_waitcnt lgkmcnt(2)
    v_mfma_f32_32x32x16_bf16 v[8:23], v[48:51], a[56:59], v[8:23]
    ds_read_b64_tr_b16 v[44:45], v217 offset:17408
    v_cvt_pk_bf16_f32 v144, v136, v137
    v_cvt_pk_bf16_f32 v145, v138, v139
    v_mfma_f32_32x32x16_bf16 v[24:39], v[48:51], a[200:203], v[24:39]
    ds_read_b64_tr_b16 v[46:47], v217 offset:17664
    v_cvt_pk_bf16_f32 v146, v140, v141
    v_cvt_pk_bf16_f32 v147, v142, v143
    buffer_store_dwordx4 v[144:147], v2, s[24:27], s46 offen sc1
    v_mfma_f32_32x32x16_bf16 v[8:23], v[52:55], a[60:63], v[8:23]
    s_add_u32 s53, s42, 59
    s_mul_i32 s52, s53, 24192
    s_mul_i32 s53, s53, 1008
    s_mov_b32 m0, s53
    ds_read_b64_tr_b16 v[48:49], v217 offset:18432
    s_mov_b32 exec_hi, 0x7fffffff
    buffer_load_dwordx4 v210, s[28:31], s52 offen lds
    s_mov_b32 exec_hi, -1
    s_nop 0
    v_mfma_f32_32x32x16_bf16 v[24:39], v[52:55], a[204:207], v[24:39]
    ds_read_b64_tr_b16 v[50:51], v217 offset:18688
    v_mul_f32 v152, s59, v80
    v_mul_f32 v153, s59, v81
    s_waitcnt lgkmcnt(2)
    v_mfma_f32_32x32x16_bf16 v[8:23], v[40:43], a[64:67], v[8:23]
    ds_read_b64_tr_b16 v[52:53], v217 offset:19456
    v_mul_f32 v154, s59, v82
    v_mul_f32 v155, s59, v83
    v_mfma_f32_32x32x16_bf16 v[24:39], v[40:43], a[208:211], v[24:39]
    ds_read_b64_tr_b16 v[54:55], v217 offset:19712
    v_mul_f32 v156, s59, v84
    v_mul_f32 v157, s59, v85
    v_mul_f32 v158, s59, v86
    v_mfma_f32_32x32x16_bf16 v[8:23], v[44:47], a[68:71], v[8:23]
    ds_read_b64_tr_b16 v[40:41], v217 offset:20480
    v_mul_f32 v159, s59, v87
    v_exp_f32 v152, v152
    v_mfma_f32_32x32x16_bf16 v[24:39], v[44:47], a[212:215], v[24:39]
    s_add_u32 s53, s42, 63
    s_mul_i32 s52, s53, 24192
    s_mul_i32 s53, s53, 1008
    s_mov_b32 m0, s53
    ds_read_b64_tr_b16 v[42:43], v217 offset:20736
    s_mov_b32 exec_hi, 0x7fffffff
    buffer_load_dwordx4 v210, s[28:31], s52 offen lds
    s_mov_b32 exec_hi, -1
    s_waitcnt lgkmcnt(2)
    v_mfma_f32_32x32x16_bf16 v[8:23], v[48:51], a[72:75], v[8:23]
    ds_read_b64_tr_b16 v[44:45], v217 offset:21504
    v_exp_f32 v153, v153
    v_exp_f32 v154, v154
    v_exp_f32 v155, v155
    v_mfma_f32_32x32x16_bf16 v[24:39], v[48:51], a[216:219], v[24:39]
    ds_read_b64_tr_b16 v[46:47], v217 offset:21760
    v_exp_f32 v156, v156
    v_exp_f32 v157, v157
    v_mfma_f32_32x32x16_bf16 v[8:23], v[52:55], a[76:79], v[8:23]
    ds_read_b64_tr_b16 v[48:49], v217 offset:22528
    v_exp_f32 v158, v158
    v_exp_f32 v159, v159
    v_mul_f32 v160, v80, v88
    v_mfma_f32_32x32x16_bf16 v[24:39], v[52:55], a[220:223], v[24:39]
    ds_read_b64_tr_b16 v[50:51], v217 offset:22784
    v_mul_f32 v161, v81, v89
    v_mul_f32 v162, v82, v90
    s_waitcnt lgkmcnt(2)
    v_mfma_f32_32x32x16_bf16 v[8:23], v[40:43], a[80:83], v[8:23]
    s_add_u32 s53, s42, 67
    s_mul_i32 s52, s53, 24192
    s_mul_i32 s53, s53, 1008
    s_mov_b32 m0, s53
    ds_read_b64_tr_b16 v[52:53], v217 offset:23552
    s_mov_b32 exec_hi, 0x7fffffff
    buffer_load_dwordx4 v210, s[28:31], s52 offen lds
    s_mov_b32 exec_hi, -1
    s_nop 0
    v_mfma_f32_32x32x16_bf16 v[24:39], v[40:43], a[224:227], v[24:39]
    ds_read_b64_tr_b16 v[54:55], v217 offset:23808
    v_mul_f32 v163, v83, v91
    v_mul_f32 v164, v84, v92
    v_mul_f32 v165, v85, v93
    v_mfma_f32_32x32x16_bf16 v[8:23], v[44:47], a[84:87], v[8:23]
    ds_read_b64_tr_b16 v[40:41], v217 offset:24576
    v_mul_f32 v166, v86, v94
    v_mul_f32 v167, v87, v95
    v_mfma_f32_32x32x16_bf16 v[24:39], v[44:47], a[228:231], v[24:39]
    ds_read_b64_tr_b16 v[42:43], v217 offset:24832
    v_add_f32 v152, 1.0, v152
    v_add_f32 v153, 1.0, v153
    v_add_f32 v154, 1.0, v154
    s_waitcnt lgkmcnt(2)
    v_mfma_f32_32x32x16_bf16 v[8:23], v[48:51], a[88:91], v[8:23]
    ds_read_b64_tr_b16 v[44:45], v217 offset:25600
    v_add_f32 v155, 1.0, v155
    v_add_f32 v156, 1.0, v156
    v_mfma_f32_32x32x16_bf16 v[24:39], v[48:51], a[232:235], v[24:39]
    s_mov_b32 s53, 71
    s_cmp_eq_u32 s42, 1
    s_cselect_b32 s53, 72, s53
    s_cmp_eq_u32 s42, 2
    s_cselect_b32 s53, 73, s53
    s_cmp_eq_u32 s42, 3
    s_cselect_b32 s53, 73, s53
    s_mul_i32 s52, s53, 24192
    s_mul_i32 s53, s53, 1008
    s_mov_b32 m0, s53
    ds_read_b64_tr_b16 v[46:47], v217 offset:25856
    s_mov_b32 exec_hi, 0x7fffffff
    buffer_load_dwordx4 v210, s[28:31], s52 offen lds
    s_mov_b32 exec_hi, -1
    s_nop 0
    v_mfma_f32_32x32x16_bf16 v[8:23], v[52:55], a[92:95], v[8:23]
    ds_read_b64_tr_b16 v[48:49], v217 offset:26624
    v_add_f32 v157, 1.0, v157
    v_add_f32 v158, 1.0, v158
    v_mfma_f32_32x32x16_bf16 v[24:39], v[52:55], a[236:239], v[24:39]
    ds_read_b64_tr_b16 v[50:51], v217 offset:26880
    v_add_f32 v159, 1.0, v159
    v_rcp_f32 v152, v152
    v_rcp_f32 v153, v153
    s_waitcnt lgkmcnt(2)
    v_mfma_f32_32x32x16_bf16 v[8:23], v[40:43], a[96:99], v[8:23]
    ds_read_b64_tr_b16 v[52:53], v217 offset:27648
    v_rcp_f32 v154, v154
    v_rcp_f32 v155, v155
    v_mfma_f32_32x32x16_bf16 v[24:39], v[40:43], a[240:243], v[24:39]
    ds_read_b64_tr_b16 v[54:55], v217 offset:27904
    v_rcp_f32 v156, v156
    v_rcp_f32 v157, v157
    v_rcp_f32 v158, v158
    v_mfma_f32_32x32x16_bf16 v[8:23], v[44:47], a[100:103], v[8:23]
    ds_read_b64_tr_b16 v[40:41], v217 offset:28672
    v_rcp_f32 v159, v159
    s_lshl_b32 s47, s58, 10
    v_mfma_f32_32x32x16_bf16 v[24:39], v[44:47], a[244:247], v[24:39]
    ds_read_b64_tr_b16 v[42:43], v217 offset:28928
    s_add_u32 s47, s47, s57
    v_mul_f32 v160, v160, v152
    v_mul_f32 v161, v161, v153
    s_waitcnt lgkmcnt(2)
    v_mfma_f32_32x32x16_bf16 v[8:23], v[48:51], a[104:107], v[8:23]
    ds_read_b64_tr_b16 v[44:45], v217 offset:29696
    v_mul_f32 v162, v162, v154
    v_mul_f32 v163, v163, v155
    v_mfma_f32_32x32x16_bf16 v[24:39], v[48:51], a[248:251], v[24:39]
    ds_read_b64_tr_b16 v[46:47], v217 offset:29952
    v_mul_f32 v164, v164, v156
    v_mul_f32 v165, v165, v157
    v_mul_f32 v166, v166, v158
    v_mfma_f32_32x32x16_bf16 v[8:23], v[52:55], a[108:111], v[8:23]
    ds_read_b64_tr_b16 v[48:49], v217 offset:30720
    v_mul_f32 v167, v167, v159
    v_cvt_pk_bf16_f32 v168, v160, v161
    v_mfma_f32_32x32x16_bf16 v[24:39], v[52:55], a[252:255], v[24:39]
    ds_read_b64_tr_b16 v[50:51], v217 offset:30976
    v_cvt_pk_bf16_f32 v169, v162, v163
    v_cvt_pk_bf16_f32 v170, v164, v165
    v_cvt_pk_bf16_f32 v171, v166, v167
    s_waitcnt lgkmcnt(2)
    v_mfma_f32_32x32x16_bf16 v[8:23], v[40:43], a[112:115], v[8:23]
    ds_read_b64_tr_b16 v[52:53], v217 offset:31744
    buffer_store_dwordx4 v[168:171], v2, s[24:27], s47 offen sc1
    s_add_u32 s58, s58, 1
    v_mfma_f32_32x32x16_bf16 v[24:39], v[40:43], v[224:227], v[24:39]
    ds_read_b64_tr_b16 v[54:55], v217 offset:32000
    v_mul_f32 v128, s59, v96
    v_mul_f32 v129, s59, v97
    v_mfma_f32_32x32x16_bf16 v[8:23], v[44:47], a[116:119], v[8:23]
    ds_read_b64_tr_b16 v[40:41], v217 offset:32768
    v_mul_f32 v130, s59, v98
    v_mul_f32 v131, s59, v99
    v_mul_f32 v132, s59, v100
    v_mfma_f32_32x32x16_bf16 v[24:39], v[44:47], v[228:231], v[24:39]
    ds_read_b64_tr_b16 v[42:43], v217 offset:33024
    v_mul_f32 v133, s59, v101
    v_mul_f32 v134, s59, v102
    s_waitcnt lgkmcnt(2)
    v_mfma_f32_32x32x16_bf16 v[8:23], v[48:51], a[120:123], v[8:23]
    ds_read_b64_tr_b16 v[44:45], v217 offset:33792
    v_mul_f32 v135, s59, v103
    v_exp_f32 v128, v128
    v_exp_f32 v129, v129
    v_mfma_f32_32x32x16_bf16 v[24:39], v[48:51], v[232:235], v[24:39]
    ds_read_b64_tr_b16 v[46:47], v217 offset:34048
    v_exp_f32 v130, v130
    v_exp_f32 v131, v131
    v_mfma_f32_32x32x16_bf16 v[8:23], v[52:55], a[124:127], v[8:23]
    ds_read_b64_tr_b16 v[48:49], v217 offset:34816
    v_exp_f32 v132, v132
    v_exp_f32 v133, v133
    v_exp_f32 v134, v134
    v_mfma_f32_32x32x16_bf16 v[24:39], v[52:55], v[236:239], v[24:39]
    ds_read_b64_tr_b16 v[50:51], v217 offset:35072
    v_exp_f32 v135, v135
    v_mul_f32 v136, v96, v104
    s_waitcnt lgkmcnt(2)
    v_mfma_f32_32x32x16_bf16 v[8:23], v[40:43], a[128:131], v[8:23]
    ds_read_b64_tr_b16 v[52:53], v217 offset:35840
    v_mul_f32 v137, v97, v105
    v_mul_f32 v138, v98, v106
    v_mul_f32 v139, v99, v107
    v_mfma_f32_32x32x16_bf16 v[24:39], v[40:43], v[240:243], v[24:39]
    ds_read_b64_tr_b16 v[54:55], v217 offset:36096
    v_mul_f32 v140, v100, v108
    v_mul_f32 v141, v101, v109
    v_mfma_f32_32x32x16_bf16 v[8:23], v[44:47], a[132:135], v[8:23]
    v_mul_f32 v142, v102, v110
    v_mul_f32 v143, v103, v111
    v_add_f32 v128, 1.0, v128
    v_mfma_f32_32x32x16_bf16 v[24:39], v[44:47], v[244:247], v[24:39]
    v_add_f32 v129, 1.0, v129
    v_add_f32 v130, 1.0, v130
    s_waitcnt lgkmcnt(0)
    v_mfma_f32_32x32x16_bf16 v[8:23], v[48:51], a[136:139], v[8:23]
    v_add_f32 v131, 1.0, v131
    v_add_f32 v132, 1.0, v132
    v_mfma_f32_32x32x16_bf16 v[24:39], v[48:51], v[248:251], v[24:39]
    s_waitcnt vmcnt(1)
    s_barrier
    ds_read_b64_tr_b16 v[40:41], v216 offset:0
    ds_read_b64_tr_b16 v[42:43], v216 offset:576
    ds_read_b64_tr_b16 v[44:45], v216 offset:2304
    ds_read_b64_tr_b16 v[46:47], v216 offset:2880
    ds_read_b64_tr_b16 v[48:49], v216 offset:4608
    ds_read_b64_tr_b16 v[50:51], v216 offset:5184
    v_mfma_f32_32x32x16_bf16 v[8:23], v[52:55], a[140:143], v[8:23]
    v_mfma_f32_32x32x16_bf16 v[24:39], v[52:55], v[252:255], v[24:39]
    v_mov_b32 v217, v213
    s_lshl_b32 s51, s42, 10
    s_add_u32 s51, s51, 83968
    s_add_u32 s61, s61, 128
    s_waitcnt lgkmcnt(2)
    v_mfma_f32_32x32x16_bf16 v[64:79], v[40:43], a[0:3], 0
    s_mul_i32 s52, s42, 147456
    s_add_u32 s52, s52, s61
    s_mov_b32 s53, s51
    s_add_u32 m0, s53, 0
    ds_read_b64_tr_b16 v[52:53], v216 offset:6912
    buffer_load_dwordx4 v208, s[32:35], s52 offen lds
    v_mfma_f32_32x32x16_bf16 v[80:95], v[40:43], a[144:147], 0
    ds_read_b64_tr_b16 v[54:55], v216 offset:7488
    v_mfma_f32_32x32x16_bf16 v[64:79], v[44:47], a[4:7], v[64:79]
    ds_read_b64_tr_b16 v[40:41], v216 offset:9216
    v_mfma_f32_32x32x16_bf16 v[80:95], v[44:47], a[148:151], v[80:95]
    ds_read_b64_tr_b16 v[42:43], v216 offset:9792
    v_add_f32 v133, 1.0, v133
    v_add_f32 v134, 1.0, v134
    v_add_f32 v135, 1.0, v135
    s_waitcnt lgkmcnt(2)
    v_mfma_f32_32x32x16_bf16 v[64:79], v[48:51], a[8:11], v[64:79]
    ds_read_b64_tr_b16 v[44:45], v216 offset:11520
    v_rcp_f32 v128, v128
    v_rcp_f32 v129, v129
    v_rcp_f32 v130, v130
    v_mfma_f32_32x32x16_bf16 v[80:95], v[48:51], a[152:155], v[80:95]
    ds_read_b64_tr_b16 v[46:47], v216 offset:12096
    v_rcp_f32 v131, v131
    v_rcp_f32 v132, v132
    v_mfma_f32_32x32x16_bf16 v[64:79], v[52:55], a[12:15], v[64:79]
    s_add_u32 m0, s53, 36864
    ds_read_b64_tr_b16 v[48:49], v216 offset:13824
    buffer_load_dwordx4 v209, s[36:39], s52 offen lds
    v_mfma_f32_32x32x16_bf16 v[80:95], v[52:55], a[156:159], v[80:95]
    ds_read_b64_tr_b16 v[50:51], v216 offset:14400
    v_rcp_f32 v133, v133
    v_rcp_f32 v134, v134
    v_rcp_f32 v135, v135
    s_waitcnt lgkmcnt(2)
    v_mfma_f32_32x32x16_bf16 v[64:79], v[40:43], a[16:19], v[64:79]
    ds_read_b64_tr_b16 v[52:53], v216 offset:16128
    s_lshl_b32 s46, s58, 10
    s_add_u32 s46, s46, s56
    v_mfma_f32_32x32x16_bf16 v[80:95], v[40:43], a[160:163], v[80:95]
    ds_read_b64_tr_b16 v[54:55], v216 offset:16704
    v_mul_f32 v136, v136, v128
    v_mul_f32 v137, v137, v129
    v_mul_f32 v138, v138, v130
    v_mfma_f32_32x32x16_bf16 v[64:79], v[44:47], a[20:23], v[64:79]
    ds_read_b64_tr_b16 v[40:41], v216 offset:18432
    v_mul_f32 v139, v139, v131
    v_mul_f32 v140, v140, v132
    v_mfma_f32_32x32x16_bf16 v[80:95], v[44:47], a[164:167], v[80:95]
    ds_read_b64_tr_b16 v[42:43], v216 offset:19008
    v_mul_f32 v141, v141, v133
    v_mul_f32 v142, v142, v134
    v_mul_f32 v143, v143, v135
    s_waitcnt lgkmcnt(2)
    v_mfma_f32_32x32x16_bf16 v[64:79], v[48:51], a[24:27], v[64:79]
    s_add_u32 s52, s52, 589824
    s_add_u32 s53, s53, 4096
    s_add_u32 m0, s53, 0
    ds_read_b64_tr_b16 v[44:45], v216 offset:20736
    buffer_load_dwordx4 v208, s[32:35], s52 offen lds
    v_mfma_f32_32x32x16_bf16 v[80:95], v[48:51], a[168:171], v[80:95]
    ds_read_b64_tr_b16 v[46:47], v216 offset:21312
    v_cvt_pk_bf16_f32 v144, v136, v137
    v_cvt_pk_bf16_f32 v145, v138, v139
    v_mfma_f32_32x32x16_bf16 v[64:79], v[52:55], a[28:31], v[64:79]
    ds_read_b64_tr_b16 v[48:49], v216 offset:23040
    v_cvt_pk_bf16_f32 v146, v140, v141
    v_cvt_pk_bf16_f32 v147, v142, v143
    buffer_store_dwordx4 v[144:147], v2, s[24:27], s46 offen sc1
    v_mfma_f32_32x32x16_bf16 v[80:95], v[52:55], a[172:175], v[80:95]
    ds_read_b64_tr_b16 v[50:51], v216 offset:23616
    v_mul_f32 v152, s59, v112
    v_mul_f32 v153, s59, v113
    s_waitcnt lgkmcnt(2)
    v_mfma_f32_32x32x16_bf16 v[64:79], v[40:43], a[32:35], v[64:79]
    ds_read_b64_tr_b16 v[52:53], v216 offset:25344
    v_mul_f32 v154, s59, v114
    v_mul_f32 v155, s59, v115
    v_mul_f32 v156, s59, v116
    v_mfma_f32_32x32x16_bf16 v[80:95], v[40:43], a[176:179], v[80:95]
    ds_read_b64_tr_b16 v[54:55], v216 offset:25920
    v_mul_f32 v157, s59, v117
    v_mul_f32 v158, s59, v118
    v_mul_f32 v159, s59, v119
    v_mfma_f32_32x32x16_bf16 v[64:79], v[44:47], a[36:39], v[64:79]
    s_add_u32 m0, s53, 36864
    ds_read_b64_tr_b16 v[40:41], v216 offset:27648
    buffer_load_dwordx4 v209, s[36:39], s52 offen lds
    v_mfma_f32_32x32x16_bf16 v[80:95], v[44:47], a[180:183], v[80:95]
    ds_read_b64_tr_b16 v[42:43], v216 offset:28224
    v_exp_f32 v152, v152
    v_exp_f32 v153, v153
    s_waitcnt lgkmcnt(2)
    v_mfma_f32_32x32x16_bf16 v[64:79], v[48:51], a[40:43], v[64:79]
    ds_read_b64_tr_b16 v[44:45], v216 offset:29952
    v_exp_f32 v154, v154
    v_exp_f32 v155, v155
    v_exp_f32 v156, v156
    v_mfma_f32_32x32x16_bf16 v[80:95], v[48:51], a[184:187], v[80:95]
    ds_read_b64_tr_b16 v[46:47], v216 offset:30528
    v_exp_f32 v157, v157
    v_exp_f32 v158, v158
    v_mfma_f32_32x32x16_bf16 v[64:79], v[52:55], a[44:47], v[64:79]
    ds_read_b64_tr_b16 v[48:49], v216 offset:32256
    v_exp_f32 v159, v159
    v_mul_f32 v160, v112, v120
    v_mul_f32 v161, v113, v121
    v_mfma_f32_32x32x16_bf16 v[80:95], v[52:55], a[188:191], v[80:95]
    ds_read_b64_tr_b16 v[50:51], v216 offset:32832
    v_mul_f32 v162, v114, v122
    v_mul_f32 v163, v115, v123
    s_waitcnt lgkmcnt(2)
    v_mfma_f32_32x32x16_bf16 v[64:79], v[40:43], a[48:51], v[64:79]
    s_add_u32 s52, s52, 589824
    s_add_u32 s53, s53, 4096
    s_add_u32 m0, s53, 0
    ds_read_b64_tr_b16 v[52:53], v216 offset:34560
    buffer_load_dwordx4 v208, s[32:35], s52 offen lds
    v_mfma_f32_32x32x16_bf16 v[80:95], v[40:43], a[192:195], v[80:95]
    ds_read_b64_tr_b16 v[54:55], v216 offset:35136
    v_mul_f32 v164, v116, v124
    v_mul_f32 v165, v117, v125
    v_mul_f32 v166, v118, v126
    v_mfma_f32_32x32x16_bf16 v[64:79], v[44:47], a[52:55], v[64:79]
    ds_read_b64_tr_b16 v[40:41], v216 offset:36864
    v_mul_f32 v167, v119, v127
    v_add_f32 v152, 1.0, v152
    v_mfma_f32_32x32x16_bf16 v[80:95], v[44:47], a[196:199], v[80:95]
    ds_read_b64_tr_b16 v[42:43], v216 offset:37440
    v_add_f32 v153, 1.0, v153
    v_add_f32 v154, 1.0, v154
    v_add_f32 v155, 1.0, v155
    s_waitcnt lgkmcnt(2)
    v_mfma_f32_32x32x16_bf16 v[64:79], v[48:51], a[56:59], v[64:79]
    ds_read_b64_tr_b16 v[44:45], v216 offset:39168
    v_add_f32 v156, 1.0, v156
    v_add_f32 v157, 1.0, v157
    v_mfma_f32_32x32x16_bf16 v[80:95], v[48:51], a[200:203], v[80:95]
    ds_read_b64_tr_b16 v[46:47], v216 offset:39744
    v_add_f32 v158, 1.0, v158
    v_add_f32 v159, 1.0, v159
    v_rcp_f32 v152, v152
    v_mfma_f32_32x32x16_bf16 v[64:79], v[52:55], a[60:63], v[64:79]
    s_add_u32 m0, s53, 36864
    ds_read_b64_tr_b16 v[48:49], v222 offset:0
    buffer_load_dwordx4 v209, s[36:39], s52 offen lds
    v_mfma_f32_32x32x16_bf16 v[80:95], v[52:55], a[204:207], v[80:95]
    ds_read_b64_tr_b16 v[50:51], v222 offset:576
    v_rcp_f32 v153, v153
    v_rcp_f32 v154, v154
    v_rcp_f32 v155, v155
    s_waitcnt lgkmcnt(2)
    v_mfma_f32_32x32x16_bf16 v[64:79], v[40:43], a[64:67], v[64:79]
    ds_read_b64_tr_b16 v[52:53], v222 offset:2304
    v_rcp_f32 v156, v156
    v_rcp_f32 v157, v157
    v_mfma_f32_32x32x16_bf16 v[80:95], v[40:43], a[208:211], v[80:95]
    ds_read_b64_tr_b16 v[54:55], v222 offset:2880
    v_rcp_f32 v158, v158
    v_rcp_f32 v159, v159
    s_lshl_b32 s47, s58, 10
    v_mfma_f32_32x32x16_bf16 v[64:79], v[44:47], a[68:71], v[64:79]
    ds_read_b64_tr_b16 v[40:41], v222 offset:4608
    s_add_u32 s47, s47, s57
    v_mul_f32 v160, v160, v152
    v_mfma_f32_32x32x16_bf16 v[80:95], v[44:47], a[212:215], v[80:95]
    ds_read_b64_tr_b16 v[42:43], v222 offset:5184
    v_mul_f32 v161, v161, v153
    v_mul_f32 v162, v162, v154
    v_mul_f32 v163, v163, v155
    s_waitcnt lgkmcnt(2)
    v_mfma_f32_32x32x16_bf16 v[64:79], v[48:51], a[72:75], v[64:79]
    s_add_u32 s52, s52, 589824
    s_add_u32 s53, s53, 4096
    s_add_u32 m0, s53, 0
    ds_read_b64_tr_b16 v[44:45], v222 offset:6912
    buffer_load_dwordx4 v208, s[32:35], s52 offen lds
    v_mfma_f32_32x32x16_bf16 v[80:95], v[48:51], a[216:219], v[80:95]
    ds_read_b64_tr_b16 v[46:47], v222 offset:7488
    v_mul_f32 v164, v164, v156
    v_mul_f32 v165, v165, v157
    v_mfma_f32_32x32x16_bf16 v[64:79], v[52:55], a[76:79], v[64:79]
    ds_read_b64_tr_b16 v[48:49], v222 offset:9216
    v_mul_f32 v166, v166, v158
    v_mul_f32 v167, v167, v159
    v_cvt_pk_bf16_f32 v168, v160, v161
    v_mfma_f32_32x32x16_bf16 v[80:95], v[52:55], a[220:223], v[80:95]
    ds_read_b64_tr_b16 v[50:51], v222 offset:9792
    v_cvt_pk_bf16_f32 v169, v162, v163
    v_cvt_pk_bf16_f32 v170, v164, v165
    s_waitcnt lgkmcnt(2)
    v_mfma_f32_32x32x16_bf16 v[64:79], v[40:43], a[80:83], v[64:79]
    ds_read_b64_tr_b16 v[52:53], v222 offset:11520
    v_cvt_pk_bf16_f32 v171, v166, v167
    buffer_store_dwordx4 v[168:171], v2, s[24:27], s47 offen sc1
    s_add_u32 s58, s58, 1
    v_mfma_f32_32x32x16_bf16 v[80:95], v[40:43], a[224:227], v[80:95]
    ds_read_b64_tr_b16 v[54:55], v222 offset:12096
    v_mul_f32 v128, s59, v176
    v_mul_f32 v129, s59, v177
    v_mfma_f32_32x32x16_bf16 v[64:79], v[44:47], a[84:87], v[64:79]
    s_add_u32 m0, s53, 36864
    ds_read_b64_tr_b16 v[40:41], v222 offset:13824
    buffer_load_dwordx4 v209, s[36:39], s52 offen lds
    v_mfma_f32_32x32x16_bf16 v[80:95], v[44:47], a[228:231], v[80:95]
    ds_read_b64_tr_b16 v[42:43], v222 offset:14400
    v_mul_f32 v130, s59, v178
    v_mul_f32 v131, s59, v179
    v_mul_f32 v132, s59, v180
    s_waitcnt lgkmcnt(2)
    v_mfma_f32_32x32x16_bf16 v[64:79], v[48:51], a[88:91], v[64:79]
    ds_read_b64_tr_b16 v[44:45], v222 offset:16128
    v_mul_f32 v133, s59, v181
    v_mul_f32 v134, s59, v182
    v_mul_f32 v135, s59, v183
    v_mfma_f32_32x32x16_bf16 v[80:95], v[48:51], a[232:235], v[80:95]
    ds_read_b64_tr_b16 v[46:47], v222 offset:16704
    v_exp_f32 v128, v128
    v_exp_f32 v129, v129
    v_mfma_f32_32x32x16_bf16 v[64:79], v[52:55], a[92:95], v[64:79]
    ds_read_b64_tr_b16 v[48:49], v222 offset:18432
    v_exp_f32 v130, v130
    v_exp_f32 v131, v131
    v_exp_f32 v132, v132
    v_mfma_f32_32x32x16_bf16 v[80:95], v[52:55], a[236:239], v[80:95]
    ds_read_b64_tr_b16 v[50:51], v222 offset:19008
    v_exp_f32 v133, v133
    v_exp_f32 v134, v134
    s_waitcnt lgkmcnt(2)
    v_mfma_f32_32x32x16_bf16 v[64:79], v[40:43], a[96:99], v[64:79]
    s_add_u32 s52, s52, 589824
    s_add_u32 s53, s53, 4096
    s_add_u32 m0, s53, 0
    ds_read_b64_tr_b16 v[52:53], v222 offset:20736
    buffer_load_dwordx4 v208, s[32:35], s52 offen lds
    v_mfma_f32_32x32x16_bf16 v[80:95], v[40:43], a[240:243], v[80:95]
    ds_read_b64_tr_b16 v[54:55], v222 offset:21312
    v_exp_f32 v135, v135
    v_mul_f32 v136, v176, v184
    v_mul_f32 v137, v177, v185
    v_mfma_f32_32x32x16_bf16 v[64:79], v[44:47], a[100:103], v[64:79]
    ds_read_b64_tr_b16 v[40:41], v222 offset:23040
    v_mul_f32 v138, v178, v186
    v_mul_f32 v139, v179, v187
    v_mfma_f32_32x32x16_bf16 v[80:95], v[44:47], a[244:247], v[80:95]
    ds_read_b64_tr_b16 v[42:43], v222 offset:23616
    v_mul_f32 v140, v180, v188
    v_mul_f32 v141, v181, v189
    v_mul_f32 v142, v182, v190
    s_waitcnt lgkmcnt(2)
    v_mfma_f32_32x32x16_bf16 v[64:79], v[48:51], a[104:107], v[64:79]
    ds_read_b64_tr_b16 v[44:45], v222 offset:25344
    v_mul_f32 v143, v183, v191
    v_add_f32 v128, 1.0, v128
    v_mfma_f32_32x32x16_bf16 v[80:95], v[48:51], a[248:251], v[80:95]
    ds_read_b64_tr_b16 v[46:47], v222 offset:25920
    v_add_f32 v129, 1.0, v129
    v_add_f32 v130, 1.0, v130
    v_add_f32 v131, 1.0, v131
    v_mfma_f32_32x32x16_bf16 v[64:79], v[52:55], a[108:111], v[64:79]
    s_add_u32 m0, s53, 36864
    ds_read_b64_tr_b16 v[48:49], v222 offset:27648
    buffer_load_dwordx4 v209, s[36:39], s52 offen lds
    v_mfma_f32_32x32x16_bf16 v[80:95], v[52:55], a[252:255], v[80:95]
    ds_read_b64_tr_b16 v[50:51], v222 offset:28224
    v_add_f32 v132, 1.0, v132
    v_add_f32 v133, 1.0, v133
    s_waitcnt lgkmcnt(2)
    v_mfma_f32_32x32x16_bf16 v[64:79], v[40:43], a[112:115], v[64:79]
    ds_read_b64_tr_b16 v[52:53], v222 offset:29952
    v_add_f32 v134, 1.0, v134
    v_add_f32 v135, 1.0, v135
    v_rcp_f32 v128, v128
    v_mfma_f32_32x32x16_bf16 v[80:95], v[40:43], v[224:227], v[80:95]
    ds_read_b64_tr_b16 v[54:55], v222 offset:30528
    v_rcp_f32 v129, v129
    v_rcp_f32 v130, v130
    v_rcp_f32 v131, v131
    v_mfma_f32_32x32x16_bf16 v[64:79], v[44:47], a[116:119], v[64:79]
    ds_read_b64_tr_b16 v[40:41], v222 offset:32256
    v_rcp_f32 v132, v132
    v_rcp_f32 v133, v133
    v_mfma_f32_32x32x16_bf16 v[80:95], v[44:47], v[228:231], v[80:95]
    ds_read_b64_tr_b16 v[42:43], v222 offset:32832
    v_rcp_f32 v134, v134
    v_rcp_f32 v135, v135
    s_lshl_b32 s46, s58, 10
    s_waitcnt lgkmcnt(2)
    v_mfma_f32_32x32x16_bf16 v[64:79], v[48:51], a[120:123], v[64:79]
    s_add_u32 s52, s52, 589824
    s_add_u32 s53, s53, 4096
    s_add_u32 m0, s53, 0
    ds_read_b64_tr_b16 v[44:45], v222 offset:34560
    buffer_load_dwordx4 v208, s[32:35], s52 offen lds
    v_mfma_f32_32x32x16_bf16 v[80:95], v[48:51], v[232:235], v[80:95]
    ds_read_b64_tr_b16 v[46:47], v222 offset:35136
    s_add_u32 s46, s46, s56
    v_mul_f32 v136, v136, v128
    v_mfma_f32_32x32x16_bf16 v[64:79], v[52:55], a[124:127], v[64:79]
    ds_read_b64_tr_b16 v[48:49], v222 offset:36864
    v_mul_f32 v137, v137, v129
    v_mul_f32 v138, v138, v130
    v_mul_f32 v139, v139, v131
    v_mfma_f32_32x32x16_bf16 v[80:95], v[52:55], v[236:239], v[80:95]
    ds_read_b64_tr_b16 v[50:51], v222 offset:37440
    v_mul_f32 v140, v140, v132
    v_mul_f32 v141, v141, v133
    s_waitcnt lgkmcnt(2)
    v_mfma_f32_32x32x16_bf16 v[64:79], v[40:43], a[128:131], v[64:79]
    ds_read_b64_tr_b16 v[52:53], v222 offset:39168
    v_mul_f32 v142, v142, v134
    v_mul_f32 v143, v143, v135
    v_cvt_pk_bf16_f32 v144, v136, v137
    v_mfma_f32_32x32x16_bf16 v[80:95], v[40:43], v[240:243], v[80:95]
    ds_read_b64_tr_b16 v[54:55], v222 offset:39744
    v_cvt_pk_bf16_f32 v145, v138, v139
    v_cvt_pk_bf16_f32 v146, v140, v141
    v_mfma_f32_32x32x16_bf16 v[64:79], v[44:47], a[132:135], v[64:79]
    s_add_u32 m0, s53, 36864
    ds_read_b64_tr_b16 v[40:41], v217 offset:0
    buffer_load_dwordx4 v209, s[36:39], s52 offen lds
    v_mfma_f32_32x32x16_bf16 v[80:95], v[44:47], v[244:247], v[80:95]
    ds_read_b64_tr_b16 v[42:43], v217 offset:576
    v_cvt_pk_bf16_f32 v147, v142, v143
    buffer_store_dwordx4 v[144:147], v2, s[24:27], s46 offen sc1
    v_mul_f32 v152, s59, v192
    s_waitcnt lgkmcnt(2)
    v_mfma_f32_32x32x16_bf16 v[64:79], v[48:51], a[136:139], v[64:79]
    ds_read_b64_tr_b16 v[44:45], v217 offset:2304
    v_mul_f32 v153, s59, v193
    v_mul_f32 v154, s59, v194
    v_mfma_f32_32x32x16_bf16 v[80:95], v[48:51], v[248:251], v[80:95]
    ds_read_b64_tr_b16 v[46:47], v217 offset:2880
    v_mfma_f32_32x32x16_bf16 v[64:79], v[52:55], a[140:143], v[64:79]
    ds_read_b64_tr_b16 v[48:49], v217 offset:4608
    v_mfma_f32_32x32x16_bf16 v[80:95], v[52:55], v[252:255], v[80:95]
    ds_read_b64_tr_b16 v[50:51], v217 offset:5184
    v_add_u32 v216, 83968, v214
    s_waitcnt lgkmcnt(2)
    v_mfma_f32_32x32x16_bf16 v[96:111], a[0:3], v[40:43], 0
    s_add_u32 s52, s52, 589824
    s_add_u32 s53, s53, 4096
    s_add_u32 m0, s53, 0
    ds_read_b64_tr_b16 v[52:53], v217 offset:6912
    buffer_load_dwordx4 v208, s[32:35], s52 offen lds
    v_mfma_f32_32x32x16_bf16 v[112:127], a[144:147], v[40:43], 0
    ds_read_b64_tr_b16 v[54:55], v217 offset:7488
    v_mfma_f32_32x32x16_bf16 v[96:111], a[4:7], v[44:47], v[96:111]
    ds_read_b64_tr_b16 v[40:41], v217 offset:9216
    v_mfma_f32_32x32x16_bf16 v[112:127], a[148:151], v[44:47], v[112:127]
    ds_read_b64_tr_b16 v[42:43], v217 offset:9792
    v_mul_f32 v155, s59, v195
    v_mul_f32 v156, s59, v196
    v_mul_f32 v157, s59, v197
    s_waitcnt lgkmcnt(2)
    v_mfma_f32_32x32x16_bf16 v[96:111], a[8:11], v[48:51], v[96:111]
    ds_read_b64_tr_b16 v[44:45], v217 offset:11520
    v_mul_f32 v158, s59, v198
    v_mul_f32 v159, s59, v199
    v_mfma_f32_32x32x16_bf16 v[112:127], a[152:155], v[48:51], v[112:127]
    ds_read_b64_tr_b16 v[46:47], v217 offset:12096
    v_exp_f32 v152, v152
    v_exp_f32 v153, v153
    v_mfma_f32_32x32x16_bf16 v[96:111], a[12:15], v[52:55], v[96:111]
    s_add_u32 m0, s53, 36864
    ds_read_b64_tr_b16 v[48:49], v217 offset:13824
    buffer_load_dwordx4 v209, s[36:39], s52 offen lds
    v_mfma_f32_32x32x16_bf16 v[112:127], a[156:159], v[52:55], v[112:127]
    ds_read_b64_tr_b16 v[50:51], v217 offset:14400
    v_exp_f32 v154, v154
    v_exp_f32 v155, v155
    v_exp_f32 v156, v156
    s_waitcnt lgkmcnt(2)
    v_mfma_f32_32x32x16_bf16 v[96:111], a[16:19], v[40:43], v[96:111]
    ds_read_b64_tr_b16 v[52:53], v217 offset:16128
    v_exp_f32 v157, v157
    v_exp_f32 v158, v158
    v_mfma_f32_32x32x16_bf16 v[112:127], a[160:163], v[40:43], v[112:127]
    ds_read_b64_tr_b16 v[54:55], v217 offset:16704
    v_exp_f32 v159, v159
    v_mul_f32 v160, v192, v200
    v_mfma_f32_32x32x16_bf16 v[96:111], a[20:23], v[44:47], v[96:111]
    ds_read_b64_tr_b16 v[40:41], v217 offset:18432
    v_mul_f32 v161, v193, v201
    v_mul_f32 v162, v194, v202
    v_mul_f32 v163, v195, v203
    v_mfma_f32_32x32x16_bf16 v[112:127], a[164:167], v[44:47], v[112:127]
    ds_read_b64_tr_b16 v[42:43], v217 offset:19008
    v_mul_f32 v164, v196, v204
    v_mul_f32 v165, v197, v205
    s_waitcnt lgkmcnt(2)
    v_mfma_f32_32x32x16_bf16 v[96:111], a[24:27], v[48:51], v[96:111]
    s_add_u32 s52, s52, 589824
    s_add_u32 s53, s53, 4096
    s_add_u32 m0, s53, 0
    ds_read_b64_tr_b16 v[44:45], v217 offset:20736
    buffer_load_dwordx4 v208, s[32:35], s52 offen lds
    v_mfma_f32_32x32x16_bf16 v[112:127], a[168:171], v[48:51], v[112:127]
    ds_read_b64_tr_b16 v[46:47], v217 offset:21312
    v_mul_f32 v166, v198, v206
    v_mul_f32 v167, v199, v207
    v_mfma_f32_32x32x16_bf16 v[96:111], a[28:31], v[52:55], v[96:111]
    ds_read_b64_tr_b16 v[48:49], v217 offset:23040
    v_add_f32 v152, 1.0, v152
    v_add_f32 v153, 1.0, v153
    v_mfma_f32_32x32x16_bf16 v[112:127], a[172:175], v[52:55], v[112:127]
    ds_read_b64_tr_b16 v[50:51], v217 offset:23616
    v_add_f32 v154, 1.0, v154
    v_add_f32 v155, 1.0, v155
    v_add_f32 v156, 1.0, v156
    s_waitcnt lgkmcnt(2)
    v_mfma_f32_32x32x16_bf16 v[96:111], a[32:35], v[40:43], v[96:111]
    ds_read_b64_tr_b16 v[52:53], v217 offset:25344
    v_add_f32 v157, 1.0, v157
    v_add_f32 v158, 1.0, v158
    v_mfma_f32_32x32x16_bf16 v[112:127], a[176:179], v[40:43], v[112:127]
    ds_read_b64_tr_b16 v[54:55], v217 offset:25920
    v_add_f32 v159, 1.0, v159
    v_rcp_f32 v152, v152
    v_mfma_f32_32x32x16_bf16 v[96:111], a[36:39], v[44:47], v[96:111]
    s_add_u32 m0, s53, 36864
    ds_read_b64_tr_b16 v[40:41], v217 offset:27648
    buffer_load_dwordx4 v209, s[36:39], s52 offen lds
    v_mfma_f32_32x32x16_bf16 v[112:127], a[180:183], v[44:47], v[112:127]
    ds_read_b64_tr_b16 v[42:43], v217 offset:28224
    v_rcp_f32 v153, v153
    v_rcp_f32 v154, v154
    v_rcp_f32 v155, v155
    s_waitcnt lgkmcnt(2)
    v_mfma_f32_32x32x16_bf16 v[96:111], a[40:43], v[48:51], v[96:111]
    ds_read_b64_tr_b16 v[44:45], v217 offset:29952
    v_rcp_f32 v156, v156
    v_rcp_f32 v157, v157
    v_mfma_f32_32x32x16_bf16 v[112:127], a[184:187], v[48:51], v[112:127]
    ds_read_b64_tr_b16 v[46:47], v217 offset:30528
    v_rcp_f32 v158, v158
    v_rcp_f32 v159, v159
    v_mfma_f32_32x32x16_bf16 v[96:111], a[44:47], v[52:55], v[96:111]
    ds_read_b64_tr_b16 v[48:49], v217 offset:32256
    s_lshl_b32 s47, s58, 10
    s_add_u32 s47, s47, s57
    v_mul_f32 v160, v160, v152
    v_mfma_f32_32x32x16_bf16 v[112:127], a[188:191], v[52:55], v[112:127]
    ds_read_b64_tr_b16 v[50:51], v217 offset:32832
    v_mul_f32 v161, v161, v153
    v_mul_f32 v162, v162, v154
    s_waitcnt lgkmcnt(2)
    v_mfma_f32_32x32x16_bf16 v[96:111], a[48:51], v[40:43], v[96:111]
    s_add_u32 s52, s52, 589824
    s_add_u32 s53, s53, 4096
    s_add_u32 m0, s53, 0
    ds_read_b64_tr_b16 v[52:53], v217 offset:34560
    buffer_load_dwordx4 v208, s[32:35], s52 offen lds
    v_mfma_f32_32x32x16_bf16 v[112:127], a[192:195], v[40:43], v[112:127]
    ds_read_b64_tr_b16 v[54:55], v217 offset:35136
    v_mul_f32 v163, v163, v155
    v_mul_f32 v164, v164, v156
    v_mfma_f32_32x32x16_bf16 v[96:111], a[52:55], v[44:47], v[96:111]
    ds_read_b64_tr_b16 v[40:41], v217 offset:36864
    v_mul_f32 v165, v165, v157
    v_mul_f32 v166, v166, v158
    v_mfma_f32_32x32x16_bf16 v[112:127], a[196:199], v[44:47], v[112:127]
    ds_read_b64_tr_b16 v[42:43], v217 offset:37440
    v_mul_f32 v167, v167, v159
    v_cvt_pk_bf16_f32 v168, v160, v161
    v_cvt_pk_bf16_f32 v169, v162, v163
    s_waitcnt lgkmcnt(2)
    v_mfma_f32_32x32x16_bf16 v[96:111], a[56:59], v[48:51], v[96:111]
    ds_read_b64_tr_b16 v[44:45], v217 offset:39168
    v_cvt_pk_bf16_f32 v170, v164, v165
    v_cvt_pk_bf16_f32 v171, v166, v167
    v_mfma_f32_32x32x16_bf16 v[112:127], a[200:203], v[48:51], v[112:127]
    ds_read_b64_tr_b16 v[46:47], v217 offset:39744
    buffer_store_dwordx4 v[168:171], v2, s[24:27], s47 offen sc1
    s_add_u32 s58, s58, 1
    v_mfma_f32_32x32x16_bf16 v[96:111], a[60:63], v[52:55], v[96:111]
    s_add_u32 m0, s53, 36864
    ds_read_b64_tr_b16 v[48:49], v223 offset:0
    buffer_load_dwordx4 v209, s[36:39], s52 offen lds
    v_mfma_f32_32x32x16_bf16 v[112:127], a[204:207], v[52:55], v[112:127]
    ds_read_b64_tr_b16 v[50:51], v223 offset:576
    v_mul_f32 v128, s59, v8
    v_mul_f32 v129, s59, v9
    v_mul_f32 v130, s59, v10
    s_waitcnt lgkmcnt(2)
    v_mfma_f32_32x32x16_bf16 v[96:111], a[64:67], v[40:43], v[96:111]
    ds_read_b64_tr_b16 v[52:53], v223 offset:2304
    v_mul_f32 v131, s59, v11
    v_mul_f32 v132, s59, v12
    v_mfma_f32_32x32x16_bf16 v[112:127], a[208:211], v[40:43], v[112:127]
    ds_read_b64_tr_b16 v[54:55], v223 offset:2880
    v_mul_f32 v133, s59, v13
    v_mul_f32 v134, s59, v14
    v_mfma_f32_32x32x16_bf16 v[96:111], a[68:71], v[44:47], v[96:111]
    ds_read_b64_tr_b16 v[40:41], v223 offset:4608
    v_mul_f32 v135, s59, v15
    v_exp_f32 v128, v128
    v_mfma_f32_32x32x16_bf16 v[112:127], a[212:215], v[44:47], v[112:127]
    ds_read_b64_tr_b16 v[42:43], v223 offset:5184
    v_exp_f32 v129, v129
    v_exp_f32 v130, v130
    v_exp_f32 v131, v131
    s_waitcnt lgkmcnt(2)
    v_mfma_f32_32x32x16_bf16 v[96:111], a[72:75], v[48:51], v[96:111]
    ds_read_b64_tr_b16 v[44:45], v223 offset:6912
    v_exp_f32 v132, v132
    v_exp_f32 v133, v133
    v_mfma_f32_32x32x16_bf16 v[112:127], a[216:219], v[48:51], v[112:127]
    ds_read_b64_tr_b16 v[46:47], v223 offset:7488
    v_exp_f32 v134, v134
    v_exp_f32 v135, v135
    v_mfma_f32_32x32x16_bf16 v[96:111], a[76:79], v[52:55], v[96:111]
    ds_read_b64_tr_b16 v[48:49], v223 offset:9216
    v_mul_f32 v136, v8, v16
    v_mul_f32 v137, v9, v17
    v_mul_f32 v138, v10, v18
    v_mfma_f32_32x32x16_bf16 v[112:127], a[220:223], v[52:55], v[112:127]
    ds_read_b64_tr_b16 v[50:51], v223 offset:9792
    v_mul_f32 v139, v11, v19
    v_mul_f32 v140, v12, v20
    s_waitcnt lgkmcnt(2)
    v_mfma_f32_32x32x16_bf16 v[96:111], a[80:83], v[40:43], v[96:111]
    ds_read_b64_tr_b16 v[52:53], v223 offset:11520
    v_mul_f32 v141, v13, v21
    v_mul_f32 v142, v14, v22
    v_mfma_f32_32x32x16_bf16 v[112:127], a[224:227], v[40:43], v[112:127]
    ds_read_b64_tr_b16 v[54:55], v223 offset:12096
    v_mul_f32 v143, v15, v23
    v_add_f32 v128, 1.0, v128
    v_add_f32 v129, 1.0, v129
    v_mfma_f32_32x32x16_bf16 v[96:111], a[84:87], v[44:47], v[96:111]
    ds_read_b64_tr_b16 v[40:41], v223 offset:13824
    v_add_f32 v130, 1.0, v130
    v_add_f32 v131, 1.0, v131
    v_mfma_f32_32x32x16_bf16 v[112:127], a[228:231], v[44:47], v[112:127]
    ds_read_b64_tr_b16 v[42:43], v223 offset:14400
    v_add_f32 v132, 1.0, v132
    v_add_f32 v133, 1.0, v133
    s_waitcnt lgkmcnt(2)
    v_mfma_f32_32x32x16_bf16 v[96:111], a[88:91], v[48:51], v[96:111]
    ds_read_b64_tr_b16 v[44:45], v223 offset:16128
    v_add_f32 v134, 1.0, v134
    v_add_f32 v135, 1.0, v135
    v_mfma_f32_32x32x16_bf16 v[112:127], a[232:235], v[48:51], v[112:127]
    ds_read_b64_tr_b16 v[46:47], v223 offset:16704
    v_rcp_f32 v128, v128
    v_rcp_f32 v129, v129
    v_rcp_f32 v130, v130
    v_mfma_f32_32x32x16_bf16 v[96:111], a[92:95], v[52:55], v[96:111]
    ds_read_b64_tr_b16 v[48:49], v223 offset:18432
    v_rcp_f32 v131, v131
    v_rcp_f32 v132, v132
    v_mfma_f32_32x32x16_bf16 v[112:127], a[236:239], v[52:55], v[112:127]
    ds_read_b64_tr_b16 v[50:51], v223 offset:19008
    v_rcp_f32 v133, v133
    v_rcp_f32 v134, v134
    s_waitcnt lgkmcnt(2)
    v_mfma_f32_32x32x16_bf16 v[96:111], a[96:99], v[40:43], v[96:111]
    ds_read_b64_tr_b16 v[52:53], v223 offset:20736
    v_rcp_f32 v135, v135
    s_lshl_b32 s46, s58, 10
    s_add_u32 s46, s46, s56
    v_mfma_f32_32x32x16_bf16 v[112:127], a[240:243], v[40:43], v[112:127]
    ds_read_b64_tr_b16 v[54:55], v223 offset:21312
    v_mul_f32 v136, v136, v128
    v_mul_f32 v137, v137, v129
    v_mfma_f32_32x32x16_bf16 v[96:111], a[100:103], v[44:47], v[96:111]
    ds_read_b64_tr_b16 v[40:41], v223 offset:23040
    v_mul_f32 v138, v138, v130
    v_mul_f32 v139, v139, v131
    v_mfma_f32_32x32x16_bf16 v[112:127], a[244:247], v[44:47], v[112:127]
    ds_read_b64_tr_b16 v[42:43], v223 offset:23616
    v_mul_f32 v140, v140, v132
    v_mul_f32 v141, v141, v133
    s_waitcnt lgkmcnt(2)
    v_mfma_f32_32x32x16_bf16 v[96:111], a[104:107], v[48:51], v[96:111]
    ds_read_b64_tr_b16 v[44:45], v223 offset:25344
    v_mul_f32 v142, v142, v134
    v_mul_f32 v143, v143, v135
    v_cvt_pk_bf16_f32 v144, v136, v137
    v_mfma_f32_32x32x16_bf16 v[112:127], a[248:251], v[48:51], v[112:127]
    ds_read_b64_tr_b16 v[46:47], v223 offset:25920
    v_cvt_pk_bf16_f32 v145, v138, v139
    v_cvt_pk_bf16_f32 v146, v140, v141
    v_mfma_f32_32x32x16_bf16 v[96:111], a[108:111], v[52:55], v[96:111]
    ds_read_b64_tr_b16 v[48:49], v223 offset:27648
    v_cvt_pk_bf16_f32 v147, v142, v143
    buffer_store_dwordx4 v[144:147], v2, s[24:27], s46 offen sc1
    v_mfma_f32_32x32x16_bf16 v[112:127], a[252:255], v[52:55], v[112:127]
    ds_read_b64_tr_b16 v[50:51], v223 offset:28224
    v_mul_f32 v152, s59, v24
    v_mul_f32 v153, s59, v25
    v_mul_f32 v154, s59, v26
    s_waitcnt lgkmcnt(2)
    v_mfma_f32_32x32x16_bf16 v[96:111], a[112:115], v[40:43], v[96:111]
    ds_read_b64_tr_b16 v[52:53], v223 offset:29952
    v_mul_f32 v155, s59, v27
    v_mul_f32 v156, s59, v28
    v_mfma_f32_32x32x16_bf16 v[112:127], v[224:227], v[40:43], v[112:127]
    ds_read_b64_tr_b16 v[54:55], v223 offset:30528
    v_mul_f32 v157, s59, v29
    v_mul_f32 v158, s59, v30
    v_mfma_f32_32x32x16_bf16 v[96:111], a[116:119], v[44:47], v[96:111]
    ds_read_b64_tr_b16 v[40:41], v223 offset:32256
    v_mul_f32 v159, s59, v31
    v_exp_f32 v152, v152
    v_exp_f32 v153, v153
    v_mfma_f32_32x32x16_bf16 v[112:127], v[228:231], v[44:47], v[112:127]
    ds_read_b64_tr_b16 v[42:43], v223 offset:32832
    v_exp_f32 v154, v154
    v_exp_f32 v155, v155
    s_waitcnt lgkmcnt(2)
    v_mfma_f32_32x32x16_bf16 v[96:111], a[120:123], v[48:51], v[96:111]
    ds_read_b64_tr_b16 v[44:45], v223 offset:34560
    v_exp_f32 v156, v156
    v_exp_f32 v157, v157
    v_mfma_f32_32x32x16_bf16 v[112:127], v[232:235], v[48:51], v[112:127]
    ds_read_b64_tr_b16 v[46:47], v223 offset:35136
    v_exp_f32 v158, v158
    v_exp_f32 v159, v159
    v_mfma_f32_32x32x16_bf16 v[96:111], a[124:127], v[52:55], v[96:111]
    ds_read_b64_tr_b16 v[48:49], v223 offset:36864
    v_mul_f32 v160, v24, v32
    v_mul_f32 v161, v25, v33
    v_mul_f32 v162, v26, v34
    v_mfma_f32_32x32x16_bf16 v[112:127], v[236:239], v[52:55], v[112:127]
    ds_read_b64_tr_b16 v[50:51], v223 offset:37440
    v_mul_f32 v163, v27, v35
    v_mul_f32 v164, v28, v36
    s_waitcnt lgkmcnt(2)
    v_mfma_f32_32x32x16_bf16 v[96:111], a[128:131], v[40:43], v[96:111]
    ds_read_b64_tr_b16 v[52:53], v223 offset:39168
    v_mul_f32 v165, v29, v37
    v_mul_f32 v166, v30, v38
    v_mfma_f32_32x32x16_bf16 v[112:127], v[240:243], v[40:43], v[112:127]
    ds_read_b64_tr_b16 v[54:55], v223 offset:39744
    v_mul_f32 v167, v31, v39
    v_add_f32 v152, 1.0, v152
    v_add_f32 v153, 1.0, v153
    v_mfma_f32_32x32x16_bf16 v[96:111], a[132:135], v[44:47], v[96:111]
    v_add_f32 v154, 1.0, v154
    v_add_f32 v155, 1.0, v155
    v_mfma_f32_32x32x16_bf16 v[112:127], v[244:247], v[44:47], v[112:127]
    v_add_f32 v156, 1.0, v156
    v_add_f32 v157, 1.0, v157
    s_waitcnt lgkmcnt(0)
    v_mfma_f32_32x32x16_bf16 v[96:111], a[136:139], v[48:51], v[96:111]
    v_add_f32 v158, 1.0, v158
    v_add_f32 v159, 1.0, v159
    v_mfma_f32_32x32x16_bf16 v[112:127], v[248:251], v[48:51], v[112:127]
    s_waitcnt vmcnt(1)
    s_barrier
    ds_read_b64_tr_b16 v[40:41], v216 offset:0
    ds_read_b64_tr_b16 v[42:43], v216 offset:256
    ds_read_b64_tr_b16 v[44:45], v216 offset:1024
    ds_read_b64_tr_b16 v[46:47], v216 offset:1280
    ds_read_b64_tr_b16 v[48:49], v216 offset:2048
    ds_read_b64_tr_b16 v[50:51], v216 offset:2304
    v_mfma_f32_32x32x16_bf16 v[96:111], a[140:143], v[52:55], v[96:111]
    v_mfma_f32_32x32x16_bf16 v[112:127], v[252:255], v[52:55], v[112:127]
    v_add_u32 v217, 83968, v215
    s_lshl_b32 s51, s42, 10
    s_add_u32 s61, s61, 64
    s_waitcnt lgkmcnt(2)
    v_mfma_f32_32x32x16_bf16 v[176:191], v[40:43], a[0:3], 0
    s_mul_i32 s52, s42, 147456
    s_add_u32 s52, s52, s61
    s_mov_b32 s53, s51
    s_add_u32 m0, s53, 0
    ds_read_b64_tr_b16 v[52:53], v216 offset:3072
    buffer_load_dwordx4 v208, s[32:35], s52 offen lds
    v_mfma_f32_32x32x16_bf16 v[192:207], v[40:43], a[144:147], 0
    ds_read_b64_tr_b16 v[54:55], v216 offset:3328
    v_mfma_f32_32x32x16_bf16 v[176:191], v[44:47], a[4:7], v[176:191]
    ds_read_b64_tr_b16 v[40:41], v216 offset:4096
    v_mfma_f32_32x32x16_bf16 v[192:207], v[44:47], a[148:151], v[192:207]
    ds_read_b64_tr_b16 v[42:43], v216 offset:4352
    v_rcp_f32 v152, v152
    v_rcp_f32 v153, v153
    v_rcp_f32 v154, v154
    s_waitcnt lgkmcnt(2)
    v_mfma_f32_32x32x16_bf16 v[176:191], v[48:51], a[8:11], v[176:191]
    ds_read_b64_tr_b16 v[44:45], v216 offset:5120
    v_rcp_f32 v155, v155
    v_rcp_f32 v156, v156
    v_rcp_f32 v157, v157
    v_mfma_f32_32x32x16_bf16 v[192:207], v[48:51], a[152:155], v[192:207]
    ds_read_b64_tr_b16 v[46:47], v216 offset:5376
    v_rcp_f32 v158, v158
    v_rcp_f32 v159, v159
    v_mfma_f32_32x32x16_bf16 v[176:191], v[52:55], a[12:15], v[176:191]
    s_add_u32 m0, s53, 36864
    ds_read_b64_tr_b16 v[48:49], v216 offset:6144
    buffer_load_dwordx4 v209, s[36:39], s52 offen lds
    v_mfma_f32_32x32x16_bf16 v[192:207], v[52:55], a[156:159], v[192:207]
    ds_read_b64_tr_b16 v[50:51], v216 offset:6400
    s_lshl_b32 s47, s58, 10
    s_add_u32 s47, s47, s57
    v_mul_f32 v160, v160, v152
    s_waitcnt lgkmcnt(2)
    v_mfma_f32_32x32x16_bf16 v[176:191], v[40:43], a[16:19], v[176:191]
    ds_read_b64_tr_b16 v[52:53], v216 offset:7168
    v_mul_f32 v161, v161, v153
    v_mul_f32 v162, v162, v154
    v_mfma_f32_32x32x16_bf16 v[192:207], v[40:43], a[160:163], v[192:207]
    ds_read_b64_tr_b16 v[54:55], v216 offset:7424
    v_mul_f32 v163, v163, v155
    v_mul_f32 v164, v164, v156
    v_mul_f32 v165, v165, v157
    v_mfma_f32_32x32x16_bf16 v[176:191], v[44:47], a[20:23], v[176:191]
    ds_read_b64_tr_b16 v[40:41], v216 offset:8192
    v_mul_f32 v166, v166, v158
    v_mul_f32 v167, v167, v159
    v_mfma_f32_32x32x16_bf16 v[192:207], v[44:47], a[164:167], v[192:207]
    ds_read_b64_tr_b16 v[42:43], v216 offset:8448
    v_cvt_pk_bf16_f32 v168, v160, v161
    v_cvt_pk_bf16_f32 v169, v162, v163
    v_cvt_pk_bf16_f32 v170, v164, v165
    s_waitcnt lgkmcnt(2)
    v_mfma_f32_32x32x16_bf16 v[176:191], v[48:51], a[24:27], v[176:191]
    s_add_u32 s52, s52, 589824
    s_add_u32 s53, s53, 4096
    s_add_u32 m0, s53, 0
    ds_read_b64_tr_b16 v[44:45], v216 offset:9216
    buffer_load_dwordx4 v208, s[32:35], s52 offen lds
    v_mfma_f32_32x32x16_bf16 v[192:207], v[48:51], a[168:171], v[192:207]
    ds_read_b64_tr_b16 v[46:47], v216 offset:9472
    v_cvt_pk_bf16_f32 v171, v166, v167
    buffer_store_dwordx4 v[168:171], v2, s[24:27], s47 offen sc1
    v_mfma_f32_32x32x16_bf16 v[176:191], v[52:55], a[28:31], v[176:191]
    ds_read_b64_tr_b16 v[48:49], v216 offset:10240
    s_add_u32 s58, s58, 1
    v_mul_f32 v128, s60, v64
    v_mul_f32 v129, s60, v65
    v_mfma_f32_32x32x16_bf16 v[192:207], v[52:55], a[172:175], v[192:207]
    ds_read_b64_tr_b16 v[50:51], v216 offset:10496
    v_mul_f32 v130, s60, v66
    v_mul_f32 v131, s60, v67
    s_waitcnt lgkmcnt(2)
    v_mfma_f32_32x32x16_bf16 v[176:191], v[40:43], a[32:35], v[176:191]
    ds_read_b64_tr_b16 v[52:53], v216 offset:11264
    v_mul_f32 v132, s60, v68
    v_mul_f32 v133, s60, v69
    v_mul_f32 v134, s60, v70
    v_mfma_f32_32x32x16_bf16 v[192:207], v[40:43], a[176:179], v[192:207]
    ds_read_b64_tr_b16 v[54:55], v216 offset:11520
    v_mul_f32 v135, s60, v71
    v_cvt_pk_bf16_f32 v140, v72, v73
    v_cvt_pk_bf16_f32 v141, v74, v75
    v_mfma_f32_32x32x16_bf16 v[176:191], v[44:47], a[36:39], v[176:191]
    s_add_u32 m0, s53, 36864
    ds_read_b64_tr_b16 v[40:41], v216 offset:12288
    buffer_load_dwordx4 v209, s[36:39], s52 offen lds
    v_mfma_f32_32x32x16_bf16 v[192:207], v[44:47], a[180:183], v[192:207]
    ds_read_b64_tr_b16 v[42:43], v216 offset:12544
    v_cvt_pk_bf16_f32 v142, v76, v77
    v_cvt_pk_bf16_f32 v143, v78, v79
    s_waitcnt lgkmcnt(2)
    v_mfma_f32_32x32x16_bf16 v[176:191], v[48:51], a[40:43], v[176:191]
    ds_read_b64_tr_b16 v[44:45], v216 offset:13312
    v_cvt_pk_bf16_f32 v136, v128, v129
    v_cvt_pk_bf16_f32 v137, v130, v131
    v_cvt_pk_bf16_f32 v138, v132, v133
    v_mfma_f32_32x32x16_bf16 v[192:207], v[48:51], a[184:187], v[192:207]
    ds_read_b64_tr_b16 v[46:47], v216 offset:13568
    v_cvt_pk_bf16_f32 v139, v134, v135
    s_lshl_b32 s46, s41, 6
    v_mfma_f32_32x32x16_bf16 v[176:191], v[52:55], a[44:47], v[176:191]
    ds_read_b64_tr_b16 v[48:49], v216 offset:14336
    s_add_u32 s46, s46, s50
    s_lshl_b32 s46, s46, 10
    s_add_u32 s47, s46, 4489216
    v_mfma_f32_32x32x16_bf16 v[192:207], v[52:55], a[188:191], v[192:207]
    ds_read_b64_tr_b16 v[50:51], v216 offset:14592
    s_add_u32 s46, s46, 2392064
    buffer_store_dwordx4 v[140:143], v2, s[24:27], s47 offen sc1
    s_waitcnt lgkmcnt(2)
    v_mfma_f32_32x32x16_bf16 v[176:191], v[40:43], a[48:51], v[176:191]
    s_add_u32 s52, s52, 589824
    s_add_u32 s53, s53, 4096
    s_add_u32 m0, s53, 0
    ds_read_b64_tr_b16 v[52:53], v216 offset:15360
    buffer_load_dwordx4 v208, s[32:35], s52 offen lds
    v_mfma_f32_32x32x16_bf16 v[192:207], v[40:43], a[192:195], v[192:207]
    ds_read_b64_tr_b16 v[54:55], v216 offset:15616
    buffer_store_dwordx4 v[136:139], v2, s[24:27], s46 offen sc1
    v_mul_f32 v152, s60, v80
    v_mul_f32 v153, s60, v81
    v_mfma_f32_32x32x16_bf16 v[176:191], v[44:47], a[52:55], v[176:191]
    ds_read_b64_tr_b16 v[40:41], v216 offset:16384
    v_mul_f32 v154, s60, v82
    v_mul_f32 v155, s60, v83
    v_mfma_f32_32x32x16_bf16 v[192:207], v[44:47], a[196:199], v[192:207]
    ds_read_b64_tr_b16 v[42:43], v216 offset:16640
    v_mul_f32 v156, s60, v84
    v_mul_f32 v157, s60, v85
    v_mul_f32 v158, s60, v86
    s_waitcnt lgkmcnt(2)
    v_mfma_f32_32x32x16_bf16 v[176:191], v[48:51], a[56:59], v[176:191]
    ds_read_b64_tr_b16 v[44:45], v216 offset:17408
    v_mul_f32 v159, s60, v87
    v_cvt_pk_bf16_f32 v164, v88, v89
    v_mfma_f32_32x32x16_bf16 v[192:207], v[48:51], a[200:203], v[192:207]
    ds_read_b64_tr_b16 v[46:47], v216 offset:17664
    v_cvt_pk_bf16_f32 v165, v90, v91
    v_cvt_pk_bf16_f32 v166, v92, v93
    v_cvt_pk_bf16_f32 v167, v94, v95
    v_mfma_f32_32x32x16_bf16 v[176:191], v[52:55], a[60:63], v[176:191]
    s_add_u32 m0, s53, 36864
    ds_read_b64_tr_b16 v[48:49], v216 offset:18432
    buffer_load_dwordx4 v209, s[36:39], s52 offen lds
    v_mfma_f32_32x32x16_bf16 v[192:207], v[52:55], a[204:207], v[192:207]
    ds_read_b64_tr_b16 v[50:51], v216 offset:18688
    v_cvt_pk_bf16_f32 v160, v152, v153
    v_cvt_pk_bf16_f32 v161, v154, v155
    v_cvt_pk_bf16_f32 v162, v156, v157
    s_waitcnt lgkmcnt(2)
    v_mfma_f32_32x32x16_bf16 v[176:191], v[40:43], a[64:67], v[176:191]
    ds_read_b64_tr_b16 v[52:53], v216 offset:19456
    v_cvt_pk_bf16_f32 v163, v158, v159
    s_lshl_b32 s46, s41, 6
    v_mfma_f32_32x32x16_bf16 v[192:207], v[40:43], a[208:211], v[192:207]
    ds_read_b64_tr_b16 v[54:55], v216 offset:19712
    s_add_u32 s46, s46, s50
    s_add_u32 s46, s46, 1
    s_lshl_b32 s46, s46, 10
    v_mfma_f32_32x32x16_bf16 v[176:191], v[44:47], a[68:71], v[176:191]
    ds_read_b64_tr_b16 v[40:41], v216 offset:20480
    s_add_u32 s47, s46, 4489216
    s_add_u32 s46, s46, 2392064
    v_mfma_f32_32x32x16_bf16 v[192:207], v[44:47], a[212:215], v[192:207]
    ds_read_b64_tr_b16 v[42:43], v216 offset:20736
    buffer_store_dwordx4 v[164:167], v2, s[24:27], s47 offen sc1
    buffer_store_dwordx4 v[160:163], v2, s[24:27], s46 offen sc1
    v_fma_f32 v128, v96, v218, v219
    s_waitcnt lgkmcnt(2)
    v_mfma_f32_32x32x16_bf16 v[176:191], v[48:51], a[72:75], v[176:191]
    s_add_u32 s52, s52, 589824
    s_add_u32 s53, s53, 4096
    s_add_u32 m0, s53, 0
    ds_read_b64_tr_b16 v[44:45], v216 offset:21504
    buffer_load_dwordx4 v208, s[32:35], s52 offen lds
    v_mfma_f32_32x32x16_bf16 v[192:207], v[48:51], a[216:219], v[192:207]
    ds_read_b64_tr_b16 v[46:47], v216 offset:21760
    v_fma_f32 v129, v97, v218, v219
    v_fma_f32 v130, v98, v218, v219
    v_mfma_f32_32x32x16_bf16 v[176:191], v[52:55], a[76:79], v[176:191]
    ds_read_b64_tr_b16 v[48:49], v216 offset:22528
    v_fma_f32 v131, v99, v218, v219
    v_fma_f32 v132, v100, v218, v219
    v_fma_f32 v133, v101, v218, v219
    v_mfma_f32_32x32x16_bf16 v[192:207], v[52:55], a[220:223], v[192:207]
    ds_read_b64_tr_b16 v[50:51], v216 offset:22784
    v_fma_f32 v134, v102, v218, v219
    v_fma_f32 v135, v103, v218, v219
    s_waitcnt lgkmcnt(2)
    v_mfma_f32_32x32x16_bf16 v[176:191], v[40:43], a[80:83], v[176:191]
    ds_read_b64_tr_b16 v[52:53], v216 offset:23552
    v_fma_f32 v136, v104, v218, v219
    v_fma_f32 v137, v105, v218, v219
    v_fma_f32 v138, v106, v218, v219
    v_mfma_f32_32x32x16_bf16 v[192:207], v[40:43], a[224:227], v[192:207]
    ds_read_b64_tr_b16 v[54:55], v216 offset:23808
    v_fma_f32 v139, v107, v218, v219
    v_fma_f32 v140, v108, v218, v219
    v_mfma_f32_32x32x16_bf16 v[176:191], v[44:47], a[84:87], v[176:191]
    s_add_u32 m0, s53, 36864
    ds_read_b64_tr_b16 v[40:41], v216 offset:24576
    buffer_load_dwordx4 v209, s[36:39], s52 offen lds
    v_mfma_f32_32x32x16_bf16 v[192:207], v[44:47], a[228:231], v[192:207]
    ds_read_b64_tr_b16 v[42:43], v216 offset:24832
    v_fma_f32 v141, v109, v218, v219
    v_fma_f32 v142, v110, v218, v219
    v_fma_f32 v143, v111, v218, v219
    s_waitcnt lgkmcnt(2)
    v_mfma_f32_32x32x16_bf16 v[176:191], v[48:51], a[88:91], v[176:191]
    ds_read_b64_tr_b16 v[44:45], v216 offset:25600
    v_cvt_pk_bf16_f32 v160, v128, v129
    v_cvt_pk_bf16_f32 v161, v130, v131
    v_cvt_pk_bf16_f32 v162, v132, v133
    v_mfma_f32_32x32x16_bf16 v[192:207], v[48:51], a[232:235], v[192:207]
    ds_read_b64_tr_b16 v[46:47], v216 offset:25856
    v_cvt_pk_bf16_f32 v163, v134, v135
    v_cvt_pk_bf16_f32 v164, v136, v137
    v_mfma_f32_32x32x16_bf16 v[176:191], v[52:55], a[92:95], v[176:191]
    ds_read_b64_tr_b16 v[48:49], v216 offset:26624
    v_cvt_pk_bf16_f32 v165, v138, v139
    v_cvt_pk_bf16_f32 v166, v140, v141
    v_cvt_pk_bf16_f32 v167, v142, v143
    v_mfma_f32_32x32x16_bf16 v[192:207], v[52:55], a[236:239], v[192:207]
    ds_read_b64_tr_b16 v[50:51], v216 offset:26880
    s_mul_i32 s46, s41, 81920
    s_add_u32 s47, s50, 0
    s_waitcnt lgkmcnt(2)
    v_mfma_f32_32x32x16_bf16 v[176:191], v[40:43], a[96:99], v[176:191]
    s_add_u32 s52, s52, 589824
    s_add_u32 s53, s53, 4096
    s_add_u32 m0, s53, 0
    ds_read_b64_tr_b16 v[52:53], v216 offset:27648
    buffer_load_dwordx4 v208, s[32:35], s52 offen lds
    v_mfma_f32_32x32x16_bf16 v[192:207], v[40:43], a[240:243], v[192:207]
    ds_read_b64_tr_b16 v[54:55], v216 offset:27904
    s_mul_i32 s47, s47, 1280
    s_add_u32 s46, s46, s47
    s_add_u32 s46, s46, 7110656
    v_mfma_f32_32x32x16_bf16 v[176:191], v[44:47], a[100:103], v[176:191]
    ds_read_b64_tr_b16 v[40:41], v216 offset:28672
    buffer_store_dwordx4 v[160:163], v220, s[24:27], s46 offen sc1
    buffer_store_dwordx4 v[164:167], v220, s[24:27], s46 offen offset:640 sc1
    v_mfma_f32_32x32x16_bf16 v[192:207], v[44:47], a[244:247], v[192:207]
    ds_read_b64_tr_b16 v[42:43], v216 offset:28928
    v_mov_b32_dpp v144, v128 row_shl:1 row_mask:0xf bank_mask:0xf bound_ctrl:0
    v_mov_b32_dpp v145, v129 row_shl:1 row_mask:0xf bank_mask:0xf bound_ctrl:0
    v_mov_b32_dpp v146, v130 row_shl:1 row_mask:0xf bank_mask:0xf bound_ctrl:0
    s_waitcnt lgkmcnt(2)
    v_mfma_f32_32x32x16_bf16 v[176:191], v[48:51], a[104:107], v[176:191]
    ds_read_b64_tr_b16 v[44:45], v216 offset:29696
    v_mov_b32_dpp v147, v131 row_shl:1 row_mask:0xf bank_mask:0xf bound_ctrl:0
    v_mov_b32_dpp v148, v132 row_shl:1 row_mask:0xf bank_mask:0xf bound_ctrl:0
    v_mfma_f32_32x32x16_bf16 v[192:207], v[48:51], a[248:251], v[192:207]
    ds_read_b64_tr_b16 v[46:47], v216 offset:29952
    v_mov_b32_dpp v149, v133 row_shl:1 row_mask:0xf bank_mask:0xf bound_ctrl:0
    v_mov_b32_dpp v150, v134 row_shl:1 row_mask:0xf bank_mask:0xf bound_ctrl:0
    v_mov_b32_dpp v151, v135 row_shl:1 row_mask:0xf bank_mask:0xf bound_ctrl:0
    v_mfma_f32_32x32x16_bf16 v[176:191], v[52:55], a[108:111], v[176:191]
    s_add_u32 m0, s53, 36864
    ds_read_b64_tr_b16 v[48:49], v216 offset:30720
    buffer_load_dwordx4 v209, s[36:39], s52 offen lds
    v_mfma_f32_32x32x16_bf16 v[192:207], v[52:55], a[252:255], v[192:207]
    ds_read_b64_tr_b16 v[50:51], v216 offset:30976
    v_mov_b32_dpp v152, v136 row_shl:1 row_mask:0xf bank_mask:0xf bound_ctrl:0
    v_mov_b32_dpp v153, v137 row_shl:1 row_mask:0xf bank_mask:0xf bound_ctrl:0
    s_waitcnt lgkmcnt(2)
    v_mfma_f32_32x32x16_bf16 v[176:191], v[40:43], a[112:115], v[176:191]
    ds_read_b64_tr_b16 v[52:53], v216 offset:31744
    v_mov_b32_dpp v154, v138 row_shl:1 row_mask:0xf bank_mask:0xf bound_ctrl:0
    v_mov_b32_dpp v155, v139 row_shl:1 row_mask:0xf bank_mask:0xf bound_ctrl:0
    v_mov_b32_dpp v156, v140 row_shl:1 row_mask:0xf bank_mask:0xf bound_ctrl:0
    v_mfma_f32_32x32x16_bf16 v[192:207], v[40:43], v[224:227], v[192:207]
    ds_read_b64_tr_b16 v[54:55], v216 offset:32000
    v_mov_b32_dpp v157, v141 row_shl:1 row_mask:0xf bank_mask:0xf bound_ctrl:0
    v_mov_b32_dpp v158, v142 row_shl:1 row_mask:0xf bank_mask:0xf bound_ctrl:0
    v_mov_b32_dpp v159, v143 row_shl:1 row_mask:0xf bank_mask:0xf bound_ctrl:0
    v_mfma_f32_32x32x16_bf16 v[176:191], v[44:47], a[116:119], v[176:191]
    ds_read_b64_tr_b16 v[40:41], v216 offset:32768
    v_cvt_pk_bf16_f32 v144, v128, v144
    v_cvt_pk_bf16_f32 v145, v129, v145
    v_mfma_f32_32x32x16_bf16 v[192:207], v[44:47], v[228:231], v[192:207]
    ds_read_b64_tr_b16 v[42:43], v216 offset:33024
    v_cvt_pk_bf16_f32 v146, v130, v146
    v_cvt_pk_bf16_f32 v147, v131, v147
    v_cvt_pk_bf16_f32 v148, v132, v148
    s_waitcnt lgkmcnt(2)
    v_mfma_f32_32x32x16_bf16 v[176:191], v[48:51], a[120:123], v[176:191]
    s_add_u32 s52, s52, 589824
    s_add_u32 s53, s53, 4096
    s_add_u32 m0, s53, 0
    ds_read_b64_tr_b16 v[44:45], v216 offset:33792
    buffer_load_dwordx4 v208, s[32:35], s52 offen lds
    v_mfma_f32_32x32x16_bf16 v[192:207], v[48:51], v[232:235], v[192:207]
    ds_read_b64_tr_b16 v[46:47], v216 offset:34048
    v_cvt_pk_bf16_f32 v149, v133, v149
    v_cvt_pk_bf16_f32 v150, v134, v150
    v_mfma_f32_32x32x16_bf16 v[176:191], v[52:55], a[124:127], v[176:191]
    ds_read_b64_tr_b16 v[48:49], v216 offset:34816
    v_cvt_pk_bf16_f32 v151, v135, v151
    v_cvt_pk_bf16_f32 v152, v136, v152
    v_cvt_pk_bf16_f32 v153, v137, v153
    v_mfma_f32_32x32x16_bf16 v[192:207], v[52:55], v[236:239], v[192:207]
    ds_read_b64_tr_b16 v[50:51], v216 offset:35072
    v_cvt_pk_bf16_f32 v154, v138, v154
    v_cvt_pk_bf16_f32 v155, v139, v155
    s_waitcnt lgkmcnt(2)
    v_mfma_f32_32x32x16_bf16 v[176:191], v[40:43], a[128:131], v[176:191]
    ds_read_b64_tr_b16 v[52:53], v216 offset:35840
    v_cvt_pk_bf16_f32 v156, v140, v156
    v_cvt_pk_bf16_f32 v157, v141, v157
    v_cvt_pk_bf16_f32 v158, v142, v158
    v_mfma_f32_32x32x16_bf16 v[192:207], v[40:43], v[240:243], v[192:207]
    ds_read_b64_tr_b16 v[54:55], v216 offset:36096
    v_cvt_pk_bf16_f32 v159, v143, v159
    s_lshl_b32 s46, s41, 13
    v_mfma_f32_32x32x16_bf16 v[176:191], v[44:47], a[132:135], v[176:191]
    s_add_u32 m0, s53, 36864
    ds_read_b64_tr_b16 v[40:41], v217 offset:0
    buffer_load_dwordx4 v209, s[36:39], s52 offen lds
    v_mfma_f32_32x32x16_bf16 v[192:207], v[44:47], v[244:247], v[192:207]
    ds_read_b64_tr_b16 v[42:43], v217 offset:256
    s_add_u32 s47, s50, 0
    s_lshl_b32 s47, s47, 7
    s_add_u32 s46, s46, s47
    s_waitcnt lgkmcnt(2)
    v_mfma_f32_32x32x16_bf16 v[176:191], v[48:51], a[136:139], v[176:191]
    ds_read_b64_tr_b16 v[44:45], v217 offset:1024
    buffer_store_dwordx4 v[144:147], v221, s[24:27], s46 offen offset:0 sc1
    buffer_store_dwordx4 v[148:151], v221, s[24:27], s46 offen offset:32 sc1
    v_mfma_f32_32x32x16_bf16 v[192:207], v[48:51], v[248:251], v[192:207]
    ds_read_b64_tr_b16 v[46:47], v217 offset:1280
    v_mfma_f32_32x32x16_bf16 v[176:191], v[52:55], a[140:143], v[176:191]
    ds_read_b64_tr_b16 v[48:49], v217 offset:2048
    v_mfma_f32_32x32x16_bf16 v[192:207], v[52:55], v[252:255], v[192:207]
    ds_read_b64_tr_b16 v[50:51], v217 offset:2304
    v_mov_b32 v216, v214
    s_waitcnt lgkmcnt(2)
    v_mfma_f32_32x32x16_bf16 v[8:23], v[40:43], a[0:3], 0
    s_add_u32 s52, s52, 589824
    s_add_u32 s53, s53, 4096
    s_add_u32 m0, s53, 0
    ds_read_b64_tr_b16 v[52:53], v217 offset:3072
    buffer_load_dwordx4 v208, s[32:35], s52 offen lds
    v_mfma_f32_32x32x16_bf16 v[24:39], v[40:43], a[144:147], 0
    ds_read_b64_tr_b16 v[54:55], v217 offset:3328
    v_mfma_f32_32x32x16_bf16 v[8:23], v[44:47], a[4:7], v[8:23]
    ds_read_b64_tr_b16 v[40:41], v217 offset:4096
    v_mfma_f32_32x32x16_bf16 v[24:39], v[44:47], a[148:151], v[24:39]
    ds_read_b64_tr_b16 v[42:43], v217 offset:4352
    buffer_store_dwordx4 v[152:155], v221, s[24:27], s46 offen offset:64 sc1
    buffer_store_dwordx4 v[156:159], v221, s[24:27], s46 offen offset:96 sc1
    v_fma_f32 v128, v112, v218, v219
    s_waitcnt lgkmcnt(2)
    v_mfma_f32_32x32x16_bf16 v[8:23], v[48:51], a[8:11], v[8:23]
    ds_read_b64_tr_b16 v[44:45], v217 offset:5120
    v_fma_f32 v129, v113, v218, v219
    v_fma_f32 v130, v114, v218, v219
    v_mfma_f32_32x32x16_bf16 v[24:39], v[48:51], a[152:155], v[24:39]
    ds_read_b64_tr_b16 v[46:47], v217 offset:5376
    v_fma_f32 v131, v115, v218, v219
    v_fma_f32 v132, v116, v218, v219
    v_mfma_f32_32x32x16_bf16 v[8:23], v[52:55], a[12:15], v[8:23]
    s_add_u32 m0, s53, 36864
    ds_read_b64_tr_b16 v[48:49], v217 offset:6144
    buffer_load_dwordx4 v209, s[36:39], s52 offen lds
    v_mfma_f32_32x32x16_bf16 v[24:39], v[52:55], a[156:159], v[24:39]
    ds_read_b64_tr_b16 v[50:51], v217 offset:6400
    v_fma_f32 v133, v117, v218, v219
    v_fma_f32 v134, v118, v218, v219
    v_fma_f32 v135, v119, v218, v219
    s_waitcnt lgkmcnt(2)
    v_mfma_f32_32x32x16_bf16 v[8:23], v[40:43], a[16:19], v[8:23]
    ds_read_b64_tr_b16 v[52:53], v217 offset:7168
    v_fma_f32 v136, v120, v218, v219
    v_fma_f32 v137, v121, v218, v219
    v_mfma_f32_32x32x16_bf16 v[24:39], v[40:43], a[160:163], v[24:39]
    ds_read_b64_tr_b16 v[54:55], v217 offset:7424
    v_fma_f32 v138, v122, v218, v219
    v_fma_f32 v139, v123, v218, v219
    v_mfma_f32_32x32x16_bf16 v[8:23], v[44:47], a[20:23], v[8:23]
    ds_read_b64_tr_b16 v[40:41], v217 offset:8192
    v_fma_f32 v140, v124, v218, v219
    v_fma_f32 v141, v125, v218, v219
    v_fma_f32 v142, v126, v218, v219
    v_mfma_f32_32x32x16_bf16 v[24:39], v[44:47], a[164:167], v[24:39]
    ds_read_b64_tr_b16 v[42:43], v217 offset:8448
    v_fma_f32 v143, v127, v218, v219
    v_cvt_pk_bf16_f32 v160, v128, v129
    s_waitcnt lgkmcnt(2)
    v_mfma_f32_32x32x16_bf16 v[8:23], v[48:51], a[24:27], v[8:23]
    s_add_u32 s52, s52, 589824
    s_add_u32 s53, s53, 4096
    s_add_u32 m0, s53, 0
    ds_read_b64_tr_b16 v[44:45], v217 offset:9216
    buffer_load_dwordx4 v208, s[32:35], s52 offen lds
    v_mfma_f32_32x32x16_bf16 v[24:39], v[48:51], a[168:171], v[24:39]
    ds_read_b64_tr_b16 v[46:47], v217 offset:9472
    v_cvt_pk_bf16_f32 v161, v130, v131
    v_cvt_pk_bf16_f32 v162, v132, v133
    v_mfma_f32_32x32x16_bf16 v[8:23], v[52:55], a[28:31], v[8:23]
    ds_read_b64_tr_b16 v[48:49], v217 offset:10240
    v_cvt_pk_bf16_f32 v163, v134, v135
    v_cvt_pk_bf16_f32 v164, v136, v137
    v_mfma_f32_32x32x16_bf16 v[24:39], v[52:55], a[172:175], v[24:39]
    ds_read_b64_tr_b16 v[50:51], v217 offset:10496
    v_cvt_pk_bf16_f32 v165, v138, v139
    v_cvt_pk_bf16_f32 v166, v140, v141
    v_cvt_pk_bf16_f32 v167, v142, v143
    s_waitcnt lgkmcnt(2)
    v_mfma_f32_32x32x16_bf16 v[8:23], v[40:43], a[32:35], v[8:23]
    ds_read_b64_tr_b16 v[52:53], v217 offset:11264
    s_mul_i32 s46, s41, 81920
    s_add_u32 s47, s50, 1
    v_mfma_f32_32x32x16_bf16 v[24:39], v[40:43], a[176:179], v[24:39]
    ds_read_b64_tr_b16 v[54:55], v217 offset:11520
    s_mul_i32 s47, s47, 1280
    s_add_u32 s46, s46, s47
    v_mfma_f32_32x32x16_bf16 v[8:23], v[44:47], a[36:39], v[8:23]
    s_add_u32 m0, s53, 36864
    ds_read_b64_tr_b16 v[40:41], v217 offset:12288
    buffer_load_dwordx4 v209, s[36:39], s52 offen lds
    v_mfma_f32_32x32x16_bf16 v[24:39], v[44:47], a[180:183], v[24:39]
    ds_read_b64_tr_b16 v[42:43], v217 offset:12544
    s_add_u32 s46, s46, 7110656
    buffer_store_dwordx4 v[160:163], v220, s[24:27], s46 offen sc1
    buffer_store_dwordx4 v[164:167], v220, s[24:27], s46 offen offset:640 sc1
    s_waitcnt lgkmcnt(2)
    v_mfma_f32_32x32x16_bf16 v[8:23], v[48:51], a[40:43], v[8:23]
    ds_read_b64_tr_b16 v[44:45], v217 offset:13312
    v_mov_b32_dpp v144, v128 row_shl:1 row_mask:0xf bank_mask:0xf bound_ctrl:0
    v_mov_b32_dpp v145, v129 row_shl:1 row_mask:0xf bank_mask:0xf bound_ctrl:0
    v_mfma_f32_32x32x16_bf16 v[24:39], v[48:51], a[184:187], v[24:39]
    ds_read_b64_tr_b16 v[46:47], v217 offset:13568
    v_mov_b32_dpp v146, v130 row_shl:1 row_mask:0xf bank_mask:0xf bound_ctrl:0
    v_mov_b32_dpp v147, v131 row_shl:1 row_mask:0xf bank_mask:0xf bound_ctrl:0
    v_mfma_f32_32x32x16_bf16 v[8:23], v[52:55], a[44:47], v[8:23]
    ds_read_b64_tr_b16 v[48:49], v217 offset:14336
    v_mov_b32_dpp v148, v132 row_shl:1 row_mask:0xf bank_mask:0xf bound_ctrl:0
    v_mov_b32_dpp v149, v133 row_shl:1 row_mask:0xf bank_mask:0xf bound_ctrl:0
    v_mov_b32_dpp v150, v134 row_shl:1 row_mask:0xf bank_mask:0xf bound_ctrl:0
    v_mfma_f32_32x32x16_bf16 v[24:39], v[52:55], a[188:191], v[24:39]
    ds_read_b64_tr_b16 v[50:51], v217 offset:14592
    v_mov_b32_dpp v151, v135 row_shl:1 row_mask:0xf bank_mask:0xf bound_ctrl:0
    v_mov_b32_dpp v152, v136 row_shl:1 row_mask:0xf bank_mask:0xf bound_ctrl:0
    s_waitcnt lgkmcnt(2)
    v_mfma_f32_32x32x16_bf16 v[8:23], v[40:43], a[48:51], v[8:23]
    s_add_u32 s52, s52, 589824
    s_add_u32 s53, s53, 4096
    s_add_u32 m0, s53, 0
    ds_read_b64_tr_b16 v[52:53], v217 offset:15360
    buffer_load_dwordx4 v208, s[32:35], s52 offen lds
    v_mfma_f32_32x32x16_bf16 v[24:39], v[40:43], a[192:195], v[24:39]
    ds_read_b64_tr_b16 v[54:55], v217 offset:15616
    v_mov_b32_dpp v153, v137 row_shl:1 row_mask:0xf bank_mask:0xf bound_ctrl:0
    v_mov_b32_dpp v154, v138 row_shl:1 row_mask:0xf bank_mask:0xf bound_ctrl:0
    v_mfma_f32_32x32x16_bf16 v[8:23], v[44:47], a[52:55], v[8:23]
    ds_read_b64_tr_b16 v[40:41], v217 offset:16384
    v_mov_b32_dpp v155, v139 row_shl:1 row_mask:0xf bank_mask:0xf bound_ctrl:0
    v_mov_b32_dpp v156, v140 row_shl:1 row_mask:0xf bank_mask:0xf bound_ctrl:0
    v_mfma_f32_32x32x16_bf16 v[24:39], v[44:47], a[196:199], v[24:39]
    ds_read_b64_tr_b16 v[42:43], v217 offset:16640
    v_mov_b32_dpp v157, v141 row_shl:1 row_mask:0xf bank_mask:0xf bound_ctrl:0
    v_mov_b32_dpp v158, v142 row_shl:1 row_mask:0xf bank_mask:0xf bound_ctrl:0
    v_mov_b32_dpp v159, v143 row_shl:1 row_mask:0xf bank_mask:0xf bound_ctrl:0
    s_waitcnt lgkmcnt(2)
    v_mfma_f32_32x32x16_bf16 v[8:23], v[48:51], a[56:59], v[8:23]
    ds_read_b64_tr_b16 v[44:45], v217 offset:17408
    v_cvt_pk_bf16_f32 v144, v128, v144
    v_cvt_pk_bf16_f32 v145, v129, v145
    v_mfma_f32_32x32x16_bf16 v[24:39], v[48:51], a[200:203], v[24:39]
    ds_read_b64_tr_b16 v[46:47], v217 offset:17664
    v_cvt_pk_bf16_f32 v146, v130, v146
    v_cvt_pk_bf16_f32 v147, v131, v147
    v_mfma_f32_32x32x16_bf16 v[8:23], v[52:55], a[60:63], v[8:23]
    s_add_u32 m0, s53, 36864
    ds_read_b64_tr_b16 v[48:49], v217 offset:18432
    buffer_load_dwordx4 v209, s[36:39], s52 offen lds
    v_mfma_f32_32x32x16_bf16 v[24:39], v[52:55], a[204:207], v[24:39]
    ds_read_b64_tr_b16 v[50:51], v217 offset:18688
    v_cvt_pk_bf16_f32 v148, v132, v148
    v_cvt_pk_bf16_f32 v149, v133, v149
    v_cvt_pk_bf16_f32 v150, v134, v150
    s_waitcnt lgkmcnt(2)
    v_mfma_f32_32x32x16_bf16 v[8:23], v[40:43], a[64:67], v[8:23]
    ds_read_b64_tr_b16 v[52:53], v217 offset:19456
    v_cvt_pk_bf16_f32 v151, v135, v151
    v_cvt_pk_bf16_f32 v152, v136, v152
    v_mfma_f32_32x32x16_bf16 v[24:39], v[40:43], a[208:211], v[24:39]
    ds_read_b64_tr_b16 v[54:55], v217 offset:19712
    v_cvt_pk_bf16_f32 v153, v137, v153
    v_cvt_pk_bf16_f32 v154, v138, v154
    v_mfma_f32_32x32x16_bf16 v[8:23], v[44:47], a[68:71], v[8:23]
    ds_read_b64_tr_b16 v[40:41], v217 offset:20480
    v_cvt_pk_bf16_f32 v155, v139, v155
    v_cvt_pk_bf16_f32 v156, v140, v156
    v_mfma_f32_32x32x16_bf16 v[24:39], v[44:47], a[212:215], v[24:39]
    ds_read_b64_tr_b16 v[42:43], v217 offset:20736
    v_cvt_pk_bf16_f32 v157, v141, v157
    v_cvt_pk_bf16_f32 v158, v142, v158
    v_cvt_pk_bf16_f32 v159, v143, v159
    s_waitcnt lgkmcnt(2)
    v_mfma_f32_32x32x16_bf16 v[8:23], v[48:51], a[72:75], v[8:23]
    ds_read_b64_tr_b16 v[44:45], v217 offset:21504
    s_lshl_b32 s46, s41, 13
    s_add_u32 s47, s50, 1
    v_mfma_f32_32x32x16_bf16 v[24:39], v[48:51], a[216:219], v[24:39]
    ds_read_b64_tr_b16 v[46:47], v217 offset:21760
    s_lshl_b32 s47, s47, 7
    s_add_u32 s46, s46, s47
    v_mfma_f32_32x32x16_bf16 v[8:23], v[52:55], a[76:79], v[8:23]
    ds_read_b64_tr_b16 v[48:49], v217 offset:22528
    buffer_store_dwordx4 v[144:147], v221, s[24:27], s46 offen offset:0 sc1
    buffer_store_dwordx4 v[148:151], v221, s[24:27], s46 offen offset:32 sc1
    buffer_store_dwordx4 v[152:155], v221, s[24:27], s46 offen offset:64 sc1
    v_mfma_f32_32x32x16_bf16 v[24:39], v[52:55], a[220:223], v[24:39]
    ds_read_b64_tr_b16 v[50:51], v217 offset:22784
    buffer_store_dwordx4 v[156:159], v221, s[24:27], s46 offen offset:96 sc1
    v_mul_f32 v128, s59, v176
    s_waitcnt lgkmcnt(2)
    v_mfma_f32_32x32x16_bf16 v[8:23], v[40:43], a[80:83], v[8:23]
    ds_read_b64_tr_b16 v[52:53], v217 offset:23552
    v_mul_f32 v129, s59, v177
    v_mul_f32 v130, s59, v178
    v_mfma_f32_32x32x16_bf16 v[24:39], v[40:43], a[224:227], v[24:39]
    ds_read_b64_tr_b16 v[54:55], v217 offset:23808
    v_mul_f32 v131, s59, v179
    v_mul_f32 v132, s59, v180
    v_mul_f32 v133, s59, v181
    v_mfma_f32_32x32x16_bf16 v[8:23], v[44:47], a[84:87], v[8:23]
    ds_read_b64_tr_b16 v[40:41], v217 offset:24576
    v_mul_f32 v134, s59, v182
    v_mul_f32 v135, s59, v183
    v_mfma_f32_32x32x16_bf16 v[24:39], v[44:47], a[228:231], v[24:39]
    ds_read_b64_tr_b16 v[42:43], v217 offset:24832
    v_exp_f32 v128, v128
    v_exp_f32 v129, v129
    s_waitcnt lgkmcnt(2)
    v_mfma_f32_32x32x16_bf16 v[8:23], v[48:51], a[88:91], v[8:23]
    ds_read_b64_tr_b16 v[44:45], v217 offset:25600
    v_exp_f32 v130, v130
    v_exp_f32 v131, v131
    v_mfma_f32_32x32x16_bf16 v[24:39], v[48:51], a[232:235], v[24:39]
    ds_read_b64_tr_b16 v[46:47], v217 offset:25856
    v_exp_f32 v132, v132
    v_exp_f32 v133, v133
    v_exp_f32 v134, v134
    v_mfma_f32_32x32x16_bf16 v[8:23], v[52:55], a[92:95], v[8:23]
    ds_read_b64_tr_b16 v[48:49], v217 offset:26624
    v_exp_f32 v135, v135
    v_mul_f32 v136, v176, v184
    v_mfma_f32_32x32x16_bf16 v[24:39], v[52:55], a[236:239], v[24:39]
    ds_read_b64_tr_b16 v[50:51], v217 offset:26880
    v_mul_f32 v137, v177, v185
    v_mul_f32 v138, v178, v186
    s_waitcnt lgkmcnt(2)
    v_mfma_f32_32x32x16_bf16 v[8:23], v[40:43], a[96:99], v[8:23]
    ds_read_b64_tr_b16 v[52:53], v217 offset:27648
    v_mul_f32 v139, v179, v187
    v_mul_f32 v140, v180, v188
    v_mul_f32 v141, v181, v189
    v_mfma_f32_32x32x16_bf16 v[24:39], v[40:43], a[240:243], v[24:39]
    ds_read_b64_tr_b16 v[54:55], v217 offset:27904
    v_mul_f32 v142, v182, v190
    v_mul_f32 v143, v183, v191
    v_mfma_f32_32x32x16_bf16 v[8:23], v[44:47], a[100:103], v[8:23]
    ds_read_b64_tr_b16 v[40:41], v217 offset:28672
    v_add_f32 v128, 1.0, v128
    v_add_f32 v129, 1.0, v129
    v_mfma_f32_32x32x16_bf16 v[24:39], v[44:47], a[244:247], v[24:39]
    ds_read_b64_tr_b16 v[42:43], v217 offset:28928
    v_add_f32 v130, 1.0, v130
    v_add_f32 v131, 1.0, v131
    s_waitcnt lgkmcnt(2)
    v_mfma_f32_32x32x16_bf16 v[8:23], v[48:51], a[104:107], v[8:23]
    ds_read_b64_tr_b16 v[44:45], v217 offset:29696
    v_add_f32 v132, 1.0, v132
    v_add_f32 v133, 1.0, v133
    v_add_f32 v134, 1.0, v134
    v_mfma_f32_32x32x16_bf16 v[24:39], v[48:51], a[248:251], v[24:39]
    ds_read_b64_tr_b16 v[46:47], v217 offset:29952
    v_add_f32 v135, 1.0, v135
    v_rcp_f32 v128, v128
    v_mfma_f32_32x32x16_bf16 v[8:23], v[52:55], a[108:111], v[8:23]
    ds_read_b64_tr_b16 v[48:49], v217 offset:30720
    v_rcp_f32 v129, v129
    v_rcp_f32 v130, v130
    v_mfma_f32_32x32x16_bf16 v[24:39], v[52:55], a[252:255], v[24:39]
    ds_read_b64_tr_b16 v[50:51], v217 offset:30976
    v_rcp_f32 v131, v131
    v_rcp_f32 v132, v132
    v_rcp_f32 v133, v133
    s_waitcnt lgkmcnt(2)
    v_mfma_f32_32x32x16_bf16 v[8:23], v[40:43], a[112:115], v[8:23]
    ds_read_b64_tr_b16 v[52:53], v217 offset:31744
    v_rcp_f32 v134, v134
    v_rcp_f32 v135, v135
    v_mfma_f32_32x32x16_bf16 v[24:39], v[40:43], v[224:227], v[24:39]
    ds_read_b64_tr_b16 v[54:55], v217 offset:32000
    s_lshl_b32 s46, s58, 10
    s_add_u32 s46, s46, s56
    v_mfma_f32_32x32x16_bf16 v[8:23], v[44:47], a[116:119], v[8:23]
    ds_read_b64_tr_b16 v[40:41], v217 offset:32768
    v_mul_f32 v136, v136, v128
    v_mul_f32 v137, v137, v129
    v_mul_f32 v138, v138, v130
    v_mfma_f32_32x32x16_bf16 v[24:39], v[44:47], v[228:231], v[24:39]
    ds_read_b64_tr_b16 v[42:43], v217 offset:33024
    v_mul_f32 v139, v139, v131
    v_mul_f32 v140, v140, v132
    s_waitcnt lgkmcnt(2)
    v_mfma_f32_32x32x16_bf16 v[8:23], v[48:51], a[120:123], v[8:23]
    ds_read_b64_tr_b16 v[44:45], v217 offset:33792
    v_mul_f32 v141, v141, v133
    v_mul_f32 v142, v142, v134
    v_mfma_f32_32x32x16_bf16 v[24:39], v[48:51], v[232:235], v[24:39]
    ds_read_b64_tr_b16 v[46:47], v217 offset:34048
    v_mul_f32 v143, v143, v135
    v_cvt_pk_bf16_f32 v144, v136, v137
    v_mfma_f32_32x32x16_bf16 v[8:23], v[52:55], a[124:127], v[8:23]
    ds_read_b64_tr_b16 v[48:49], v217 offset:34816
    v_cvt_pk_bf16_f32 v145, v138, v139
    v_cvt_pk_bf16_f32 v146, v140, v141
    v_cvt_pk_bf16_f32 v147, v142, v143
    v_mfma_f32_32x32x16_bf16 v[24:39], v[52:55], v[236:239], v[24:39]
    ds_read_b64_tr_b16 v[50:51], v217 offset:35072
    buffer_store_dwordx4 v[144:147], v2, s[24:27], s46 offen sc1
    v_mul_f32 v152, s59, v192
    s_waitcnt lgkmcnt(2)
    v_mfma_f32_32x32x16_bf16 v[8:23], v[40:43], a[128:131], v[8:23]
    ds_read_b64_tr_b16 v[52:53], v217 offset:35840
    v_mul_f32 v153, s59, v193
    v_mul_f32 v154, s59, v194
    v_mfma_f32_32x32x16_bf16 v[24:39], v[40:43], v[240:243], v[24:39]
    ds_read_b64_tr_b16 v[54:55], v217 offset:36096
    v_mul_f32 v155, s59, v195
    v_mul_f32 v156, s59, v196
    v_mul_f32 v157, s59, v197
    v_mfma_f32_32x32x16_bf16 v[8:23], v[44:47], a[132:135], v[8:23]
    v_mul_f32 v158, s59, v198
    v_mul_f32 v159, s59, v199
    v_mfma_f32_32x32x16_bf16 v[24:39], v[44:47], v[244:247], v[24:39]
    v_exp_f32 v152, v152
    v_exp_f32 v153, v153
    s_waitcnt lgkmcnt(0)
    v_mfma_f32_32x32x16_bf16 v[8:23], v[48:51], a[136:139], v[8:23]
    v_exp_f32 v154, v154
    v_exp_f32 v155, v155
    v_mfma_f32_32x32x16_bf16 v[24:39], v[48:51], v[248:251], v[24:39]
    s_waitcnt vmcnt(1)
    s_barrier
    ds_read_b64_tr_b16 v[40:41], v216 offset:0
    ds_read_b64_tr_b16 v[42:43], v216 offset:256
    ds_read_b64_tr_b16 v[44:45], v216 offset:1024
    ds_read_b64_tr_b16 v[46:47], v216 offset:1280
    ds_read_b64_tr_b16 v[48:49], v216 offset:2048
    ds_read_b64_tr_b16 v[50:51], v216 offset:2304
    v_mfma_f32_32x32x16_bf16 v[8:23], v[52:55], a[140:143], v[8:23]
    v_mfma_f32_32x32x16_bf16 v[24:39], v[52:55], v[252:255], v[24:39]
    s_cmp_lg_u32 s42, 0
    s_cbranch_scc1 L_pub_15
    s_lshl_b32 s49, s2, 7
    s_add_u32 s49, s49, 8
    v_mov_b32 v4, s44
    v_mov_b32 v5, s45
    v_mov_b32 v6, 0
    s_mov_b64 exec, 1
    buffer_store_dwordx2 v[4:5], v6, s[24:27], s49 offen sc1
    s_mov_b64 exec, -1
L_pub_15:
    v_mov_b32 v217, v215
    s_lshl_b32 s51, s42, 10
    s_add_u32 s51, s51, 83968
    s_mov_b32 s61, s62
    s_waitcnt lgkmcnt(2)
    v_mfma_f32_32x32x16_bf16 v[64:79], v[40:43], a[0:3], 0
    s_mul_i32 s52, s42, 147456
    s_add_u32 s52, s52, s61
    s_mov_b32 s53, s51
    s_add_u32 m0, s53, 0
    ds_read_b64_tr_b16 v[52:53], v216 offset:3072
    buffer_load_dwordx4 v208, s[32:35], s52 offen lds
    v_mfma_f32_32x32x16_bf16 v[80:95], v[40:43], a[144:147], 0
    ds_read_b64_tr_b16 v[54:55], v216 offset:3328
    v_mfma_f32_32x32x16_bf16 v[64:79], v[44:47], a[4:7], v[64:79]
    ds_read_b64_tr_b16 v[40:41], v216 offset:4096
    v_mfma_f32_32x32x16_bf16 v[80:95], v[44:47], a[148:151], v[80:95]
    ds_read_b64_tr_b16 v[42:43], v216 offset:4352
    v_exp_f32 v156, v156
    v_exp_f32 v157, v157
    v_exp_f32 v158, v158
    s_waitcnt lgkmcnt(2)
    v_mfma_f32_32x32x16_bf16 v[64:79], v[48:51], a[8:11], v[64:79]
    ds_read_b64_tr_b16 v[44:45], v216 offset:5120
    v_exp_f32 v159, v159
    v_mul_f32 v160, v192, v200
    v_mul_f32 v161, v193, v201
    v_mfma_f32_32x32x16_bf16 v[80:95], v[48:51], a[152:155], v[80:95]
    ds_read_b64_tr_b16 v[46:47], v216 offset:5376
    v_mul_f32 v162, v194, v202
    v_mul_f32 v163, v195, v203
    v_mfma_f32_32x32x16_bf16 v[64:79], v[52:55], a[12:15], v[64:79]
    s_add_u32 m0, s53, 36864
    ds_read_b64_tr_b16 v[48:49], v216 offset:6144
    buffer_load_dwordx4 v209, s[36:39], s52 offen lds
    v_mfma_f32_32x32x16_bf16 v[80:95], v[52:55], a[156:159], v[80:95]
    ds_read_b64_tr_b16 v[50:51], v216 offset:6400
    v_mul_f32 v164, v196, v204
    v_mul_f32 v165, v197, v205
    v_mul_f32 v166, v198, v206
    s_waitcnt lgkmcnt(2)
    v_mfma_f32_32x32x16_bf16 v[64:79], v[40:43], a[16:19], v[64:79]
    ds_read_b64_tr_b16 v[52:53], v216 offset:7168
    v_mul_f32 v167, v199, v207
    v_add_f32 v152, 1.0, v152
    v_mfma_f32_32x32x16_bf16 v[80:95], v[40:43], a[160:163], v[80:95]
    ds_read_b64_tr_b16 v[54:55], v216 offset:7424
    v_add_f32 v153, 1.0, v153
    v_add_f32 v154, 1.0, v154
    v_add_f32 v155, 1.0, v155
    v_mfma_f32_32x32x16_bf16 v[64:79], v[44:47], a[20:23], v[64:79]
    ds_read_b64_tr_b16 v[40:41], v216 offset:8192
    v_add_f32 v156, 1.0, v156
    v_add_f32 v157, 1.0, v157
    v_mfma_f32_32x32x16_bf16 v[80:95], v[44:47], a[164:167], v[80:95]
    ds_read_b64_tr_b16 v[42:43], v216 offset:8448
    v_add_f32 v158, 1.0, v158
    v_add_f32 v159, 1.0, v159
    v_rcp_f32 v152, v152
    s_waitcnt lgkmcnt(2)
    v_mfma_f32_32x32x16_bf16 v[64:79], v[48:51], a[24:27], v[64:79]
    s_add_u32 s52, s52, 589824
    s_add_u32 s53, s53, 4096
    s_add_u32 m0, s53, 0
    ds_read_b64_tr_b16 v[44:45], v216 offset:9216
    buffer_load_dwordx4 v208, s[32:35], s52 offen lds
    v_mfma_f32_32x32x16_bf16 v[80:95], v[48:51], a[168:171], v[80:95]
    ds_read_b64_tr_b16 v[46:47], v216 offset:9472
    v_rcp_f32 v153, v153
    v_rcp_f32 v154, v154
    v_mfma_f32_32x32x16_bf16 v[64:79], v[52:55], a[28:31], v[64:79]
    ds_read_b64_tr_b16 v[48:49], v216 offset:10240
    v_rcp_f32 v155, v155
    v_rcp_f32 v156, v156
    v_rcp_f32 v157, v157
    v_mfma_f32_32x32x16_bf16 v[80:95], v[52:55], a[172:175], v[80:95]
    ds_read_b64_tr_b16 v[50:51], v216 offset:10496
    v_rcp_f32 v158, v158
    v_rcp_f32 v159, v159
    s_waitcnt lgkmcnt(2)
    v_mfma_f32_32x32x16_bf16 v[64:79], v[40:43], a[32:35], v[64:79]
    ds_read_b64_tr_b16 v[52:53], v216 offset:11264
    s_lshl_b32 s47, s58, 10
    s_add_u32 s47, s47, s57
    v_mul_f32 v160, v160, v152
    v_mfma_f32_32x32x16_bf16 v[80:95], v[40:43], a[176:179], v[80:95]
    ds_read_b64_tr_b16 v[54:55], v216 offset:11520
    v_mul_f32 v161, v161, v153
    v_mul_f32 v162, v162, v154
    v_mul_f32 v163, v163, v155
    v_mfma_f32_32x32x16_bf16 v[64:79], v[44:47], a[36:39], v[64:79]
    s_add_u32 m0, s53, 36864
    ds_read_b64_tr_b16 v[40:41], v216 offset:12288
    buffer_load_dwordx4 v209, s[36:39], s52 offen lds
    v_mfma_f32_32x32x16_bf16 v[80:95], v[44:47], a[180:183], v[80:95]
    ds_read_b64_tr_b16 v[42:43], v216 offset:12544
    v_mul_f32 v164, v164, v156
    v_mul_f32 v165, v165, v157
    s_waitcnt lgkmcnt(2)
    v_mfma_f32_32x32x16_bf16 v[64:79], v[48:51], a[40:43], v[64:79]
    ds_read_b64_tr_b16 v[44:45], v216 offset:13312
    v_mul_f32 v166, v166, v158
    v_mul_f32 v167, v167, v159
    v_cvt_pk_bf16_f32 v168, v160, v161
    v_mfma_f32_32x32x16_bf16 v[80:95], v[48:51], a[184:187], v[80:95]
    ds_read_b64_tr_b16 v[46:47], v216 offset:13568
    v_cvt_pk_bf16_f32 v169, v162, v163
    v_cvt_pk_bf16_f32 v170, v164, v165
    v_mfma_f32_32x32x16_bf16 v[64:79], v[52:55], a[44:47], v[64:79]
    ds_read_b64_tr_b16 v[48:49], v216 offset:14336
    v_cvt_pk_bf16_f32 v171, v166, v167
    buffer_store_dwordx4 v[168:171], v2, s[24:27], s47 offen sc1
    s_add_u32 s58, s58, 1
    v_mfma_f32_32x32x16_bf16 v[80:95], v[52:55], a[188:191], v[80:95]
    ds_read_b64_tr_b16 v[50:51], v216 offset:14592
    v_mul_f32 v128, s59, v8
    v_mul_f32 v129, s59, v9
    s_waitcnt lgkmcnt(2)
    v_mfma_f32_32x32x16_bf16 v[64:79], v[40:43], a[48:51], v[64:79]
    s_add_u32 s52, s52, 589824
    s_add_u32 s53, s53, 4096
    s_add_u32 m0, s53, 0
    ds_read_b64_tr_b16 v[52:53], v216 offset:15360
    buffer_load_dwordx4 v208, s[32:35], s52 offen lds
    v_mfma_f32_32x32x16_bf16 v[80:95], v[40:43], a[192:195], v[80:95]
    ds_read_b64_tr_b16 v[54:55], v216 offset:15616
    v_mul_f32 v130, s59, v10
    v_mul_f32 v131, s59, v11
    v_mul_f32 v132, s59, v12
    v_mfma_f32_32x32x16_bf16 v[64:79], v[44:47], a[52:55], v[64:79]
    ds_read_b64_tr_b16 v[40:41], v216 offset:16384
    v_mul_f32 v133, s59, v13
    v_mul_f32 v134, s59, v14
    v_mfma_f32_32x32x16_bf16 v[80:95], v[44:47], a[196:199], v[80:95]
    ds_read_b64_tr_b16 v[42:43], v216 offset:16640
    v_mul_f32 v135, s59, v15
    v_exp_f32 v128, v128
    v_exp_f32 v129, v129
    s_waitcnt lgkmcnt(2)
    v_mfma_f32_32x32x16_bf16 v[64:79], v[48:51], a[56:59], v[64:79]
    ds_read_b64_tr_b16 v[44:45], v216 offset:17408
    v_exp_f32 v130, v130
    v_exp_f32 v131, v131
    v_mfma_f32_32x32x16_bf16 v[80:95], v[48:51], a[200:203], v[80:95]
    ds_read_b64_tr_b16 v[46:47], v216 offset:17664
    v_exp_f32 v132, v132
    v_exp_f32 v133, v133
    v_exp_f32 v134, v134
    v_mfma_f32_32x32x16_bf16 v[64:79], v[52:55], a[60:63], v[64:79]
    s_add_u32 m0, s53, 36864
    ds_read_b64_tr_b16 v[48:49], v216 offset:18432
    buffer_load_dwordx4 v209, s[36:39], s52 offen lds
    v_mfma_f32_32x32x16_bf16 v[80:95], v[52:55], a[204:207], v[80:95]
    ds_read_b64_tr_b16 v[50:51], v216 offset:18688
    v_exp_f32 v135, v135
    v_mul_f32 v136, v8, v16
    v_mul_f32 v137, v9, v17
    s_waitcnt lgkmcnt(2)
    v_mfma_f32_32x32x16_bf16 v[64:79], v[40:43], a[64:67], v[64:79]
    ds_read_b64_tr_b16 v[52:53], v216 offset:19456
    v_mul_f32 v138, v10, v18
    v_mul_f32 v139, v11, v19
    v_mfma_f32_32x32x16_bf16 v[80:95], v[40:43], a[208:211], v[80:95]
    ds_read_b64_tr_b16 v[54:55], v216 offset:19712
    v_mul_f32 v140, v12, v20
    v_mul_f32 v141, v13, v21
    v_mul_f32 v142, v14, v22
    v_mfma_f32_32x32x16_bf16 v[64:79], v[44:47], a[68:71], v[64:79]
    ds_read_b64_tr_b16 v[40:41], v216 offset:20480
    v_mul_f32 v143, v15, v23
    v_add_f32 v128, 1.0, v128
    v_mfma_f32_32x32x16_bf16 v[80:95], v[44:47], a[212:215], v[80:95]
    ds_read_b64_tr_b16 v[42:43], v216 offset:20736
    v_add_f32 v129, 1.0, v129
    v_add_f32 v130, 1.0, v130
    v_add_f32 v131, 1.0, v131
    s_waitcnt lgkmcnt(2)
    v_mfma_f32_32x32x16_bf16 v[64:79], v[48:51], a[72:75], v[64:79]
    s_add_u32 s52, s52, 589824
    s_add_u32 s53, s53, 4096
    s_add_u32 m0, s53, 0
    ds_read_b64_tr_b16 v[44:45], v216 offset:21504
    buffer_load_dwordx4 v208, s[32:35], s52 offen lds
    v_mfma_f32_32x32x16_bf16 v[80:95], v[48:51], a[216:219], v[80:95]
    ds_read_b64_tr_b16 v[46:47], v216 offset:21760
    v_add_f32 v132, 1.0, v132
    v_add_f32 v133, 1.0, v133
    v_mfma_f32_32x32x16_bf16 v[64:79], v[52:55], a[76:79], v[64:79]
    ds_read_b64_tr_b16 v[48:49], v216 offset:22528
    v_add_f32 v134, 1.0, v134
    v_add_f32 v135, 1.0, v135
    v_rcp_f32 v128, v128
    v_mfma_f32_32x32x16_bf16 v[80:95], v[52:55], a[220:223], v[80:95]
    ds_read_b64_tr_b16 v[50:51], v216 offset:22784
    v_rcp_f32 v129, v129
    v_rcp_f32 v130, v130
    s_waitcnt lgkmcnt(2)
    v_mfma_f32_32x32x16_bf16 v[64:79], v[40:43], a[80:83], v[64:79]
    ds_read_b64_tr_b16 v[52:53], v216 offset:23552
    v_rcp_f32 v131, v131
    v_rcp_f32 v132, v132
    v_rcp_f32 v133, v133
    v_mfma_f32_32x32x16_bf16 v[80:95], v[40:43], a[224:227], v[80:95]
    ds_read_b64_tr_b16 v[54:55], v216 offset:23808
    v_rcp_f32 v134, v134
    v_rcp_f32 v135, v135
    v_mfma_f32_32x32x16_bf16 v[64:79], v[44:47], a[84:87], v[64:79]
    s_add_u32 m0, s53, 36864
    ds_read_b64_tr_b16 v[40:41], v216 offset:24576
    buffer_load_dwordx4 v209, s[36:39], s52 offen lds
    v_mfma_f32_32x32x16_bf16 v[80:95], v[44:47], a[228:231], v[80:95]
    ds_read_b64_tr_b16 v[42:43], v216 offset:24832
    s_lshl_b32 s46, s58, 10
    s_add_u32 s46, s46, s56
    v_mul_f32 v136, v136, v128
    s_waitcnt lgkmcnt(2)
    v_mfma_f32_32x32x16_bf16 v[64:79], v[48:51], a[88:91], v[64:79]
    ds_read_b64_tr_b16 v[44:45], v216 offset:25600
    v_mul_f32 v137, v137, v129
    v_mul_f32 v138, v138, v130
    v_mul_f32 v139, v139, v131
    v_mfma_f32_32x32x16_bf16 v[80:95], v[48:51], a[232:235], v[80:95]
    ds_read_b64_tr_b16 v[46:47], v216 offset:25856
    v_mul_f32 v140, v140, v132
    v_mul_f32 v141, v141, v133
    v_mfma_f32_32x32x16_bf16 v[64:79], v[52:55], a[92:95], v[64:79]
    ds_read_b64_tr_b16 v[48:49], v216 offset:26624
    v_mul_f32 v142, v142, v134
    v_mul_f32 v143, v143, v135
    v_cvt_pk_bf16_f32 v144, v136, v137
    v_mfma_f32_32x32x16_bf16 v[80:95], v[52:55], a[236:239], v[80:95]
    ds_read_b64_tr_b16 v[50:51], v216 offset:26880
    v_cvt_pk_bf16_f32 v145, v138, v139
    v_cvt_pk_bf16_f32 v146, v140, v141
    s_waitcnt lgkmcnt(2)
    v_mfma_f32_32x32x16_bf16 v[64:79], v[40:43], a[96:99], v[64:79]
    s_add_u32 s52, s52, 589824
    s_add_u32 s53, s53, 4096
    s_add_u32 m0, s53, 0
    ds_read_b64_tr_b16 v[52:53], v216 offset:27648
    buffer_load_dwordx4 v208, s[32:35], s52 offen lds
    v_mfma_f32_32x32x16_bf16 v[80:95], v[40:43], a[240:243], v[80:95]
    ds_read_b64_tr_b16 v[54:55], v216 offset:27904
    v_cvt_pk_bf16_f32 v147, v142, v143
    buffer_store_dwordx4 v[144:147], v2, s[24:27], s46 offen sc1
    v_mul_f32 v152, s59, v24
    v_mfma_f32_32x32x16_bf16 v[64:79], v[44:47], a[100:103], v[64:79]
    ds_read_b64_tr_b16 v[40:41], v216 offset:28672
    v_mul_f32 v153, s59, v25
    v_mul_f32 v154, s59, v26
    v_mfma_f32_32x32x16_bf16 v[80:95], v[44:47], a[244:247], v[80:95]
    ds_read_b64_tr_b16 v[42:43], v216 offset:28928
    v_mul_f32 v155, s59, v27
    v_mul_f32 v156, s59, v28
    v_mul_f32 v157, s59, v29
    s_waitcnt lgkmcnt(2)
    v_mfma_f32_32x32x16_bf16 v[64:79], v[48:51], a[104:107], v[64:79]
    ds_read_b64_tr_b16 v[44:45], v216 offset:29696
    v_mul_f32 v158, s59, v30
    v_mul_f32 v159, s59, v31
    v_mfma_f32_32x32x16_bf16 v[80:95], v[48:51], a[248:251], v[80:95]
    ds_read_b64_tr_b16 v[46:47], v216 offset:29952
    v_exp_f32 v152, v152
    v_exp_f32 v153, v153
    v_exp_f32 v154, v154
    v_mfma_f32_32x32x16_bf16 v[64:79], v[52:55], a[108:111], v[64:79]
    s_add_u32 m0, s53, 36864
    ds_read_b64_tr_b16 v[48:49], v216 offset:30720
    buffer_load_dwordx4 v209, s[36:39], s52 offen lds
    v_mfma_f32_32x32x16_bf16 v[80:95], v[52:55], a[252:255], v[80:95]
    ds_read_b64_tr_b16 v[50:51], v216 offset:30976
    v_exp_f32 v155, v155
    v_exp_f32 v156, v156
    s_waitcnt lgkmcnt(2)
    v_mfma_f32_32x32x16_bf16 v[64:79], v[40:43], a[112:115], v[64:79]
    ds_read_b64_tr_b16 v[52:53], v216 offset:31744
    v_exp_f32 v157, v157
    v_exp_f32 v158, v158
    v_exp_f32 v159, v159
    v_mfma_f32_32x32x16_bf16 v[80:95], v[40:43], v[224:227], v[80:95]
    ds_read_b64_tr_b16 v[54:55], v216 offset:32000
    v_mul_f32 v160, v24, v32
    v_mul_f32 v161, v25, v33
    v_mul_f32 v162, v26, v34
    v_mfma_f32_32x32x16_bf16 v[64:79], v[44:47], a[116:119], v[64:79]
    ds_read_b64_tr_b16 v[40:41], v216 offset:32768
    v_mul_f32 v163, v27, v35
    v_mul_f32 v164, v28, v36
    v_mfma_f32_32x32x16_bf16 v[80:95], v[44:47], v[228:231], v[80:95]
    ds_read_b64_tr_b16 v[42:43], v216 offset:33024
    v_mul_f32 v165, v29, v37
    v_mul_f32 v166, v30, v38
    v_mul_f32 v167, v31, v39
    s_waitcnt lgkmcnt(2)
    v_mfma_f32_32x32x16_bf16 v[64:79], v[48:51], a[120:123], v[64:79]
    s_add_u32 s52, s52, 589824
    s_add_u32 s53, s53, 4096
    s_add_u32 m0, s53, 0
    ds_read_b64_tr_b16 v[44:45], v216 offset:33792
    buffer_load_dwordx4 v208, s[32:35], s52 offen lds
    v_mfma_f32_32x32x16_bf16 v[80:95], v[48:51], v[232:235], v[80:95]
    ds_read_b64_tr_b16 v[46:47], v216 offset:34048
    v_add_f32 v152, 1.0, v152
    v_add_f32 v153, 1.0, v153
    v_mfma_f32_32x32x16_bf16 v[64:79], v[52:55], a[124:127], v[64:79]
    ds_read_b64_tr_b16 v[48:49], v216 offset:34816
    v_add_f32 v154, 1.0, v154
    v_add_f32 v155, 1.0, v155
    v_add_f32 v156, 1.0, v156
    v_mfma_f32_32x32x16_bf16 v[80:95], v[52:55], v[236:239], v[80:95]
    ds_read_b64_tr_b16 v[50:51], v216 offset:35072
    v_add_f32 v157, 1.0, v157
    v_add_f32 v158, 1.0, v158
    s_waitcnt lgkmcnt(2)
    v_mfma_f32_32x32x16_bf16 v[64:79], v[40:43], a[128:131], v[64:79]
    ds_read_b64_tr_b16 v[52:53], v216 offset:35840
    v_add_f32 v159, 1.0, v159
    v_rcp_f32 v152, v152
    v_rcp_f32 v153, v153
    v_mfma_f32_32x32x16_bf16 v[80:95], v[40:43], v[240:243], v[80:95]
    ds_read_b64_tr_b16 v[54:55], v216 offset:36096
    v_rcp_f32 v154, v154
    v_rcp_f32 v155, v155
    v_mfma_f32_32x32x16_bf16 v[64:79], v[44:47], a[132:135], v[64:79]
    s_add_u32 m0, s53, 36864
    ds_read_b64_tr_b16 v[40:41], v217 offset:0
    buffer_load_dwordx4 v209, s[36:39], s52 offen lds
    v_mfma_f32_32x32x16_bf16 v[80:95], v[44:47], v[244:247], v[80:95]
    ds_read_b64_tr_b16 v[42:43], v217 offset:256
    v_rcp_f32 v156, v156
    v_rcp_f32 v157, v157
    v_rcp_f32 v158, v158
    s_waitcnt lgkmcnt(2)
    v_mfma_f32_32x32x16_bf16 v[64:79], v[48:51], a[136:139], v[64:79]
    ds_read_b64_tr_b16 v[44:45], v217 offset:1024
    v_rcp_f32 v159, v159
    s_lshl_b32 s47, s58, 10
    v_mfma_f32_32x32x16_bf16 v[80:95], v[48:51], v[248:251], v[80:95]
    ds_read_b64_tr_b16 v[46:47], v217 offset:1280
    v_mfma_f32_32x32x16_bf16 v[64:79], v[52:55], a[140:143], v[64:79]
    ds_read_b64_tr_b16 v[48:49], v217 offset:2048
    v_mfma_f32_32x32x16_bf16 v[80:95], v[52:55], v[252:255], v[80:95]
    ds_read_b64_tr_b16 v[50:51], v217 offset:2304
    v_and_b32 v3, 1, v0
    v_bfe_u32 v6, v0, 1, 2
    v_lshl_add_u32 v3, v6, 3, v3
    s_and_b32 s48, s2, 0xe6
    v_add_u32 v3, s48, v3
    v_lshlrev_b32 v6, 7, v3
    v_add_u32 v6, 8, v6
    s_mov_b64 exec, 255
    buffer_load_dwordx2 v[4:5], v6, s[24:27], 0 offen sc1
    s_mov_b64 exec, -1
    s_lshl_b32 s49, s64, 5
    v_xor_b32 v216, s49, v214
    v_add_u32 v216, 83968, v216
    s_waitcnt lgkmcnt(2)
    v_mfma_f32_32x32x16_bf16 v[96:111], v[40:43], a[0:3], 0
    s_add_u32 s52, s52, 589824
    s_add_u32 s53, s53, 4096
    s_add_u32 m0, s53, 0
    ds_read_b64_tr_b16 v[52:53], v217 offset:3072
    buffer_load_dwordx4 v208, s[32:35], s52 offen lds
    v_mfma_f32_32x32x16_bf16 v[112:127], v[40:43], a[144:147], 0
    ds_read_b64_tr_b16 v[54:55], v217 offset:3328
    v_mfma_f32_32x32x16_bf16 v[96:111], v[44:47], a[4:7], v[96:111]
    ds_read_b64_tr_b16 v[40:41], v217 offset:4096
    v_mfma_f32_32x32x16_bf16 v[112:127], v[44:47], a[148:151], v[112:127]
    ds_read_b64_tr_b16 v[42:43], v217 offset:4352
    s_add_u32 s47, s47, s57
    v_mul_f32 v160, v160, v152
    v_mul_f32 v161, v161, v153
    s_waitcnt lgkmcnt(2)
    v_mfma_f32_32x32x16_bf16 v[96:111], v[48:51], a[8:11], v[96:111]
    ds_read_b64_tr_b16 v[44:45], v217 offset:5120
    v_mul_f32 v162, v162, v154
    v_mul_f32 v163, v163, v155
    v_mfma_f32_32x32x16_bf16 v[112:127], v[48:51], a[152:155], v[112:127]
    ds_read_b64_tr_b16 v[46:47], v217 offset:5376
    v_mul_f32 v164, v164, v156
    v_mul_f32 v165, v165, v157
    v_mfma_f32_32x32x16_bf16 v[96:111], v[52:55], a[12:15], v[96:111]
    s_add_u32 m0, s53, 36864
    ds_read_b64_tr_b16 v[48:49], v217 offset:6144
    buffer_load_dwordx4 v209, s[36:39], s52 offen lds
    v_mfma_f32_32x32x16_bf16 v[112:127], v[52:55], a[156:159], v[112:127]
    ds_read_b64_tr_b16 v[50:51], v217 offset:6400
    v_mul_f32 v166, v166, v158
    v_mul_f32 v167, v167, v159
    s_waitcnt lgkmcnt(2)
    v_mfma_f32_32x32x16_bf16 v[96:111], v[40:43], a[16:19], v[96:111]
    ds_read_b64_tr_b16 v[52:53], v217 offset:7168
    v_cvt_pk_bf16_f32 v168, v160, v161
    v_cvt_pk_bf16_f32 v169, v162, v163
    v_mfma_f32_32x32x16_bf16 v[112:127], v[40:43], a[160:163], v[112:127]
    ds_read_b64_tr_b16 v[54:55], v217 offset:7424
    v_cvt_pk_bf16_f32 v170, v164, v165
    v_cvt_pk_bf16_f32 v171, v166, v167
    v_mfma_f32_32x32x16_bf16 v[96:111], v[44:47], a[20:23], v[96:111]
    ds_read_b64_tr_b16 v[40:41], v217 offset:8192
    buffer_store_dwordx4 v[168:171], v2, s[24:27], s47 offen sc1
    s_add_u32 s58, s58, 1
    v_mfma_f32_32x32x16_bf16 v[112:127], v[44:47], a[164:167], v[112:127]
    ds_read_b64_tr_b16 v[42:43], v217 offset:8448
    v_mul_f32 v128, s59, v64
    v_mul_f32 v129, s59, v65
    s_waitcnt lgkmcnt(2)
    v_mfma_f32_32x32x16_bf16 v[96:111], v[48:51], a[24:27], v[96:111]
    s_add_u32 s52, s52, 589824
    s_add_u32 s53, s53, 4096
    s_add_u32 m0, s53, 0
    ds_read_b64_tr_b16 v[44:45], v217 offset:9216
    buffer_load_dwordx4 v208, s[32:35], s52 offen lds
    v_mfma_f32_32x32x16_bf16 v[112:127], v[48:51], a[168:171], v[112:127]
    ds_read_b64_tr_b16 v[46:47], v217 offset:9472
    v_mul_f32 v130, s59, v66
    v_mul_f32 v131, s59, v67
    v_mfma_f32_32x32x16_bf16 v[96:111], v[52:55], a[28:31], v[96:111]
    ds_read_b64_tr_b16 v[48:49], v217 offset:10240
    v_mul_f32 v132, s59, v68
    v_mul_f32 v133, s59, v69
    v_mfma_f32_32x32x16_bf16 v[112:127], v[52:55], a[172:175], v[112:127]
    ds_read_b64_tr_b16 v[50:51], v217 offset:10496
    v_mul_f32 v134, s59, v70
    v_mul_f32 v135, s59, v71
    s_waitcnt lgkmcnt(2)
    v_mfma_f32_32x32x16_bf16 v[96:111], v[40:43], a[32:35], v[96:111]
    ds_read_b64_tr_b16 v[52:53], v217 offset:11264
    v_exp_f32 v128, v128
    v_exp_f32 v129, v129
    v_mfma_f32_32x32x16_bf16 v[112:127], v[40:43], a[176:179], v[112:127]
    ds_read_b64_tr_b16 v[54:55], v217 offset:11520
    v_exp_f32 v130, v130
    v_exp_f32 v131, v131
    v_mfma_f32_32x32x16_bf16 v[96:111], v[44:47], a[36:39], v[96:111]
    s_add_u32 m0, s53, 36864
    ds_read_b64_tr_b16 v[40:41], v217 offset:12288
    buffer_load_dwordx4 v209, s[36:39], s52 offen lds
    v_mfma_f32_32x32x16_bf16 v[112:127], v[44:47], a[180:183], v[112:127]
    ds_read_b64_tr_b16 v[42:43], v217 offset:12544
    v_exp_f32 v132, v132
    v_exp_f32 v133, v133
    s_waitcnt lgkmcnt(2)
    v_mfma_f32_32x32x16_bf16 v[96:111], v[48:51], a[40:43], v[96:111]
    ds_read_b64_tr_b16 v[44:45], v217 offset:13312
    v_exp_f32 v134, v134
    v_exp_f32 v135, v135
    v_mfma_f32_32x32x16_bf16 v[112:127], v[48:51], a[184:187], v[112:127]
    ds_read_b64_tr_b16 v[46:47], v217 offset:13568
    v_mul_f32 v136, v64, v72
    v_mul_f32 v137, v65, v73
    v_mul_f32 v138, v66, v74
    v_mfma_f32_32x32x16_bf16 v[96:111], v[52:55], a[44:47], v[96:111]
    ds_read_b64_tr_b16 v[48:49], v217 offset:14336
    v_mul_f32 v139, v67, v75
    v_mul_f32 v140, v68, v76
    v_mfma_f32_32x32x16_bf16 v[112:127], v[52:55], a[188:191], v[112:127]
    ds_read_b64_tr_b16 v[50:51], v217 offset:14592
    v_mul_f32 v141, v69, v77
    v_mul_f32 v142, v70, v78
    s_waitcnt lgkmcnt(2)
    v_mfma_f32_32x32x16_bf16 v[96:111], v[40:43], a[48:51], v[96:111]
    s_add_u32 s52, s52, 589824
    s_add_u32 s53, s53, 4096
    s_add_u32 m0, s53, 0
    ds_read_b64_tr_b16 v[52:53], v217 offset:15360
    buffer_load_dwordx4 v208, s[32:35], s52 offen lds
    v_mfma_f32_32x32x16_bf16 v[112:127], v[40:43], a[192:195], v[112:127]
    ds_read_b64_tr_b16 v[54:55], v217 offset:15616
    v_mul_f32 v143, v71, v79
    v_add_f32 v128, 1.0, v128
    v_mfma_f32_32x32x16_bf16 v[96:111], v[44:47], a[52:55], v[96:111]
    ds_read_b64_tr_b16 v[40:41], v217 offset:16384
    v_add_f32 v129, 1.0, v129
    v_add_f32 v130, 1.0, v130
    v_mfma_f32_32x32x16_bf16 v[112:127], v[44:47], a[196:199], v[112:127]
    ds_read_b64_tr_b16 v[42:43], v217 offset:16640
    v_add_f32 v131, 1.0, v131
    v_add_f32 v132, 1.0, v132
    s_waitcnt lgkmcnt(2)
    v_mfma_f32_32x32x16_bf16 v[96:111], v[48:51], a[56:59], v[96:111]
    ds_read_b64_tr_b16 v[44:45], v217 offset:17408
    v_add_f32 v133, 1.0, v133
    v_add_f32 v134, 1.0, v134
    v_mfma_f32_32x32x16_bf16 v[112:127], v[48:51], a[200:203], v[112:127]
    ds_read_b64_tr_b16 v[46:47], v217 offset:17664
    v_add_f32 v135, 1.0, v135
    v_rcp_f32 v128, v128
    v_mfma_f32_32x32x16_bf16 v[96:111], v[52:55], a[60:63], v[96:111]
    s_add_u32 m0, s53, 36864
    ds_read_b64_tr_b16 v[48:49], v217 offset:18432
    buffer_load_dwordx4 v209, s[36:39], s52 offen lds
    v_mfma_f32_32x32x16_bf16 v[112:127], v[52:55], a[204:207], v[112:127]
    ds_read_b64_tr_b16 v[50:51], v217 offset:18688
    v_rcp_f32 v129, v129
    v_rcp_f32 v130, v130
    s_waitcnt lgkmcnt(2)
    v_mfma_f32_32x32x16_bf16 v[96:111], v[40:43], a[64:67], v[96:111]
    ds_read_b64_tr_b16 v[52:53], v217 offset:19456
    v_rcp_f32 v131, v131
    v_rcp_f32 v132, v132
    v_mfma_f32_32x32x16_bf16 v[112:127], v[40:43], a[208:211], v[112:127]
    ds_read_b64_tr_b16 v[54:55], v217 offset:19712
    v_rcp_f32 v133, v133
    v_rcp_f32 v134, v134
    v_mfma_f32_32x32x16_bf16 v[96:111], v[44:47], a[68:71], v[96:111]
    ds_read_b64_tr_b16 v[40:41], v217 offset:20480
    v_rcp_f32 v135, v135
    s_lshl_b32 s46, s58, 10
    v_mfma_f32_32x32x16_bf16 v[112:127], v[44:47], a[212:215], v[112:127]
    ds_read_b64_tr_b16 v[42:43], v217 offset:20736
    s_add_u32 s46, s46, s56
    v_mul_f32 v136, v136, v128
    s_waitcnt lgkmcnt(2)
    v_mfma_f32_32x32x16_bf16 v[96:111], v[48:51], a[72:75], v[96:111]
    ds_read_b64_tr_b16 v[44:45], v217 offset:21504
    v_mul_f32 v137, v137, v129
    v_mul_f32 v138, v138, v130
    v_mfma_f32_32x32x16_bf16 v[112:127], v[48:51], a[216:219], v[112:127]
    ds_read_b64_tr_b16 v[46:47], v217 offset:21760
    v_mul_f32 v139, v139, v131
    v_mul_f32 v140, v140, v132
    v_mfma_f32_32x32x16_bf16 v[96:111], v[52:55], a[76:79], v[96:111]
    ds_read_b64_tr_b16 v[48:49], v217 offset:22528
    v_mul_f32 v141, v141, v133
    v_mul_f32 v142, v142, v134
    v_mul_f32 v143, v143, v135
    v_mfma_f32_32x32x16_bf16 v[112:127], v[52:55], a[220:223], v[112:127]
    ds_read_b64_tr_b16 v[50:51], v217 offset:22784
    v_cvt_pk_bf16_f32 v144, v136, v137
    v_cvt_pk_bf16_f32 v145, v138, v139
    s_waitcnt lgkmcnt(2)
    v_mfma_f32_32x32x16_bf16 v[96:111], v[40:43], a[80:83], v[96:111]
    ds_read_b64_tr_b16 v[52:53], v217 offset:23552
    v_cvt_pk_bf16_f32 v146, v140, v141
    v_cvt_pk_bf16_f32 v147, v142, v143
    v_mfma_f32_32x32x16_bf16 v[112:127], v[40:43], a[224:227], v[112:127]
    ds_read_b64_tr_b16 v[54:55], v217 offset:23808
    buffer_store_dwordx4 v[144:147], v2, s[24:27], s46 offen sc1
    v_mul_f32 v152, s59, v80
    v_mfma_f32_32x32x16_bf16 v[96:111], v[44:47], a[84:87], v[96:111]
    ds_read_b64_tr_b16 v[40:41], v217 offset:24576
    v_mul_f32 v153, s59, v81
    v_mul_f32 v154, s59, v82
    v_mfma_f32_32x32x16_bf16 v[112:127], v[44:47], a[228:231], v[112:127]
    ds_read_b64_tr_b16 v[42:43], v217 offset:24832
    v_mul_f32 v155, s59, v83
    v_mul_f32 v156, s59, v84
    s_waitcnt lgkmcnt(2)
    v_mfma_f32_32x32x16_bf16 v[96:111], v[48:51], a[88:91], v[96:111]
    ds_read_b64_tr_b16 v[44:45], v217 offset:25600
    v_mul_f32 v157, s59, v85
    v_mul_f32 v158, s59, v86
    v_mfma_f32_32x32x16_bf16 v[112:127], v[48:51], a[232:235], v[112:127]
    ds_read_b64_tr_b16 v[46:47], v217 offset:25856
    v_mul_f32 v159, s59, v87
    v_exp_f32 v152, v152
    v_mfma_f32_32x32x16_bf16 v[96:111], v[52:55], a[92:95], v[96:111]
    ds_read_b64_tr_b16 v[48:49], v217 offset:26624
    v_exp_f32 v153, v153
    v_exp_f32 v154, v154
    v_mfma_f32_32x32x16_bf16 v[112:127], v[52:55], a[236:239], v[112:127]
    ds_read_b64_tr_b16 v[50:51], v217 offset:26880
    v_exp_f32 v155, v155
    v_exp_f32 v156, v156
    s_waitcnt lgkmcnt(2)
    v_mfma_f32_32x32x16_bf16 v[96:111], v[40:43], a[96:99], v[96:111]
    ds_read_b64_tr_b16 v[52:53], v217 offset:27648
    v_exp_f32 v157, v157
    v_exp_f32 v158, v158
    v_mfma_f32_32x32x16_bf16 v[112:127], v[40:43], a[240:243], v[112:127]
    ds_read_b64_tr_b16 v[54:55], v217 offset:27904
    v_exp_f32 v159, v159
    v_mul_f32 v160, v80, v88
    v_mfma_f32_32x32x16_bf16 v[96:111], v[44:47], a[100:103], v[96:111]
    ds_read_b64_tr_b16 v[40:41], v217 offset:28672
    v_mul_f32 v161, v81, v89
    v_mul_f32 v162, v82, v90
    v_mfma_f32_32x32x16_bf16 v[112:127], v[44:47], a[244:247], v[112:127]
    ds_read_b64_tr_b16 v[42:43], v217 offset:28928
    v_mul_f32 v163, v83, v91
    v_mul_f32 v164, v84, v92
    s_waitcnt lgkmcnt(2)
    v_mfma_f32_32x32x16_bf16 v[96:111], v[48:51], a[104:107], v[96:111]
    ds_read_b64_tr_b16 v[44:45], v217 offset:29696
    v_mul_f32 v165, v85, v93
    v_mul_f32 v166, v86, v94
    v_mfma_f32_32x32x16_bf16 v[112:127], v[48:51], a[248:251], v[112:127]
    ds_read_b64_tr_b16 v[46:47], v217 offset:29952
    v_mul_f32 v167, v87, v95
    v_add_f32 v152, 1.0, v152
    v_add_f32 v153, 1.0, v153
    v_mfma_f32_32x32x16_bf16 v[96:111], v[52:55], a[108:111], v[96:111]
    ds_read_b64_tr_b16 v[48:49], v217 offset:30720
    v_add_f32 v154, 1.0, v154
    v_add_f32 v155, 1.0, v155
    v_mfma_f32_32x32x16_bf16 v[112:127], v[52:55], a[252:255], v[112:127]
    ds_read_b64_tr_b16 v[50:51], v217 offset:30976
    s_waitcnt vmcnt(8)
    s_mov_b64 exec, 255
    v_cmp_ne_u32 vcc, s44, v4
    v_cmp_ne_u32 s[48:49], s45, v5
    s_nop 0
    s_or_b64 vcc, vcc, s[48:49]
    s_nop 1
    s_cbranch_vccnz L_pslow_16
L_pback_17:
    s_mov_b64 exec, -1
    v_add_f32 v156, 1.0, v156
    v_add_f32 v157, 1.0, v157
    s_waitcnt lgkmcnt(2)
    v_mfma_f32_32x32x16_bf16 v[96:111], v[40:43], a[112:115], v[96:111]
    ds_read_b64_tr_b16 v[52:53], v217 offset:31744
    v_add_f32 v158, 1.0, v158
    v_add_f32 v159, 1.0, v159
    v_mfma_f32_32x32x16_bf16 v[112:127], v[40:43], v[224:227], v[112:127]
    ds_read_b64_tr_b16 v[54:55], v217 offset:32000
    v_rcp_f32 v152, v152
    v_rcp_f32 v153, v153
    v_mfma_f32_32x32x16_bf16 v[96:111], v[44:47], a[116:119], v[96:111]
    ds_read_b64_tr_b16 v[40:41], v217 offset:32768
    v_rcp_f32 v154, v154
    v_rcp_f32 v155, v155
    v_mfma_f32_32x32x16_bf16 v[112:127], v[44:47], v[228:231], v[112:127]
    ds_read_b64_tr_b16 v[42:43], v217 offset:33024
    v_rcp_f32 v156, v156
    v_rcp_f32 v157, v157
    s_waitcnt lgkmcnt(2)
    v_mfma_f32_32x32x16_bf16 v[96:111], v[48:51], a[120:123], v[96:111]
    ds_read_b64_tr_b16 v[44:45], v217 offset:33792
    v_rcp_f32 v158, v158
    v_rcp_f32 v159, v159
    v_mfma_f32_32x32x16_bf16 v[112:127], v[48:51], v[232:235], v[112:127]
    ds_read_b64_tr_b16 v[46:47], v217 offset:34048
    s_lshl_b32 s47, s58, 10
    s_add_u32 s47, s47, s57
    v_mfma_f32_32x32x16_bf16 v[96:111], v[52:55], a[124:127], v[96:111]
    ds_read_b64_tr_b16 v[48:49], v217 offset:34816
    v_mul_f32 v160, v160, v152
    v_mul_f32 v161, v161, v153
    v_mfma_f32_32x32x16_bf16 v[112:127], v[52:55], v[236:239], v[112:127]
    ds_read_b64_tr_b16 v[50:51], v217 offset:35072
    v_mul_f32 v162, v162, v154
    v_mul_f32 v163, v163, v155
    s_waitcnt lgkmcnt(2)
    v_mfma_f32_32x32x16_bf16 v[96:111], v[40:43], a[128:131], v[96:111]
    ds_read_b64_tr_b16 v[52:53], v217 offset:35840
    v_mul_f32 v164, v164, v156
    v_mul_f32 v165, v165, v157
    v_mfma_f32_32x32x16_bf16 v[112:127], v[40:43], v[240:243], v[112:127]
    ds_read_b64_tr_b16 v[54:55], v217 offset:36096
    v_mul_f32 v166, v166, v158
    v_mul_f32 v167, v167, v159
    v_mfma_f32_32x32x16_bf16 v[96:111], v[44:47], a[132:135], v[96:111]
    v_cvt_pk_bf16_f32 v168, v160, v161
    v_cvt_pk_bf16_f32 v169, v162, v163
    v_mfma_f32_32x32x16_bf16 v[112:127], v[44:47], v[244:247], v[112:127]
    v_cvt_pk_bf16_f32 v170, v164, v165
    v_cvt_pk_bf16_f32 v171, v166, v167
    s_waitcnt lgkmcnt(0)
    v_mfma_f32_32x32x16_bf16 v[96:111], v[48:51], a[136:139], v[96:111]
    buffer_store_dwordx4 v[168:171], v2, s[24:27], s47 offen sc1
    s_add_u32 s58, s58, 1
    v_mfma_f32_32x32x16_bf16 v[112:127], v[48:51], v[248:251], v[112:127]
    s_waitcnt vmcnt(2)
    s_barrier
    ds_read_b64_tr_b16 v[40:41], v216 offset:0
    ds_read_b64_tr_b16 v[42:43], v216 offset:256
    ds_read_b64_tr_b16 v[44:45], v216 offset:1024
    ds_read_b64_tr_b16 v[46:47], v216 offset:1280
    ds_read_b64_tr_b16 v[48:49], v216 offset:2048
    ds_read_b64_tr_b16 v[50:51], v216 offset:2304
    v_mfma_f32_32x32x16_bf16 v[96:111], v[52:55], a[140:143], v[96:111]
    v_mfma_f32_32x32x16_bf16 v[112:127], v[52:55], v[252:255], v[112:127]
    s_lshl_b32 s65, s41, 16
    s_add_u32 s65, s65, 4489216
    s_lshl_b32 s66, s41, 13
    s_add_u32 s66, s66, 6848512
    s_mul_i32 s67, s41, 81920
    s_add_u32 s67, s67, 7110656
    s_waitcnt lgkmcnt(2)
    v_mfma_f32_32x32x16_bf16 v[176:191], v[40:43], a[0:3], 0
    s_mov_b32 s49, s42
    s_lshl_b32 s48, s49, 10
    s_add_u32 m0, s48, 0
    s_add_u32 s48, s48, s65
    ds_read_b64_tr_b16 v[52:53], v216 offset:3072
    buffer_load_dwordx4 v2, s[24:27], s48 offen sc1 lds
    v_mfma_f32_32x32x16_bf16 v[192:207], v[40:43], a[144:147], 0
    ds_read_b64_tr_b16 v[54:55], v216 offset:3328
    v_mul_f32 v128, s59, v96
    v_mul_f32 v129, s59, v97
    v_mul_f32 v130, s59, v98
    v_mfma_f32_32x32x16_bf16 v[176:191], v[44:47], a[4:7], v[176:191]
    ds_read_b64_tr_b16 v[40:41], v216 offset:4096
    v_mul_f32 v131, s59, v99
    v_mul_f32 v132, s59, v100
    v_mfma_f32_32x32x16_bf16 v[192:207], v[44:47], a[148:151], v[192:207]
    s_mov_b32 s49, s42
    s_lshl_b32 s48, s49, 10
    s_add_u32 m0, s48, 73728
    s_add_u32 s48, s48, s67
    ds_read_b64_tr_b16 v[42:43], v216 offset:4352
    buffer_load_dwordx4 v2, s[24:27], s48 offen sc1 lds
    s_waitcnt lgkmcnt(2)
    v_mfma_f32_32x32x16_bf16 v[176:191], v[48:51], a[8:11], v[176:191]
    ds_read_b64_tr_b16 v[44:45], v216 offset:5120
    v_mul_f32 v133, s59, v101
    v_mul_f32 v134, s59, v102
    v_mul_f32 v135, s59, v103
    v_mfma_f32_32x32x16_bf16 v[192:207], v[48:51], a[152:155], v[192:207]
    ds_read_b64_tr_b16 v[46:47], v216 offset:5376
    v_exp_f32 v128, v128
    v_exp_f32 v129, v129
    v_mfma_f32_32x32x16_bf16 v[176:191], v[52:55], a[12:15], v[176:191]
    s_mov_b32 s49, s42
    s_lshl_b32 s48, s49, 10
    s_add_u32 m0, s48, 65536
    s_add_u32 s48, s48, s66
    ds_read_b64_tr_b16 v[48:49], v216 offset:6144
    buffer_load_dwordx4 v2, s[24:27], s48 offen sc1 lds
    v_mfma_f32_32x32x16_bf16 v[192:207], v[52:55], a[156:159], v[192:207]
    ds_read_b64_tr_b16 v[50:51], v216 offset:6400
    v_exp_f32 v130, v130
    v_exp_f32 v131, v131
    v_exp_f32 v132, v132
    s_waitcnt lgkmcnt(2)
    v_mfma_f32_32x32x16_bf16 v[176:191], v[40:43], a[16:19], v[176:191]
    ds_read_b64_tr_b16 v[52:53], v216 offset:7168
    v_exp_f32 v133, v133
    v_exp_f32 v134, v134
    v_mfma_f32_32x32x16_bf16 v[192:207], v[40:43], a[160:163], v[192:207]
    s_add_u32 s49, s42, 4
    s_lshl_b32 s48, s49, 10
    s_add_u32 m0, s48, 0
    s_add_u32 s48, s48, s65
    ds_read_b64_tr_b16 v[54:55], v216 offset:7424
    buffer_load_dwordx4 v2, s[24:27], s48 offen sc1 lds
    v_mfma_f32_32x32x16_bf16 v[176:191], v[44:47], a[20:23], v[176:191]
    ds_read_b64_tr_b16 v[40:41], v216 offset:8192
    v_exp_f32 v135, v135
    v_mul_f32 v136, v96, v104
    v_mul_f32 v137, v97, v105
    v_mfma_f32_32x32x16_bf16 v[192:207], v[44:47], a[164:167], v[192:207]
    ds_read_b64_tr_b16 v[42:43], v216 offset:8448
    v_mul_f32 v138, v98, v106
    v_mul_f32 v139, v99, v107
    s_waitcnt lgkmcnt(2)
    v_mfma_f32_32x32x16_bf16 v[176:191], v[48:51], a[24:27], v[176:191]
    s_add_u32 s49, s42, 4
    s_lshl_b32 s48, s49, 10
    s_add_u32 m0, s48, 73728
    s_add_u32 s48, s48, s67
    ds_read_b64_tr_b16 v[44:45], v216 offset:9216
    buffer_load_dwordx4 v2, s[24:27], s48 offen sc1 lds
    v_mfma_f32_32x32x16_bf16 v[192:207], v[48:51], a[168:171], v[192:207]
    ds_read_b64_tr_b16 v[46:47], v216 offset:9472
    v_mul_f32 v140, v100, v108
    v_mul_f32 v141, v101, v109
    v_mul_f32 v142, v102, v110
    v_mfma_f32_32x32x16_bf16 v[176:191], v[52:55], a[28:31], v[176:191]
    ds_read_b64_tr_b16 v[48:49], v216 offset:10240
    v_mul_f32 v143, v103, v111
    v_add_f32 v128, 1.0, v128
    v_mfma_f32_32x32x16_bf16 v[192:207], v[52:55], a[172:175], v[192:207]
    s_add_u32 s49, s42, 8
    s_min_u32 s49, s49, 9
    s_lshl_b32 s48, s49, 10
    s_add_u32 m0, s48, 73728
    s_add_u32 s48, s48, s67
    ds_read_b64_tr_b16 v[50:51], v216 offset:10496
    buffer_load_dwordx4 v2, s[24:27], s48 offen sc1 lds
    s_waitcnt lgkmcnt(2)
    v_mfma_f32_32x32x16_bf16 v[176:191], v[40:43], a[32:35], v[176:191]
    ds_read_b64_tr_b16 v[52:53], v216 offset:11264
    v_add_f32 v129, 1.0, v129
    v_add_f32 v130, 1.0, v130
    v_add_f32 v131, 1.0, v131
    v_mfma_f32_32x32x16_bf16 v[192:207], v[40:43], a[176:179], v[192:207]
    ds_read_b64_tr_b16 v[54:55], v216 offset:11520
    v_add_f32 v132, 1.0, v132
    v_add_f32 v133, 1.0, v133
    v_mfma_f32_32x32x16_bf16 v[176:191], v[44:47], a[36:39], v[176:191]
    s_lshl_b32 s49, s41, 6
    s_add_u32 s49, s49, s50
    s_lshl_b32 s49, s49, 10
    s_add_u32 s49, s49, 2392064
    ds_read_b64_tr_b16 v[40:41], v216 offset:12288
    buffer_load_dwordx4 v[24:27], v2, s[24:27], s49 offen sc1
    v_mfma_f32_32x32x16_bf16 v[192:207], v[44:47], a[180:183], v[192:207]
    ds_read_b64_tr_b16 v[42:43], v216 offset:12544
    v_add_f32 v134, 1.0, v134
    v_add_f32 v135, 1.0, v135
    v_rcp_f32 v128, v128
    s_waitcnt lgkmcnt(2)
    v_mfma_f32_32x32x16_bf16 v[176:191], v[48:51], a[40:43], v[176:191]
    ds_read_b64_tr_b16 v[44:45], v216 offset:13312
    v_rcp_f32 v129, v129
    v_rcp_f32 v130, v130
    v_mfma_f32_32x32x16_bf16 v[192:207], v[48:51], a[184:187], v[192:207]
    ds_read_b64_tr_b16 v[46:47], v216 offset:13568
    buffer_load_dwordx4 v[28:31], v2, s[24:27], s49 offen offset:1024 sc1
    v_mfma_f32_32x32x16_bf16 v[176:191], v[52:55], a[44:47], v[176:191]
    ds_read_b64_tr_b16 v[48:49], v216 offset:14336
    v_rcp_f32 v131, v131
    v_rcp_f32 v132, v132
    v_mfma_f32_32x32x16_bf16 v[192:207], v[52:55], a[188:191], v[192:207]
    ds_read_b64_tr_b16 v[50:51], v216 offset:14592
    v_rcp_f32 v133, v133
    v_rcp_f32 v134, v134
    v_rcp_f32 v135, v135
    s_waitcnt lgkmcnt(2)
    v_mfma_f32_32x32x16_bf16 v[176:191], v[40:43], a[48:51], v[176:191]
    v_lshlrev_b32 v12, 2, v0
    s_lshl_b32 s49, s41, 13
    s_lshl_b32 s48, s50, 7
    s_add_u32 s49, s49, s48
    s_add_u32 s49, s49, 6586368
    ds_read_b64_tr_b16 v[52:53], v216 offset:15360
    buffer_load_dword v32, v12, s[24:27], s49 offen sc1
    v_mfma_f32_32x32x16_bf16 v[192:207], v[40:43], a[192:195], v[192:207]
    ds_read_b64_tr_b16 v[54:55], v216 offset:15616
    s_lshl_b32 s46, s58, 10
    s_add_u32 s46, s46, s56
    v_mfma_f32_32x32x16_bf16 v[176:191], v[44:47], a[52:55], v[176:191]
    ds_read_b64_tr_b16 v[40:41], v216 offset:16384
    v_mul_f32 v136, v136, v128
    v_mul_f32 v137, v137, v129
    v_mul_f32 v138, v138, v130
    v_mfma_f32_32x32x16_bf16 v[192:207], v[44:47], a[196:199], v[192:207]
    s_add_u32 s49, s42, 8
    s_lshl_b32 s48, s49, 10
    s_add_u32 m0, s48, 0
    s_add_u32 s48, s48, s65
    ds_read_b64_tr_b16 v[42:43], v216 offset:16640
    buffer_load_dwordx4 v2, s[24:27], s48 offen sc1 lds
    s_waitcnt lgkmcnt(2)
    v_mfma_f32_32x32x16_bf16 v[176:191], v[48:51], a[56:59], v[176:191]
    ds_read_b64_tr_b16 v[44:45], v216 offset:17408
    v_mul_f32 v139, v139, v131
    v_mul_f32 v140, v140, v132
    v_mfma_f32_32x32x16_bf16 v[192:207], v[48:51], a[200:203], v[192:207]
    ds_read_b64_tr_b16 v[46:47], v216 offset:17664
    v_mul_f32 v141, v141, v133
    v_mul_f32 v142, v142, v134
    v_mul_f32 v143, v143, v135
    v_mfma_f32_32x32x16_bf16 v[176:191], v[52:55], a[60:63], v[176:191]
    s_add_u32 s49, s42, 12
    s_lshl_b32 s48, s49, 10
    s_add_u32 m0, s48, 0
    s_add_u32 s48, s48, s65
    ds_read_b64_tr_b16 v[48:49], v216 offset:18432
    buffer_load_dwordx4 v2, s[24:27], s48 offen sc1 lds
    v_mfma_f32_32x32x16_bf16 v[192:207], v[52:55], a[204:207], v[192:207]
    ds_read_b64_tr_b16 v[50:51], v216 offset:18688
    v_cvt_pk_bf16_f32 v144, v136, v137
    v_cvt_pk_bf16_f32 v145, v138, v139
    s_waitcnt lgkmcnt(2)
    v_mfma_f32_32x32x16_bf16 v[176:191], v[40:43], a[64:67], v[176:191]
    ds_read_b64_tr_b16 v[52:53], v216 offset:19456
    v_cvt_pk_bf16_f32 v146, v140, v141
    v_cvt_pk_bf16_f32 v147, v142, v143
    buffer_store_dwordx4 v[144:147], v2, s[24:27], s46 offen sc1
    v_mfma_f32_32x32x16_bf16 v[192:207], v[40:43], a[208:211], v[192:207]
    s_add_u32 s49, s42, 16
    s_lshl_b32 s48, s49, 10
    s_add_u32 m0, s48, 0
    s_add_u32 s48, s48, s65
    ds_read_b64_tr_b16 v[54:55], v216 offset:19712
    buffer_load_dwordx4 v2, s[24:27], s48 offen sc1 lds
    v_mfma_f32_32x32x16_bf16 v[176:191], v[44:47], a[68:71], v[176:191]
    ds_read_b64_tr_b16 v[40:41], v216 offset:20480
    v_mul_f32 v152, s59, v112
    v_mul_f32 v153, s59, v113
    v_mfma_f32_32x32x16_bf16 v[192:207], v[44:47], a[212:215], v[192:207]
    ds_read_b64_tr_b16 v[42:43], v216 offset:20736
    v_mul_f32 v154, s59, v114
    v_mul_f32 v155, s59, v115
    v_mul_f32 v156, s59, v116
    s_waitcnt lgkmcnt(2)
    v_mfma_f32_32x32x16_bf16 v[176:191], v[48:51], a[72:75], v[176:191]
    s_add_u32 s49, s42, 20
    s_lshl_b32 s48, s49, 10
    s_add_u32 m0, s48, 0
    s_add_u32 s48, s48, s65
    ds_read_b64_tr_b16 v[44:45], v216 offset:21504
    buffer_load_dwordx4 v2, s[24:27], s48 offen sc1 lds
    v_mfma_f32_32x32x16_bf16 v[192:207], v[48:51], a[216:219], v[192:207]
    ds_read_b64_tr_b16 v[46:47], v216 offset:21760
    v_mul_f32 v157, s59, v117
    v_mul_f32 v158, s59, v118
    v_mfma_f32_32x32x16_bf16 v[176:191], v[52:55], a[76:79], v[176:191]
    ds_read_b64_tr_b16 v[48:49], v216 offset:22528
    v_mul_f32 v159, s59, v119
    v_exp_f32 v152, v152
    v_exp_f32 v153, v153
    v_mfma_f32_32x32x16_bf16 v[192:207], v[52:55], a[220:223], v[192:207]
    s_add_u32 s49, s42, 24
    s_lshl_b32 s48, s49, 10
    s_add_u32 m0, s48, 0
    s_add_u32 s48, s48, s65
    ds_read_b64_tr_b16 v[50:51], v216 offset:22784
    buffer_load_dwordx4 v2, s[24:27], s48 offen sc1 lds
    s_waitcnt lgkmcnt(2)
    v_mfma_f32_32x32x16_bf16 v[176:191], v[40:43], a[80:83], v[176:191]
    ds_read_b64_tr_b16 v[52:53], v216 offset:23552
    v_exp_f32 v154, v154
    v_exp_f32 v155, v155
    v_mfma_f32_32x32x16_bf16 v[192:207], v[40:43], a[224:227], v[192:207]
    ds_read_b64_tr_b16 v[54:55], v216 offset:23808
    v_exp_f32 v156, v156
    v_exp_f32 v157, v157
    v_exp_f32 v158, v158
    v_mfma_f32_32x32x16_bf16 v[176:191], v[44:47], a[84:87], v[176:191]
    s_add_u32 s49, s42, 28
    s_lshl_b32 s48, s49, 10
    s_add_u32 m0, s48, 0
    s_add_u32 s48, s48, s65
    ds_read_b64_tr_b16 v[40:41], v216 offset:24576
    buffer_load_dwordx4 v2, s[24:27], s48 offen sc1 lds
    v_mfma_f32_32x32x16_bf16 v[192:207], v[44:47], a[228:231], v[192:207]
    ds_read_b64_tr_b16 v[42:43], v216 offset:24832
    v_exp_f32 v159, v159
    v_mul_f32 v160, v112, v120
    s_waitcnt lgkmcnt(2)
    v_mfma_f32_32x32x16_bf16 v[176:191], v[48:51], a[88:91], v[176:191]
    ds_read_b64_tr_b16 v[44:45], v216 offset:25600
    v_mul_f32 v161, v113, v121
    v_mul_f32 v162, v114, v122
    v_mfma_f32_32x32x16_bf16 v[192:207], v[48:51], a[232:235], v[192:207]
    s_add_u32 s49, s42, 32
    s_lshl_b32 s48, s49, 10
    s_add_u32 m0, s48, 0
    s_add_u32 s48, s48, s65
    ds_read_b64_tr_b16 v[46:47], v216 offset:25856
    buffer_load_dwordx4 v2, s[24:27], s48 offen sc1 lds
    v_mfma_f32_32x32x16_bf16 v[176:191], v[52:55], a[92:95], v[176:191]
    ds_read_b64_tr_b16 v[48:49], v216 offset:26624
    v_mul_f32 v163, v115, v123
    v_mul_f32 v164, v116, v124
    v_mul_f32 v165, v117, v125
    v_mfma_f32_32x32x16_bf16 v[192:207], v[52:55], a[236:239], v[192:207]
    ds_read_b64_tr_b16 v[50:51], v216 offset:26880
    v_mul_f32 v166, v118, v126
    v_mul_f32 v167, v119, v127
    s_waitcnt lgkmcnt(2)
    v_mfma_f32_32x32x16_bf16 v[176:191], v[40:43], a[96:99], v[176:191]
    s_add_u32 s49, s42, 36
    s_lshl_b32 s48, s49, 10
    s_add_u32 m0, s48, 0
    s_add_u32 s48, s48, s65
    ds_read_b64_tr_b16 v[52:53], v216 offset:27648
    buffer_load_dwordx4 v2, s[24:27], s48 offen sc1 lds
    v_mfma_f32_32x32x16_bf16 v[192:207], v[40:43], a[240:243], v[192:207]
    ds_read_b64_tr_b16 v[54:55], v216 offset:27904
    v_add_f32 v152, 1.0, v152
    v_add_f32 v153, 1.0, v153
    v_add_f32 v154, 1.0, v154
    v_mfma_f32_32x32x16_bf16 v[176:191], v[44:47], a[100:103], v[176:191]
    ds_read_b64_tr_b16 v[40:41], v216 offset:28672
    v_add_f32 v155, 1.0, v155
    v_add_f32 v156, 1.0, v156
    v_mfma_f32_32x32x16_bf16 v[192:207], v[44:47], a[244:247], v[192:207]
    s_add_u32 s49, s42, 40
    s_lshl_b32 s48, s49, 10
    s_add_u32 m0, s48, 0
    s_add_u32 s48, s48, s65
    ds_read_b64_tr_b16 v[42:43], v216 offset:28928
    buffer_load_dwordx4 v2, s[24:27], s48 offen sc1 lds
    s_waitcnt lgkmcnt(2)
    v_mfma_f32_32x32x16_bf16 v[176:191], v[48:51], a[104:107], v[176:191]
    ds_read_b64_tr_b16 v[44:45], v216 offset:29696
    v_add_f32 v157, 1.0, v157
    v_add_f32 v158, 1.0, v158
    v_add_f32 v159, 1.0, v159
    v_mfma_f32_32x32x16_bf16 v[192:207], v[48:51], a[248:251], v[192:207]
    ds_read_b64_tr_b16 v[46:47], v216 offset:29952
    v_rcp_f32 v152, v152
    v_rcp_f32 v153, v153
    v_mfma_f32_32x32x16_bf16 v[176:191], v[52:55], a[108:111], v[176:191]
    s_add_u32 s49, s42, 44
    s_lshl_b32 s48, s49, 10
    s_add_u32 m0, s48, 0
    s_add_u32 s48, s48, s65
    ds_read_b64_tr_b16 v[48:49], v216 offset:30720
    buffer_load_dwordx4 v2, s[24:27], s48 offen sc1 lds
    v_mfma_f32_32x32x16_bf16 v[192:207], v[52:55], a[252:255], v[192:207]
    ds_read_b64_tr_b16 v[50:51], v216 offset:30976
    v_rcp_f32 v154, v154
    v_rcp_f32 v155, v155
    v_rcp_f32 v156, v156
    s_waitcnt lgkmcnt(2)
    v_mfma_f32_32x32x16_bf16 v[176:191], v[40:43], a[112:115], v[176:191]
    ds_read_b64_tr_b16 v[52:53], v216 offset:31744
    v_rcp_f32 v157, v157
    v_rcp_f32 v158, v158
    v_mfma_f32_32x32x16_bf16 v[192:207], v[40:43], v[224:227], v[192:207]
    s_add_u32 s49, s42, 48
    s_lshl_b32 s48, s49, 10
    s_add_u32 m0, s48, 0
    s_add_u32 s48, s48, s65
    ds_read_b64_tr_b16 v[54:55], v216 offset:32000
    buffer_load_dwordx4 v2, s[24:27], s48 offen sc1 lds
    v_mfma_f32_32x32x16_bf16 v[176:191], v[44:47], a[116:119], v[176:191]
    ds_read_b64_tr_b16 v[40:41], v216 offset:32768
    v_rcp_f32 v159, v159
    s_lshl_b32 s47, s58, 10
    s_add_u32 s47, s47, s57
    v_mfma_f32_32x32x16_bf16 v[192:207], v[44:47], v[228:231], v[192:207]
    ds_read_b64_tr_b16 v[42:43], v216 offset:33024
    v_mul_f32 v160, v160, v152
    v_mul_f32 v161, v161, v153
    s_waitcnt lgkmcnt(2)
    v_mfma_f32_32x32x16_bf16 v[176:191], v[48:51], a[120:123], v[176:191]
    s_add_u32 s49, s42, 52
    s_lshl_b32 s48, s49, 10
    s_add_u32 m0, s48, 0
    s_add_u32 s48, s48, s65
    ds_read_b64_tr_b16 v[44:45], v216 offset:33792
    buffer_load_dwordx4 v2, s[24:27], s48 offen sc1 lds
    v_mfma_f32_32x32x16_bf16 v[192:207], v[48:51], v[232:235], v[192:207]
    ds_read_b64_tr_b16 v[46:47], v216 offset:34048
    v_mul_f32 v162, v162, v154
    v_mul_f32 v163, v163, v155
    v_mul_f32 v164, v164, v156
    v_mfma_f32_32x32x16_bf16 v[176:191], v[52:55], a[124:127], v[176:191]
    ds_read_b64_tr_b16 v[48:49], v216 offset:34816
    v_mul_f32 v165, v165, v157
    v_mul_f32 v166, v166, v158
    v_mfma_f32_32x32x16_bf16 v[192:207], v[52:55], v[236:239], v[192:207]
    s_add_u32 s49, s42, 56
    s_lshl_b32 s48, s49, 10
    s_add_u32 m0, s48, 0
    s_add_u32 s48, s48, s65
    ds_read_b64_tr_b16 v[50:51], v216 offset:35072
    buffer_load_dwordx4 v2, s[24:27], s48 offen sc1 lds
    s_waitcnt lgkmcnt(2)
    v_mfma_f32_32x32x16_bf16 v[176:191], v[40:43], a[128:131], v[176:191]
    ds_read_b64_tr_b16 v[52:53], v216 offset:35840
    v_mul_f32 v167, v167, v159
    v_cvt_pk_bf16_f32 v168, v160, v161
    v_cvt_pk_bf16_f32 v169, v162, v163
    v_mfma_f32_32x32x16_bf16 v[192:207], v[40:43], v[240:243], v[192:207]
    ds_read_b64_tr_b16 v[54:55], v216 offset:36096
    v_cvt_pk_bf16_f32 v170, v164, v165
    v_cvt_pk_bf16_f32 v171, v166, v167
    v_mfma_f32_32x32x16_bf16 v[176:191], v[44:47], a[132:135], v[176:191]
    s_add_u32 s49, s42, 60
    s_lshl_b32 s48, s49, 10
    s_add_u32 m0, s48, 0
    s_add_u32 s48, s48, s65
    buffer_load_dwordx4 v2, s[24:27], s48 offen sc1 lds
    v_mfma_f32_32x32x16_bf16 v[192:207], v[44:47], v[244:247], v[192:207]
    buffer_store_dwordx4 v[168:171], v2, s[24:27], s47 offen sc1
    s_mov_b32 s58, s63
    s_waitcnt lgkmcnt(0)
    v_mfma_f32_32x32x16_bf16 v[176:191], v[48:51], a[136:139], v[176:191]
    v_mfma_f32_32x32x16_bf16 v[192:207], v[48:51], v[248:251], v[192:207]
    s_add_u32 s49, s42, 4
    s_lshl_b32 s48, s49, 10
    s_add_u32 m0, s48, 65536
    s_add_u32 s48, s48, s66
    buffer_load_dwordx4 v2, s[24:27], s48 offen sc1 lds
    v_mfma_f32_32x32x16_bf16 v[176:191], v[52:55], a[140:143], v[176:191]
    v_mfma_f32_32x32x16_bf16 v[192:207], v[52:55], v[252:255], v[192:207]
    s_nop 10
    v_mul_f32 v128, s59, v176
    v_mul_f32 v129, s59, v177
    v_mul_f32 v130, s59, v178
    v_mul_f32 v131, s59, v179
    v_mul_f32 v132, s59, v180
    v_mul_f32 v133, s59, v181
    v_mul_f32 v134, s59, v182
    v_mul_f32 v135, s59, v183
    v_exp_f32 v128, v128
    v_exp_f32 v129, v129
    v_exp_f32 v130, v130
    v_exp_f32 v131, v131
    v_exp_f32 v132, v132
    v_exp_f32 v133, v133
    v_exp_f32 v134, v134
    v_exp_f32 v135, v135
    v_mul_f32 v136, v176, v184
    v_mul_f32 v137, v177, v185
    v_mul_f32 v138, v178, v186
    v_mul_f32 v139, v179, v187
    v_mul_f32 v140, v180, v188
    v_mul_f32 v141, v181, v189
    v_mul_f32 v142, v182, v190
    v_mul_f32 v143, v183, v191
    v_add_f32 v128, 1.0, v128
    v_add_f32 v129, 1.0, v129
    v_add_f32 v130, 1.0, v130
    v_add_f32 v131, 1.0, v131
    v_add_f32 v132, 1.0, v132
    v_add_f32 v133, 1.0, v133
    v_add_f32 v134, 1.0, v134
    v_add_f32 v135, 1.0, v135
    v_rcp_f32 v128, v128
    v_rcp_f32 v129, v129
    v_rcp_f32 v130, v130
    v_rcp_f32 v131, v131
    v_rcp_f32 v132, v132
    v_rcp_f32 v133, v133
    v_rcp_f32 v134, v134
    v_rcp_f32 v135, v135
    s_lshl_b32 s46, s58, 10
    s_add_u32 s46, s46, s56
    v_mul_f32 v136, v136, v128
    v_mul_f32 v137, v137, v129
    v_mul_f32 v138, v138, v130
    v_mul_f32 v139, v139, v131
    v_mul_f32 v140, v140, v132
    v_mul_f32 v141, v141, v133
    v_mul_f32 v142, v142, v134
    v_mul_f32 v143, v143, v135
    v_cvt_pk_bf16_f32 v144, v136, v137
    v_cvt_pk_bf16_f32 v145, v138, v139
    v_cvt_pk_bf16_f32 v146, v140, v141
    v_cvt_pk_bf16_f32 v147, v142, v143
    buffer_store_dwordx4 v[144:147], v2, s[24:27], s46 offen sc1
    v_mul_f32 v152, s59, v192
    v_mul_f32 v153, s59, v193
    v_mul_f32 v154, s59, v194
    v_mul_f32 v155, s59, v195
    v_mul_f32 v156, s59, v196
    v_mul_f32 v157, s59, v197
    v_mul_f32 v158, s59, v198
    v_mul_f32 v159, s59, v199
    v_exp_f32 v152, v152
    v_exp_f32 v153, v153
    v_exp_f32 v154, v154
    v_exp_f32 v155, v155
    v_exp_f32 v156, v156
    v_exp_f32 v157, v157
    v_exp_f32 v158, v158
    v_exp_f32 v159, v159
    v_mul_f32 v160, v192, v200
    v_mul_f32 v161, v193, v201
    v_mul_f32 v162, v194, v202
    v_mul_f32 v163, v195, v203
    v_mul_f32 v164, v196, v204
    v_mul_f32 v165, v197, v205
    v_mul_f32 v166, v198, v206
    v_mul_f32 v167, v199, v207
    v_add_f32 v152, 1.0, v152
    v_add_f32 v153, 1.0, v153
    v_add_f32 v154, 1.0, v154
    v_add_f32 v155, 1.0, v155
    v_add_f32 v156, 1.0, v156
    v_add_f32 v157, 1.0, v157
    v_add_f32 v158, 1.0, v158
    v_add_f32 v159, 1.0, v159
    v_rcp_f32 v152, v152
    v_rcp_f32 v153, v153
    v_rcp_f32 v154, v154
    v_rcp_f32 v155, v155
    v_rcp_f32 v156, v156
    v_rcp_f32 v157, v157
    v_rcp_f32 v158, v158
    v_rcp_f32 v159, v159
    s_lshl_b32 s47, s58, 10
    s_add_u32 s47, s47, s57
    v_mul_f32 v160, v160, v152
    v_mul_f32 v161, v161, v153
    v_mul_f32 v162, v162, v154
    v_mul_f32 v163, v163, v155
    v_mul_f32 v164, v164, v156
    v_mul_f32 v165, v165, v157
    v_mul_f32 v166, v166, v158
    v_mul_f32 v167, v167, v159
    v_cvt_pk_bf16_f32 v168, v160, v161
    v_cvt_pk_bf16_f32 v169, v162, v163
    v_cvt_pk_bf16_f32 v170, v164, v165
    v_cvt_pk_bf16_f32 v171, v166, v167
    buffer_store_dwordx4 v[168:171], v2, s[24:27], s47 offen sc1
    s_waitcnt vmcnt(2)
    s_barrier
    s_add_u32 s53, s42, 10
    s_lshl_b32 s53, s53, 10
    s_add_u32 s52, s53, s67
    s_add_u32 s53, s53, 73728
    v_mov_b32 v33, 0
    v_mov_b32 v57, 0x3f80
    v_mov_b32 v61, 0x3f80
    v_mov_b32 v8, v2
    v_and_b32 v12, 31, v0
    v_lshlrev_b32 v9, 2, v12
    v_add_u32 v9, 65536, v9
    v_min_u32 v13, 19, v12
    v_lshrrev_b32 v14, 5, v0
    v_mul_u32_u24 v14, 320, v14
    v_lshl_add_u32 v10, v13, 4, v14
    v_add_u32 v10, 73728, v10
    ds_read_b128 v[48:51], v8 offset:0
    ds_read_b32 v56, v9 offset:0
    ds_read_b128 v[52:55], v8 offset:1024
    ds_read_b32 v60, v9 offset:128
    ds_read_b128 v[64:67], v10 offset:0
    ds_read_b128 v[68:71], v10 offset:640
    s_waitcnt lgkmcnt(5)
    v_mfma_f32_32x32x16_bf16 v[128:143], v[48:51], v[24:27], 0
    v_mfma_f32_32x32x16_bf16 v[144:159], v[48:51], v[28:31], 0
    s_waitcnt lgkmcnt(4)
    s_nop 8
    v_mfma_f32_32x32x4_2b_bf16 v[128:159], v[56:57], v[32:33], v[128:159]
    s_waitcnt lgkmcnt(3)
    v_mfma_f32_32x32x16_bf16 v[160:175], v[52:55], v[24:27], 0
    v_mfma_f32_32x32x16_bf16 v[176:191], v[52:55], v[28:31], 0
    s_waitcnt lgkmcnt(2)
    s_nop 8
    v_mfma_f32_32x32x4_2b_bf16 v[160:191], v[60:61], v[32:33], v[160:191]
    s_nop 5
    v_max3_f32 v12, v128, v129, v130
    v_max3_f32 v12, v12, v131, v132
    v_max3_f32 v12, v12, v133, v134
    v_max3_f32 v12, v12, v135, v136
    v_max3_f32 v12, v12, v137, v138
    v_max3_f32 v12, v12, v139, v140
    v_max3_f32 v12, v12, v141, v142
    s_nop 6
    v_max3_f32 v12, v12, v143, v160
    v_max3_f32 v12, v12, v161, v162
    v_max3_f32 v12, v12, v163, v164
    v_max3_f32 v12, v12, v165, v166
    v_max3_f32 v12, v12, v167, v168
    v_max3_f32 v12, v12, v169, v170
    v_max3_f32 v12, v12, v171, v172
    v_max3_f32 v12, v12, v173, v174
    v_max_f32 v12, v12, v175
    v_max3_f32 v13, v144, v145, v146
    v_max3_f32 v13, v13, v147, v148
    v_max3_f32 v13, v13, v149, v150
    v_max3_f32 v13, v13, v151, v152
    v_max3_f32 v13, v13, v153, v154
    v_max3_f32 v13, v13, v155, v156
    v_max3_f32 v13, v13, v157, v158
    v_max3_f32 v13, v13, v159, v176
    v_max3_f32 v13, v13, v177, v178
    v_max3_f32 v13, v13, v179, v180
    v_max3_f32 v13, v13, v181, v182
    v_max3_f32 v13, v13, v183, v184
    v_max3_f32 v13, v13, v185, v186
    v_max3_f32 v13, v13, v187, v188
    v_max3_f32 v13, v13, v189, v190
    v_max_f32 v13, v13, v191
    s_mov_b32 s46, 0x42700000
    v_mov_b32 v14, v12
    s_nop 1
    v_permlane32_swap_b32 v12, v14
    v_max_f32 v12, v12, v14
    v_add_f32 v12, s46, v12
    v_cvt_pk_bf16_f32 v12, -v12, 0
    v_mov_b32 v15, v13
    s_nop 1
    v_permlane32_swap_b32 v13, v15
    v_max_f32 v13, v13, v15
    v_add_f32 v13, s46, v13
    v_cvt_pk_bf16_f32 v13, -v13, 0
    v_cmp_gt_u32 vcc, 32, v0
    s_nop 1
    v_cndmask_b32 v33, v13, v12, vcc
    v_mfma_f32_32x32x16_bf16 v[128:143], v[48:51], v[24:27], 0
    v_mfma_f32_32x32x16_bf16 v[144:159], v[48:51], v[28:31], 0
    s_nop 9
    v_mfma_f32_32x32x4_2b_bf16 v[128:159], v[56:57], v[32:33], v[128:159]
    s_nop 15
    s_nop 3
    v_exp_f32 v128, v128
    v_exp_f32 v129, v129
    ds_read_b128 v[72:75], v10 offset:1280
    v_exp_f32 v130, v130
    v_exp_f32 v131, v131
    v_exp_f32 v132, v132
    v_exp_f32 v133, v133
    v_exp_f32 v134, v134
    v_exp_f32 v135, v135
    s_waitcnt lgkmcnt(1)
    v_mfma_f32_32x32x16_bf16 v[160:175], v[52:55], v[24:27], 0
    s_mov_b32 m0, s53
    s_add_u32 s53, s53, 4096
    buffer_load_dwordx4 v2, s[24:27], s52 offen sc1 lds
    s_add_u32 s52, s52, 4096
    v_cvt_pk_bf16_f32 v80, v128, v129
    v_cvt_pk_bf16_f32 v81, v130, v131
    v_cvt_pk_bf16_f32 v82, v132, v133
    v_cvt_pk_bf16_f32 v83, v134, v135
    v_exp_f32 v136, v136
    v_exp_f32 v137, v137
    v_mfma_f32_32x32x16_bf16 v[176:191], v[52:55], v[28:31], 0
    ds_read_b128 v[76:79], v10 offset:1920
    v_exp_f32 v138, v138
    v_exp_f32 v139, v139
    v_exp_f32 v140, v140
    v_exp_f32 v141, v141
    v_exp_f32 v142, v142
    v_exp_f32 v143, v143
    v_mfma_f32_32x32x16_bf16 v[96:111], v[64:67], v[80:83], 0
    s_mov_b32 m0, s53
    s_add_u32 s53, s53, 4096
    buffer_load_dwordx4 v2, s[24:27], s52 offen sc1 lds
    s_add_u32 s52, s52, 4096
    v_cvt_pk_bf16_f32 v84, v136, v137
    v_cvt_pk_bf16_f32 v85, v138, v139
    v_cvt_pk_bf16_f32 v86, v140, v141
    v_cvt_pk_bf16_f32 v87, v142, v143
    v_exp_f32 v144, v144
    v_exp_f32 v145, v145
    v_mfma_f32_32x32x4_2b_bf16 v[160:191], v[60:61], v[32:33], v[160:191]
    ds_read_b128 v[48:51], v8 offset:2048
    v_exp_f32 v146, v146
    v_exp_f32 v147, v147
    v_exp_f32 v148, v148
    v_exp_f32 v149, v149
    v_exp_f32 v150, v150
    v_exp_f32 v151, v151
    v_cvt_pk_bf16_f32 v88, v144, v145
    v_cvt_pk_bf16_f32 v89, v146, v147
    v_cvt_pk_bf16_f32 v90, v148, v149
    v_mfma_f32_32x32x16_bf16 v[96:111], v[68:71], v[84:87], v[96:111]
    ds_read_b32 v56, v9 offset:256
    v_cvt_pk_bf16_f32 v91, v150, v151
    v_exp_f32 v152, v152
    v_exp_f32 v153, v153
    v_exp_f32 v154, v154
    v_exp_f32 v155, v155
    v_exp_f32 v156, v156
    v_exp_f32 v157, v157
    v_mfma_f32_32x32x16_bf16 v[112:127], v[64:67], v[88:91], 0
    v_exp_f32 v158, v158
    v_exp_f32 v159, v159
    v_cvt_pk_bf16_f32 v92, v152, v153
    v_cvt_pk_bf16_f32 v93, v154, v155
    v_cvt_pk_bf16_f32 v94, v156, v157
    v_cvt_pk_bf16_f32 v95, v158, v159
    v_exp_f32 v160, v160
    v_exp_f32 v161, v161
    v_mfma_f32_32x32x16_bf16 v[112:127], v[68:71], v[92:95], v[112:127]
    ds_read_b128 v[64:67], v10 offset:2560
    v_exp_f32 v162, v162
    v_exp_f32 v163, v163
    v_exp_f32 v164, v164
    v_exp_f32 v165, v165
    v_exp_f32 v166, v166
    v_exp_f32 v167, v167
    s_waitcnt lgkmcnt(1)
    v_mfma_f32_32x32x16_bf16 v[128:143], v[48:51], v[24:27], 0
    s_mov_b32 m0, s53
    s_add_u32 s53, s53, 4096
    buffer_load_dwordx4 v2, s[24:27], s52 offen sc1 lds
    s_add_u32 s52, s52, 4096
    v_cvt_pk_bf16_f32 v80, v160, v161
    v_cvt_pk_bf16_f32 v81, v162, v163
    v_cvt_pk_bf16_f32 v82, v164, v165
    v_cvt_pk_bf16_f32 v83, v166, v167
    v_exp_f32 v168, v168
    v_exp_f32 v169, v169
    v_mfma_f32_32x32x16_bf16 v[144:159], v[48:51], v[28:31], 0
    ds_read_b128 v[68:71], v10 offset:3200
    v_exp_f32 v170, v170
    v_exp_f32 v171, v171
    v_exp_f32 v172, v172
    v_exp_f32 v173, v173
    v_exp_f32 v174, v174
    v_exp_f32 v175, v175
    v_mfma_f32_32x32x16_bf16 v[96:111], v[72:75], v[80:83], v[96:111]
    s_mov_b32 m0, s53
    s_add_u32 s53, s53, 4096
    buffer_load_dwordx4 v2, s[24:27], s52 offen sc1 lds
    s_add_u32 s52, s52, 4096
    v_cvt_pk_bf16_f32 v84, v168, v169
    v_cvt_pk_bf16_f32 v85, v170, v171
    v_cvt_pk_bf16_f32 v86, v172, v173
    v_cvt_pk_bf16_f32 v87, v174, v175
    v_exp_f32 v176, v176
    v_exp_f32 v177, v177
    v_mfma_f32_32x32x4_2b_bf16 v[128:159], v[56:57], v[32:33], v[128:159]
    ds_read_b128 v[52:55], v8 offset:3072
    v_exp_f32 v178, v178
    v_exp_f32 v179, v179
    v_exp_f32 v180, v180
    v_exp_f32 v181, v181
    v_exp_f32 v182, v182
    v_exp_f32 v183, v183
    v_cvt_pk_bf16_f32 v88, v176, v177
    v_cvt_pk_bf16_f32 v89, v178, v179
    v_cvt_pk_bf16_f32 v90, v180, v181
    v_mfma_f32_32x32x16_bf16 v[96:111], v[76:79], v[84:87], v[96:111]
    ds_read_b32 v60, v9 offset:384
    v_cvt_pk_bf16_f32 v91, v182, v183
    v_exp_f32 v184, v184
    v_exp_f32 v185, v185
    v_exp_f32 v186, v186
    v_exp_f32 v187, v187
    v_exp_f32 v188, v188
    v_exp_f32 v189, v189
    v_mfma_f32_32x32x16_bf16 v[112:127], v[72:75], v[88:91], v[112:127]
    v_exp_f32 v190, v190
    v_exp_f32 v191, v191
    v_cvt_pk_bf16_f32 v92, v184, v185
    v_cvt_pk_bf16_f32 v93, v186, v187
    v_cvt_pk_bf16_f32 v94, v188, v189
    v_cvt_pk_bf16_f32 v95, v190, v191
    v_exp_f32 v128, v128
    v_exp_f32 v129, v129
    v_mfma_f32_32x32x16_bf16 v[112:127], v[76:79], v[92:95], v[112:127]
    ds_read_b128 v[72:75], v10 offset:3840
    v_exp_f32 v130, v130
    v_exp_f32 v131, v131
    v_exp_f32 v132, v132
    v_exp_f32 v133, v133
    v_exp_f32 v134, v134
    v_exp_f32 v135, v135
    s_waitcnt lgkmcnt(1)
    v_mfma_f32_32x32x16_bf16 v[160:175], v[52:55], v[24:27], 0
    s_mov_b32 m0, s53
    s_add_u32 s53, s53, 4096
    buffer_load_dwordx4 v2, s[24:27], s52 offen sc1 lds
    s_add_u32 s52, s52, 4096
    v_cvt_pk_bf16_f32 v80, v128, v129
    v_cvt_pk_bf16_f32 v81, v130, v131
    v_cvt_pk_bf16_f32 v82, v132, v133
    v_cvt_pk_bf16_f32 v83, v134, v135
    v_exp_f32 v136, v136
    v_exp_f32 v137, v137
    v_mfma_f32_32x32x16_bf16 v[176:191], v[52:55], v[28:31], 0
    ds_read_b128 v[76:79], v10 offset:4480
    v_exp_f32 v138, v138
    v_exp_f32 v139, v139
    v_exp_f32 v140, v140
    v_exp_f32 v141, v141
    v_exp_f32 v142, v142
    v_exp_f32 v143, v143
    v_mfma_f32_32x32x16_bf16 v[96:111], v[64:67], v[80:83], v[96:111]
    s_mov_b32 m0, s53
    s_add_u32 s53, s53, 4096
    buffer_load_dwordx4 v2, s[24:27], s52 offen sc1 lds
    s_add_u32 s52, s52, 4096
    v_cvt_pk_bf16_f32 v84, v136, v137
    v_cvt_pk_bf16_f32 v85, v138, v139
    v_cvt_pk_bf16_f32 v86, v140, v141
    v_cvt_pk_bf16_f32 v87, v142, v143
    v_exp_f32 v144, v144
    v_exp_f32 v145, v145
    v_mfma_f32_32x32x4_2b_bf16 v[160:191], v[60:61], v[32:33], v[160:191]
    ds_read_b128 v[48:51], v8 offset:4096
    v_exp_f32 v146, v146
    v_exp_f32 v147, v147
    v_exp_f32 v148, v148
    v_exp_f32 v149, v149
    v_exp_f32 v150, v150
    v_exp_f32 v151, v151
    v_cvt_pk_bf16_f32 v88, v144, v145
    v_cvt_pk_bf16_f32 v89, v146, v147
    v_cvt_pk_bf16_f32 v90, v148, v149
    v_mfma_f32_32x32x16_bf16 v[96:111], v[68:71], v[84:87], v[96:111]
    ds_read_b32 v56, v9 offset:512
    v_cvt_pk_bf16_f32 v91, v150, v151
    v_exp_f32 v152, v152
    v_exp_f32 v153, v153
    v_exp_f32 v154, v154
    v_exp_f32 v155, v155
    v_exp_f32 v156, v156
    v_exp_f32 v157, v157
    v_mfma_f32_32x32x16_bf16 v[112:127], v[64:67], v[88:91], v[112:127]
    v_exp_f32 v158, v158
    v_exp_f32 v159, v159
    v_cvt_pk_bf16_f32 v92, v152, v153
    v_cvt_pk_bf16_f32 v93, v154, v155
    v_cvt_pk_bf16_f32 v94, v156, v157
    v_cvt_pk_bf16_f32 v95, v158, v159
    v_exp_f32 v160, v160
    v_exp_f32 v161, v161
    v_mfma_f32_32x32x16_bf16 v[112:127], v[68:71], v[92:95], v[112:127]
    ds_read_b128 v[64:67], v10 offset:5120
    v_exp_f32 v162, v162
    v_exp_f32 v163, v163
    v_exp_f32 v164, v164
    v_exp_f32 v165, v165
    v_exp_f32 v166, v166
    v_exp_f32 v167, v167
    s_waitcnt lgkmcnt(1)
    v_mfma_f32_32x32x16_bf16 v[128:143], v[48:51], v[24:27], 0
    s_mov_b32 m0, s53
    s_add_u32 s53, s53, 4096
    buffer_load_dwordx4 v2, s[24:27], s52 offen sc1 lds
    s_add_u32 s52, s52, 4096
    v_cvt_pk_bf16_f32 v80, v160, v161
    v_cvt_pk_bf16_f32 v81, v162, v163
    v_cvt_pk_bf16_f32 v82, v164, v165
    v_cvt_pk_bf16_f32 v83, v166, v167
    v_exp_f32 v168, v168
    v_exp_f32 v169, v169
    v_mfma_f32_32x32x16_bf16 v[144:159], v[48:51], v[28:31], 0
    ds_read_b128 v[68:71], v10 offset:5760
    v_exp_f32 v170, v170
    v_exp_f32 v171, v171
    v_exp_f32 v172, v172
    v_exp_f32 v173, v173
    v_exp_f32 v174, v174
    v_exp_f32 v175, v175
    v_mfma_f32_32x32x16_bf16 v[96:111], v[72:75], v[80:83], v[96:111]
    s_mov_b32 m0, s53
    s_add_u32 s53, s53, 4096
    buffer_load_dwordx4 v2, s[24:27], s52 offen sc1 lds
    s_add_u32 s52, s52, 4096
    v_cvt_pk_bf16_f32 v84, v168, v169
    v_cvt_pk_bf16_f32 v85, v170, v171
    v_cvt_pk_bf16_f32 v86, v172, v173
    v_cvt_pk_bf16_f32 v87, v174, v175
    v_exp_f32 v176, v176
    v_exp_f32 v177, v177
    v_mfma_f32_32x32x4_2b_bf16 v[128:159], v[56:57], v[32:33], v[128:159]
    ds_read_b128 v[52:55], v8 offset:5120
    v_exp_f32 v178, v178
    v_exp_f32 v179, v179
    v_exp_f32 v180, v180
    v_exp_f32 v181, v181
    v_exp_f32 v182, v182
    v_exp_f32 v183, v183
    v_cvt_pk_bf16_f32 v88, v176, v177
    v_cvt_pk_bf16_f32 v89, v178, v179
    v_cvt_pk_bf16_f32 v90, v180, v181
    v_mfma_f32_32x32x16_bf16 v[96:111], v[76:79], v[84:87], v[96:111]
    ds_read_b32 v60, v9 offset:640
    v_cvt_pk_bf16_f32 v91, v182, v183
    v_exp_f32 v184, v184
    v_exp_f32 v185, v185
    v_exp_f32 v186, v186
    v_exp_f32 v187, v187
    v_exp_f32 v188, v188
    v_exp_f32 v189, v189
    v_mfma_f32_32x32x16_bf16 v[112:127], v[72:75], v[88:91], v[112:127]
    v_exp_f32 v190, v190
    v_exp_f32 v191, v191
    v_cvt_pk_bf16_f32 v92, v184, v185
    v_cvt_pk_bf16_f32 v93, v186, v187
    v_cvt_pk_bf16_f32 v94, v188, v189
    v_cvt_pk_bf16_f32 v95, v190, v191
    v_exp_f32 v128, v128
    v_exp_f32 v129, v129
    v_mfma_f32_32x32x16_bf16 v[112:127], v[76:79], v[92:95], v[112:127]
    ds_read_b128 v[72:75], v10 offset:6400
    v_exp_f32 v130, v130
    v_exp_f32 v131, v131
    v_exp_f32 v132, v132
    v_exp_f32 v133, v133
    v_exp_f32 v134, v134
    v_exp_f32 v135, v135
    s_waitcnt lgkmcnt(1)
    v_mfma_f32_32x32x16_bf16 v[160:175], v[52:55], v[24:27], 0
    v_cvt_pk_bf16_f32 v80, v128, v129
    v_cvt_pk_bf16_f32 v81, v130, v131
    v_cvt_pk_bf16_f32 v82, v132, v133
    v_cvt_pk_bf16_f32 v83, v134, v135
    v_exp_f32 v136, v136
    v_exp_f32 v137, v137
    v_mfma_f32_32x32x16_bf16 v[176:191], v[52:55], v[28:31], 0
    ds_read_b128 v[76:79], v10 offset:7040
    v_exp_f32 v138, v138
    v_exp_f32 v139, v139
    v_exp_f32 v140, v140
    v_exp_f32 v141, v141
    v_exp_f32 v142, v142
    v_exp_f32 v143, v143
    v_mfma_f32_32x32x16_bf16 v[96:111], v[64:67], v[80:83], v[96:111]
    v_cvt_pk_bf16_f32 v84, v136, v137
    v_cvt_pk_bf16_f32 v85, v138, v139
    v_cvt_pk_bf16_f32 v86, v140, v141
    v_cvt_pk_bf16_f32 v87, v142, v143
    v_exp_f32 v144, v144
    v_exp_f32 v145, v145
    v_mfma_f32_32x32x4_2b_bf16 v[160:191], v[60:61], v[32:33], v[160:191]
    ds_read_b128 v[48:51], v8 offset:6144
    v_exp_f32 v146, v146
    v_exp_f32 v147, v147
    v_exp_f32 v148, v148
    v_exp_f32 v149, v149
    v_exp_f32 v150, v150
    v_exp_f32 v151, v151
    v_cvt_pk_bf16_f32 v88, v144, v145
    v_cvt_pk_bf16_f32 v89, v146, v147
    v_cvt_pk_bf16_f32 v90, v148, v149
    v_mfma_f32_32x32x16_bf16 v[96:111], v[68:71], v[84:87], v[96:111]
    ds_read_b32 v56, v9 offset:768
    v_cvt_pk_bf16_f32 v91, v150, v151
    v_exp_f32 v152, v152
    v_exp_f32 v153, v153
    v_exp_f32 v154, v154
    v_exp_f32 v155, v155
    v_exp_f32 v156, v156
    v_exp_f32 v157, v157
    v_mfma_f32_32x32x16_bf16 v[112:127], v[64:67], v[88:91], v[112:127]
    v_exp_f32 v158, v158
    v_exp_f32 v159, v159
    v_cvt_pk_bf16_f32 v92, v152, v153
    v_cvt_pk_bf16_f32 v93, v154, v155
    v_cvt_pk_bf16_f32 v94, v156, v157
    v_cvt_pk_bf16_f32 v95, v158, v159
    v_exp_f32 v160, v160
    v_exp_f32 v161, v161
    v_mfma_f32_32x32x16_bf16 v[112:127], v[68:71], v[92:95], v[112:127]
    ds_read_b128 v[64:67], v10 offset:7680
    v_exp_f32 v162, v162
    v_exp_f32 v163, v163
    v_exp_f32 v164, v164
    v_exp_f32 v165, v165
    v_exp_f32 v166, v166
    v_exp_f32 v167, v167
    s_waitcnt lgkmcnt(1)
    v_mfma_f32_32x32x16_bf16 v[128:143], v[48:51], v[24:27], 0
    v_cvt_pk_bf16_f32 v80, v160, v161
    v_cvt_pk_bf16_f32 v81, v162, v163
    v_cvt_pk_bf16_f32 v82, v164, v165
    v_cvt_pk_bf16_f32 v83, v166, v167
    v_exp_f32 v168, v168
    v_exp_f32 v169, v169
    v_mfma_f32_32x32x16_bf16 v[144:159], v[48:51], v[28:31], 0
    ds_read_b128 v[68:71], v10 offset:8320
    v_exp_f32 v170, v170
    v_exp_f32 v171, v171
    v_exp_f32 v172, v172
    v_exp_f32 v173, v173
    v_exp_f32 v174, v174
    v_exp_f32 v175, v175
    v_mfma_f32_32x32x16_bf16 v[96:111], v[72:75], v[80:83], v[96:111]
    v_cvt_pk_bf16_f32 v84, v168, v169
    v_cvt_pk_bf16_f32 v85, v170, v171
    v_cvt_pk_bf16_f32 v86, v172, v173
    v_cvt_pk_bf16_f32 v87, v174, v175
    v_exp_f32 v176, v176
    v_exp_f32 v177, v177
    v_mfma_f32_32x32x4_2b_bf16 v[128:159], v[56:57], v[32:33], v[128:159]
    ds_read_b128 v[52:55], v8 offset:7168
    v_exp_f32 v178, v178
    v_exp_f32 v179, v179
    v_exp_f32 v180, v180
    v_exp_f32 v181, v181
    v_exp_f32 v182, v182
    v_exp_f32 v183, v183
    v_cvt_pk_bf16_f32 v88, v176, v177
    v_cvt_pk_bf16_f32 v89, v178, v179
    v_cvt_pk_bf16_f32 v90, v180, v181
    v_mfma_f32_32x32x16_bf16 v[96:111], v[76:79], v[84:87], v[96:111]
    ds_read_b32 v60, v9 offset:896
    v_cvt_pk_bf16_f32 v91, v182, v183
    v_exp_f32 v184, v184
    v_exp_f32 v185, v185
    v_exp_f32 v186, v186
    v_exp_f32 v187, v187
    v_exp_f32 v188, v188
    v_exp_f32 v189, v189
    v_mfma_f32_32x32x16_bf16 v[112:127], v[72:75], v[88:91], v[112:127]
    v_exp_f32 v190, v190
    v_exp_f32 v191, v191
    v_cvt_pk_bf16_f32 v92, v184, v185
    v_cvt_pk_bf16_f32 v93, v186, v187
    v_cvt_pk_bf16_f32 v94, v188, v189
    v_cvt_pk_bf16_f32 v95, v190, v191
    s_waitcnt vmcnt(0)
    s_barrier
    s_cmp_lg_u32 s42, 0
    s_cbranch_scc1 L_pub_18
    s_lshl_b32 s49, s2, 7
    s_add_u32 s49, s49, 16
    v_mov_b32 v4, s44
    v_mov_b32 v5, s45
    v_mov_b32 v6, 0
    s_mov_b64 exec, 1
    buffer_store_dwordx2 v[4:5], v6, s[24:27], s49 offen sc1
    s_mov_b64 exec, -1
L_pub_18:
    v_exp_f32 v128, v128
    v_exp_f32 v129, v129
    v_mfma_f32_32x32x16_bf16 v[112:127], v[76:79], v[92:95], v[112:127]
    ds_read_b128 v[72:75], v10 offset:8960
    v_exp_f32 v130, v130
    v_exp_f32 v131, v131
    v_exp_f32 v132, v132
    v_exp_f32 v133, v133
    v_exp_f32 v134, v134
    v_exp_f32 v135, v135
    s_waitcnt lgkmcnt(1)
    v_mfma_f32_32x32x16_bf16 v[160:175], v[52:55], v[24:27], 0
    v_cvt_pk_bf16_f32 v80, v128, v129
    v_cvt_pk_bf16_f32 v81, v130, v131
    v_cvt_pk_bf16_f32 v82, v132, v133
    v_cvt_pk_bf16_f32 v83, v134, v135
    v_exp_f32 v136, v136
    v_exp_f32 v137, v137
    v_mfma_f32_32x32x16_bf16 v[176:191], v[52:55], v[28:31], 0
    ds_read_b128 v[76:79], v10 offset:9600
    v_exp_f32 v138, v138
    v_exp_f32 v139, v139
    v_exp_f32 v140, v140
    v_exp_f32 v141, v141
    v_exp_f32 v142, v142
    v_exp_f32 v143, v143
    v_mfma_f32_32x32x16_bf16 v[96:111], v[64:67], v[80:83], v[96:111]
    v_cvt_pk_bf16_f32 v84, v136, v137
    v_cvt_pk_bf16_f32 v85, v138, v139
    v_cvt_pk_bf16_f32 v86, v140, v141
    v_cvt_pk_bf16_f32 v87, v142, v143
    v_exp_f32 v144, v144
    v_exp_f32 v145, v145
    v_mfma_f32_32x32x4_2b_bf16 v[160:191], v[60:61], v[32:33], v[160:191]
    ds_read_b128 v[48:51], v8 offset:8192
    v_exp_f32 v146, v146
    v_exp_f32 v147, v147
    v_exp_f32 v148, v148
    v_exp_f32 v149, v149
    v_exp_f32 v150, v150
    v_exp_f32 v151, v151
    v_cvt_pk_bf16_f32 v88, v144, v145
    v_cvt_pk_bf16_f32 v89, v146, v147
    v_cvt_pk_bf16_f32 v90, v148, v149
    v_mfma_f32_32x32x16_bf16 v[96:111], v[68:71], v[84:87], v[96:111]
    ds_read_b32 v56, v9 offset:1024
    v_cvt_pk_bf16_f32 v91, v150, v151
    v_exp_f32 v152, v152
    v_exp_f32 v153, v153
    v_exp_f32 v154, v154
    v_exp_f32 v155, v155
    v_exp_f32 v156, v156
    v_exp_f32 v157, v157
    v_mfma_f32_32x32x16_bf16 v[112:127], v[64:67], v[88:91], v[112:127]
    v_exp_f32 v158, v158
    v_exp_f32 v159, v159
    v_cvt_pk_bf16_f32 v92, v152, v153
    v_cvt_pk_bf16_f32 v93, v154, v155
    v_cvt_pk_bf16_f32 v94, v156, v157
    v_cvt_pk_bf16_f32 v95, v158, v159
    v_exp_f32 v160, v160
    v_exp_f32 v161, v161
    v_mfma_f32_32x32x16_bf16 v[112:127], v[68:71], v[92:95], v[112:127]
    ds_read_b128 v[64:67], v10 offset:10240
    v_exp_f32 v162, v162
    v_exp_f32 v163, v163
    v_exp_f32 v164, v164
    v_exp_f32 v165, v165
    v_exp_f32 v166, v166
    v_exp_f32 v167, v167
    s_waitcnt lgkmcnt(1)
    v_mfma_f32_32x32x16_bf16 v[128:143], v[48:51], v[24:27], 0
    v_cvt_pk_bf16_f32 v80, v160, v161
    v_cvt_pk_bf16_f32 v81, v162, v163
    v_cvt_pk_bf16_f32 v82, v164, v165
    v_cvt_pk_bf16_f32 v83, v166, v167
    v_exp_f32 v168, v168
    v_exp_f32 v169, v169
    v_mfma_f32_32x32x16_bf16 v[144:159], v[48:51], v[28:31], 0
    ds_read_b128 v[68:71], v10 offset:10880
    v_exp_f32 v170, v170
    v_exp_f32 v171, v171
    v_exp_f32 v172, v172
    v_exp_f32 v173, v173
    v_exp_f32 v174, v174
    v_exp_f32 v175, v175
    v_mfma_f32_32x32x16_bf16 v[96:111], v[72:75], v[80:83], v[96:111]
    v_cvt_pk_bf16_f32 v84, v168, v169
    v_cvt_pk_bf16_f32 v85, v170, v171
    v_cvt_pk_bf16_f32 v86, v172, v173
    v_cvt_pk_bf16_f32 v87, v174, v175
    v_exp_f32 v176, v176
    v_exp_f32 v177, v177
    v_mfma_f32_32x32x4_2b_bf16 v[128:159], v[56:57], v[32:33], v[128:159]
    ds_read_b128 v[52:55], v8 offset:9216
    v_exp_f32 v178, v178
    v_exp_f32 v179, v179
    v_exp_f32 v180, v180
    v_exp_f32 v181, v181
    v_exp_f32 v182, v182
    v_exp_f32 v183, v183
    v_cvt_pk_bf16_f32 v88, v176, v177
    v_cvt_pk_bf16_f32 v89, v178, v179
    v_cvt_pk_bf16_f32 v90, v180, v181
    v_mfma_f32_32x32x16_bf16 v[96:111], v[76:79], v[84:87], v[96:111]
    ds_read_b32 v60, v9 offset:1152
    v_cvt_pk_bf16_f32 v91, v182, v183
    v_exp_f32 v184, v184
    v_exp_f32 v185, v185
    v_exp_f32 v186, v186
    v_exp_f32 v187, v187
    v_exp_f32 v188, v188
    v_exp_f32 v189, v189
    v_mfma_f32_32x32x16_bf16 v[112:127], v[72:75], v[88:91], v[112:127]
    v_exp_f32 v190, v190
    v_exp_f32 v191, v191
    v_cvt_pk_bf16_f32 v92, v184, v185
    v_cvt_pk_bf16_f32 v93, v186, v187
    v_cvt_pk_bf16_f32 v94, v188, v189
    v_cvt_pk_bf16_f32 v95, v190, v191
    v_add_u32 v8, 8192, v8
    v_add_u32 v9, 1024, v9
    v_add_u32 v10, 10240, v10
    v_exp_f32 v128, v128
    v_exp_f32 v129, v129
    v_mfma_f32_32x32x16_bf16 v[112:127], v[76:79], v[92:95], v[112:127]
    ds_read_b128 v[72:75], v10 offset:1280
    v_exp_f32 v130, v130
    v_exp_f32 v131, v131
    v_exp_f32 v132, v132
    v_exp_f32 v133, v133
    v_exp_f32 v134, v134
    v_exp_f32 v135, v135
    s_waitcnt lgkmcnt(1)
    v_mfma_f32_32x32x16_bf16 v[160:175], v[52:55], v[24:27], 0
    s_mov_b32 m0, s53
    s_add_u32 s53, s53, 4096
    buffer_load_dwordx4 v2, s[24:27], s52 offen sc1 lds
    s_add_u32 s52, s52, 4096
    v_cvt_pk_bf16_f32 v80, v128, v129
    v_cvt_pk_bf16_f32 v81, v130, v131
    v_cvt_pk_bf16_f32 v82, v132, v133
    v_cvt_pk_bf16_f32 v83, v134, v135
    v_exp_f32 v136, v136
    v_exp_f32 v137, v137
    v_mfma_f32_32x32x16_bf16 v[176:191], v[52:55], v[28:31], 0
    ds_read_b128 v[76:79], v10 offset:1920
    v_exp_f32 v138, v138
    v_exp_f32 v139, v139
    v_exp_f32 v140, v140
    v_exp_f32 v141, v141
    v_exp_f32 v142, v142
    v_exp_f32 v143, v143
    v_mfma_f32_32x32x16_bf16 v[96:111], v[64:67], v[80:83], v[96:111]
    s_mov_b32 m0, s53
    s_add_u32 s53, s53, 4096
    buffer_load_dwordx4 v2, s[24:27], s52 offen sc1 lds
    s_add_u32 s52, s52, 4096
    v_cvt_pk_bf16_f32 v84, v136, v137
    v_cvt_pk_bf16_f32 v85, v138, v139
    v_cvt_pk_bf16_f32 v86, v140, v141
    v_cvt_pk_bf16_f32 v87, v142, v143
    v_exp_f32 v144, v144
    v_exp_f32 v145, v145
    v_mfma_f32_32x32x4_2b_bf16 v[160:191], v[60:61], v[32:33], v[160:191]
    ds_read_b128 v[48:51], v8 offset:2048
    v_exp_f32 v146, v146
    v_exp_f32 v147, v147
    v_exp_f32 v148, v148
    v_exp_f32 v149, v149
    v_exp_f32 v150, v150
    v_exp_f32 v151, v151
    v_cvt_pk_bf16_f32 v88, v144, v145
    v_cvt_pk_bf16_f32 v89, v146, v147
    v_cvt_pk_bf16_f32 v90, v148, v149
    v_mfma_f32_32x32x16_bf16 v[96:111], v[68:71], v[84:87], v[96:111]
    ds_read_b32 v56, v9 offset:256
    v_cvt_pk_bf16_f32 v91, v150, v151
    v_exp_f32 v152, v152
    v_exp_f32 v153, v153
    v_exp_f32 v154, v154
    v_exp_f32 v155, v155
    v_exp_f32 v156, v156
    v_exp_f32 v157, v157
    v_mfma_f32_32x32x16_bf16 v[112:127], v[64:67], v[88:91], v[112:127]
    v_exp_f32 v158, v158
    v_exp_f32 v159, v159
    v_cvt_pk_bf16_f32 v92, v152, v153
    v_cvt_pk_bf16_f32 v93, v154, v155
    v_cvt_pk_bf16_f32 v94, v156, v157
    v_cvt_pk_bf16_f32 v95, v158, v159
    v_exp_f32 v160, v160
    v_exp_f32 v161, v161
    v_mfma_f32_32x32x16_bf16 v[112:127], v[68:71], v[92:95], v[112:127]
    ds_read_b128 v[64:67], v10 offset:2560
    v_exp_f32 v162, v162
    v_exp_f32 v163, v163
    v_exp_f32 v164, v164
    v_exp_f32 v165, v165
    v_exp_f32 v166, v166
    v_exp_f32 v167, v167
    s_waitcnt lgkmcnt(1)
    v_mfma_f32_32x32x16_bf16 v[128:143], v[48:51], v[24:27], 0
    s_mov_b32 m0, s53
    s_add_u32 s53, s53, 4096
    buffer_load_dwordx4 v2, s[24:27], s52 offen sc1 lds
    s_add_u32 s52, s52, 4096
    v_cvt_pk_bf16_f32 v80, v160, v161
    v_cvt_pk_bf16_f32 v81, v162, v163
    v_cvt_pk_bf16_f32 v82, v164, v165
    v_cvt_pk_bf16_f32 v83, v166, v167
    v_exp_f32 v168, v168
    v_exp_f32 v169, v169
    v_mfma_f32_32x32x16_bf16 v[144:159], v[48:51], v[28:31], 0
    ds_read_b128 v[68:71], v10 offset:3200
    v_exp_f32 v170, v170
    v_exp_f32 v171, v171
    v_exp_f32 v172, v172
    v_exp_f32 v173, v173
    v_exp_f32 v174, v174
    v_exp_f32 v175, v175
    v_mfma_f32_32x32x16_bf16 v[96:111], v[72:75], v[80:83], v[96:111]
    s_mov_b32 m0, s53
    s_add_u32 s53, s53, 4096
    buffer_load_dwordx4 v2, s[24:27], s52 offen sc1 lds
    s_add_u32 s52, s52, 4096
    v_cvt_pk_bf16_f32 v84, v168, v169
    v_cvt_pk_bf16_f32 v85, v170, v171
    v_cvt_pk_bf16_f32 v86, v172, v173
    v_cvt_pk_bf16_f32 v87, v174, v175
    v_exp_f32 v176, v176
    v_exp_f32 v177, v177
    v_mfma_f32_32x32x4_2b_bf16 v[128:159], v[56:57], v[32:33], v[128:159]
    ds_read_b128 v[52:55], v8 offset:3072
    v_exp_f32 v178, v178
    v_exp_f32 v179, v179
    v_exp_f32 v180, v180
    v_exp_f32 v181, v181
    v_exp_f32 v182, v182
    v_exp_f32 v183, v183
    v_cvt_pk_bf16_f32 v88, v176, v177
    v_cvt_pk_bf16_f32 v89, v178, v179
    v_cvt_pk_bf16_f32 v90, v180, v181
    v_mfma_f32_32x32x16_bf16 v[96:111], v[76:79], v[84:87], v[96:111]
    ds_read_b32 v60, v9 offset:384
    v_cvt_pk_bf16_f32 v91, v182, v183
    v_exp_f32 v184, v184
    v_exp_f32 v185, v185
    v_exp_f32 v186, v186
    v_exp_f32 v187, v187
    v_exp_f32 v188, v188
    v_exp_f32 v189, v189
    v_mfma_f32_32x32x16_bf16 v[112:127], v[72:75], v[88:91], v[112:127]
    v_exp_f32 v190, v190
    v_exp_f32 v191, v191
    v_cvt_pk_bf16_f32 v92, v184, v185
    v_cvt_pk_bf16_f32 v93, v186, v187
    v_cvt_pk_bf16_f32 v94, v188, v189
    v_cvt_pk_bf16_f32 v95, v190, v191
    v_exp_f32 v128, v128
    v_exp_f32 v129, v129
    v_mfma_f32_32x32x16_bf16 v[112:127], v[76:79], v[92:95], v[112:127]
    ds_read_b128 v[72:75], v10 offset:3840
    v_exp_f32 v130, v130
    v_exp_f32 v131, v131
    v_exp_f32 v132, v132
    v_exp_f32 v133, v133
    v_exp_f32 v134, v134
    v_exp_f32 v135, v135
    s_waitcnt lgkmcnt(1)
    v_mfma_f32_32x32x16_bf16 v[160:175], v[52:55], v[24:27], 0
    s_mov_b32 m0, s53
    s_add_u32 s53, s53, 4096
    buffer_load_dwordx4 v2, s[24:27], s52 offen sc1 lds
    s_add_u32 s52, s52, 4096
    v_cvt_pk_bf16_f32 v80, v128, v129
    v_cvt_pk_bf16_f32 v81, v130, v131
    v_cvt_pk_bf16_f32 v82, v132, v133
    v_cvt_pk_bf16_f32 v83, v134, v135
    v_exp_f32 v136, v136
    v_exp_f32 v137, v137
    v_mfma_f32_32x32x16_bf16 v[176:191], v[52:55], v[28:31], 0
    ds_read_b128 v[76:79], v10 offset:4480
    v_exp_f32 v138, v138
    v_exp_f32 v139, v139
    v_exp_f32 v140, v140
    v_exp_f32 v141, v141
    v_exp_f32 v142, v142
    v_exp_f32 v143, v143
    v_mfma_f32_32x32x16_bf16 v[96:111], v[64:67], v[80:83], v[96:111]
    s_mov_b32 m0, s53
    s_add_u32 s53, s53, 4096
    buffer_load_dwordx4 v2, s[24:27], s52 offen sc1 lds
    s_add_u32 s52, s52, 4096
    v_cvt_pk_bf16_f32 v84, v136, v137
    v_cvt_pk_bf16_f32 v85, v138, v139
    v_cvt_pk_bf16_f32 v86, v140, v141
    v_cvt_pk_bf16_f32 v87, v142, v143
    v_exp_f32 v144, v144
    v_exp_f32 v145, v145
    v_mfma_f32_32x32x4_2b_bf16 v[160:191], v[60:61], v[32:33], v[160:191]
    ds_read_b128 v[48:51], v8 offset:4096
    v_exp_f32 v146, v146
    v_exp_f32 v147, v147
    v_exp_f32 v148, v148
    v_exp_f32 v149, v149
    v_exp_f32 v150, v150
    v_exp_f32 v151, v151
    v_cvt_pk_bf16_f32 v88, v144, v145
    v_cvt_pk_bf16_f32 v89, v146, v147
    v_cvt_pk_bf16_f32 v90, v148, v149
    v_mfma_f32_32x32x16_bf16 v[96:111], v[68:71], v[84:87], v[96:111]
    ds_read_b32 v56, v9 offset:512
    v_cvt_pk_bf16_f32 v91, v150, v151
    v_exp_f32 v152, v152
    v_exp_f32 v153, v153
    v_exp_f32 v154, v154
    v_exp_f32 v155, v155
    v_exp_f32 v156, v156
    v_exp_f32 v157, v157
    v_mfma_f32_32x32x16_bf16 v[112:127], v[64:67], v[88:91], v[112:127]
    v_exp_f32 v158, v158
    v_exp_f32 v159, v159
    v_cvt_pk_bf16_f32 v92, v152, v153
    v_cvt_pk_bf16_f32 v93, v154, v155
    v_cvt_pk_bf16_f32 v94, v156, v157
    v_cvt_pk_bf16_f32 v95, v158, v159
    v_exp_f32 v160, v160
    v_exp_f32 v161, v161
    v_mfma_f32_32x32x16_bf16 v[112:127], v[68:71], v[92:95], v[112:127]
    ds_read_b128 v[64:67], v10 offset:5120
    v_exp_f32 v162, v162
    v_exp_f32 v163, v163
    v_exp_f32 v164, v164
    v_exp_f32 v165, v165
    v_exp_f32 v166, v166
    v_exp_f32 v167, v167
    s_waitcnt lgkmcnt(1)
    v_mfma_f32_32x32x16_bf16 v[128:143], v[48:51], v[24:27], 0
    s_mov_b32 m0, s53
    s_add_u32 s53, s53, 4096
    buffer_load_dwordx4 v2, s[24:27], s52 offen sc1 lds
    s_add_u32 s52, s52, 4096
    v_cvt_pk_bf16_f32 v80, v160, v161
    v_cvt_pk_bf16_f32 v81, v162, v163
    v_cvt_pk_bf16_f32 v82, v164, v165
    v_cvt_pk_bf16_f32 v83, v166, v167
    v_exp_f32 v168, v168
    v_exp_f32 v169, v169
    v_mfma_f32_32x32x16_bf16 v[144:159], v[48:51], v[28:31], 0
    ds_read_b128 v[68:71], v10 offset:5760
    v_exp_f32 v170, v170
    v_exp_f32 v171, v171
    v_exp_f32 v172, v172
    v_exp_f32 v173, v173
    v_exp_f32 v174, v174
    v_exp_f32 v175, v175
    v_mfma_f32_32x32x16_bf16 v[96:111], v[72:75], v[80:83], v[96:111]
    s_mov_b32 m0, s53
    s_add_u32 s53, s53, 4096
    buffer_load_dwordx4 v2, s[24:27], s52 offen sc1 lds
    s_add_u32 s52, s52, 4096
    v_cvt_pk_bf16_f32 v84, v168, v169
    v_cvt_pk_bf16_f32 v85, v170, v171
    v_cvt_pk_bf16_f32 v86, v172, v173
    v_cvt_pk_bf16_f32 v87, v174, v175
    v_exp_f32 v176, v176
    v_exp_f32 v177, v177
    v_mfma_f32_32x32x4_2b_bf16 v[128:159], v[56:57], v[32:33], v[128:159]
    ds_read_b128 v[52:55], v8 offset:5120
    v_exp_f32 v178, v178
    v_exp_f32 v179, v179
    v_exp_f32 v180, v180
    v_exp_f32 v181, v181
    v_exp_f32 v182, v182
    v_exp_f32 v183, v183
    v_cvt_pk_bf16_f32 v88, v176, v177
    v_cvt_pk_bf16_f32 v89, v178, v179
    v_cvt_pk_bf16_f32 v90, v180, v181
    v_mfma_f32_32x32x16_bf16 v[96:111], v[76:79], v[84:87], v[96:111]
    ds_read_b32 v60, v9 offset:640
    v_cvt_pk_bf16_f32 v91, v182, v183
    v_exp_f32 v184, v184
    v_exp_f32 v185, v185
    v_exp_f32 v186, v186
    v_exp_f32 v187, v187
    v_exp_f32 v188, v188
    v_exp_f32 v189, v189
    v_mfma_f32_32x32x16_bf16 v[112:127], v[72:75], v[88:91], v[112:127]
    v_exp_f32 v190, v190
    v_exp_f32 v191, v191
    v_cvt_pk_bf16_f32 v92, v184, v185
    v_cvt_pk_bf16_f32 v93, v186, v187
    v_cvt_pk_bf16_f32 v94, v188, v189
    v_cvt_pk_bf16_f32 v95, v190, v191
    v_exp_f32 v128, v128
    v_exp_f32 v129, v129
    v_mfma_f32_32x32x16_bf16 v[112:127], v[76:79], v[92:95], v[112:127]
    ds_read_b128 v[72:75], v10 offset:6400
    v_exp_f32 v130, v130
    v_exp_f32 v131, v131
    v_exp_f32 v132, v132
    v_exp_f32 v133, v133
    v_exp_f32 v134, v134
    v_exp_f32 v135, v135
    s_waitcnt lgkmcnt(1)
    v_mfma_f32_32x32x16_bf16 v[160:175], v[52:55], v[24:27], 0
    s_mov_b32 m0, s53
    s_add_u32 s53, s53, 4096
    buffer_load_dwordx4 v2, s[24:27], s52 offen sc1 lds
    s_add_u32 s52, s52, 4096
    v_cvt_pk_bf16_f32 v80, v128, v129
    v_cvt_pk_bf16_f32 v81, v130, v131
    v_cvt_pk_bf16_f32 v82, v132, v133
    v_cvt_pk_bf16_f32 v83, v134, v135
    v_exp_f32 v136, v136
    v_exp_f32 v137, v137
    v_mfma_f32_32x32x16_bf16 v[176:191], v[52:55], v[28:31], 0
    ds_read_b128 v[76:79], v10 offset:7040
    v_exp_f32 v138, v138
    v_exp_f32 v139, v139
    v_exp_f32 v140, v140
    v_exp_f32 v141, v141
    v_exp_f32 v142, v142
    v_exp_f32 v143, v143
    v_mfma_f32_32x32x16_bf16 v[96:111], v[64:67], v[80:83], v[96:111]
    v_cvt_pk_bf16_f32 v84, v136, v137
    v_cvt_pk_bf16_f32 v85, v138, v139
    v_cvt_pk_bf16_f32 v86, v140, v141
    v_cvt_pk_bf16_f32 v87, v142, v143
    v_exp_f32 v144, v144
    v_exp_f32 v145, v145
    v_mfma_f32_32x32x4_2b_bf16 v[160:191], v[60:61], v[32:33], v[160:191]
    ds_read_b128 v[48:51], v8 offset:6144
    v_exp_f32 v146, v146
    v_exp_f32 v147, v147
    v_exp_f32 v148, v148
    v_exp_f32 v149, v149
    v_exp_f32 v150, v150
    v_exp_f32 v151, v151
    v_cvt_pk_bf16_f32 v88, v144, v145
    v_cvt_pk_bf16_f32 v89, v146, v147
    v_cvt_pk_bf16_f32 v90, v148, v149
    v_mfma_f32_32x32x16_bf16 v[96:111], v[68:71], v[84:87], v[96:111]
    ds_read_b32 v56, v9 offset:768
    v_cvt_pk_bf16_f32 v91, v150, v151
    v_exp_f32 v152, v152
    v_exp_f32 v153, v153
    v_exp_f32 v154, v154
    v_exp_f32 v155, v155
    v_exp_f32 v156, v156
    v_exp_f32 v157, v157
    v_mfma_f32_32x32x16_bf16 v[112:127], v[64:67], v[88:91], v[112:127]
    v_exp_f32 v158, v158
    v_exp_f32 v159, v159
    v_cvt_pk_bf16_f32 v92, v152, v153
    v_cvt_pk_bf16_f32 v93, v154, v155
    v_cvt_pk_bf16_f32 v94, v156, v157
    v_cvt_pk_bf16_f32 v95, v158, v159
    v_exp_f32 v160, v160
    v_exp_f32 v161, v161
    v_mfma_f32_32x32x16_bf16 v[112:127], v[68:71], v[92:95], v[112:127]
    ds_read_b128 v[64:67], v10 offset:7680
    v_exp_f32 v162, v162
    v_exp_f32 v163, v163
    v_exp_f32 v164, v164
    v_exp_f32 v165, v165
    v_exp_f32 v166, v166
    v_exp_f32 v167, v167
    s_waitcnt lgkmcnt(1)
    v_mfma_f32_32x32x16_bf16 v[128:143], v[48:51], v[24:27], 0
    s_cmp_ge_u32 s42, 2
    s_cselect_b32 s48, 2048, 0
    s_sub_u32 s52, s52, s48
    s_sub_u32 s53, s53, s48
    s_mov_b32 m0, s53
    s_add_u32 s53, s53, 4096
    buffer_load_dwordx4 v2, s[24:27], s52 offen sc1 lds
    s_add_u32 s52, s52, 4096
    v_cvt_pk_bf16_f32 v80, v160, v161
    v_cvt_pk_bf16_f32 v81, v162, v163
    v_cvt_pk_bf16_f32 v82, v164, v165
    v_cvt_pk_bf16_f32 v83, v166, v167
    v_exp_f32 v168, v168
    v_exp_f32 v169, v169
    v_mfma_f32_32x32x16_bf16 v[144:159], v[48:51], v[28:31], 0
    ds_read_b128 v[68:71], v10 offset:8320
    v_exp_f32 v170, v170
    v_exp_f32 v171, v171
    v_exp_f32 v172, v172
    v_exp_f32 v173, v173
    v_exp_f32 v174, v174
    v_exp_f32 v175, v175
    v_mfma_f32_32x32x16_bf16 v[96:111], v[72:75], v[80:83], v[96:111]
    v_cvt_pk_bf16_f32 v84, v168, v169
    v_cvt_pk_bf16_f32 v85, v170, v171
    v_cvt_pk_bf16_f32 v86, v172, v173
    v_cvt_pk_bf16_f32 v87, v174, v175
    v_exp_f32 v176, v176
    v_exp_f32 v177, v177
    v_mfma_f32_32x32x4_2b_bf16 v[128:159], v[56:57], v[32:33], v[128:159]
    ds_read_b128 v[52:55], v8 offset:7168
    v_exp_f32 v178, v178
    v_exp_f32 v179, v179
    v_exp_f32 v180, v180
    v_exp_f32 v181, v181
    v_exp_f32 v182, v182
    v_exp_f32 v183, v183
    v_cvt_pk_bf16_f32 v88, v176, v177
    v_cvt_pk_bf16_f32 v89, v178, v179
    v_cvt_pk_bf16_f32 v90, v180, v181
    v_mfma_f32_32x32x16_bf16 v[96:111], v[76:79], v[84:87], v[96:111]
    ds_read_b32 v60, v9 offset:896
    v_cvt_pk_bf16_f32 v91, v182, v183
    v_exp_f32 v184, v184
    v_exp_f32 v185, v185
    v_exp_f32 v186, v186
    v_exp_f32 v187, v187
    v_exp_f32 v188, v188
    v_exp_f32 v189, v189
    v_mfma_f32_32x32x16_bf16 v[112:127], v[72:75], v[88:91], v[112:127]
    v_exp_f32 v190, v190
    v_exp_f32 v191, v191
    v_cvt_pk_bf16_f32 v92, v184, v185
    v_cvt_pk_bf16_f32 v93, v186, v187
    v_cvt_pk_bf16_f32 v94, v188, v189
    v_cvt_pk_bf16_f32 v95, v190, v191
    v_exp_f32 v128, v128
    v_exp_f32 v129, v129
    v_mfma_f32_32x32x16_bf16 v[112:127], v[76:79], v[92:95], v[112:127]
    ds_read_b128 v[72:75], v10 offset:8960
    v_exp_f32 v130, v130
    v_exp_f32 v131, v131
    v_exp_f32 v132, v132
    v_exp_f32 v133, v133
    v_exp_f32 v134, v134
    v_exp_f32 v135, v135
    s_waitcnt lgkmcnt(1)
    v_mfma_f32_32x32x16_bf16 v[160:175], v[52:55], v[24:27], 0
    v_cvt_pk_bf16_f32 v80, v128, v129
    v_cvt_pk_bf16_f32 v81, v130, v131
    v_cvt_pk_bf16_f32 v82, v132, v133
    v_cvt_pk_bf16_f32 v83, v134, v135
    v_exp_f32 v136, v136
    v_exp_f32 v137, v137
    v_mfma_f32_32x32x16_bf16 v[176:191], v[52:55], v[28:31], 0
    ds_read_b128 v[76:79], v10 offset:9600
    v_exp_f32 v138, v138
    v_exp_f32 v139, v139
    v_exp_f32 v140, v140
    v_exp_f32 v141, v141
    v_exp_f32 v142, v142
    v_exp_f32 v143, v143
    v_mfma_f32_32x32x16_bf16 v[96:111], v[64:67], v[80:83], v[96:111]
    v_cvt_pk_bf16_f32 v84, v136, v137
    v_cvt_pk_bf16_f32 v85, v138, v139
    v_cvt_pk_bf16_f32 v86, v140, v141
    v_cvt_pk_bf16_f32 v87, v142, v143
    v_exp_f32 v144, v144
    v_exp_f32 v145, v145
    v_mfma_f32_32x32x4_2b_bf16 v[160:191], v[60:61], v[32:33], v[160:191]
    ds_read_b128 v[48:51], v8 offset:8192
    v_exp_f32 v146, v146
    v_exp_f32 v147, v147
    v_exp_f32 v148, v148
    v_exp_f32 v149, v149
    v_exp_f32 v150, v150
    v_exp_f32 v151, v151
    v_cvt_pk_bf16_f32 v88, v144, v145
    v_cvt_pk_bf16_f32 v89, v146, v147
    v_cvt_pk_bf16_f32 v90, v148, v149
    v_mfma_f32_32x32x16_bf16 v[96:111], v[68:71], v[84:87], v[96:111]
    ds_read_b32 v56, v9 offset:1024
    v_cvt_pk_bf16_f32 v91, v150, v151
    v_exp_f32 v152, v152
    v_exp_f32 v153, v153
    v_exp_f32 v154, v154
    v_exp_f32 v155, v155
    v_exp_f32 v156, v156
    v_exp_f32 v157, v157
    v_mfma_f32_32x32x16_bf16 v[112:127], v[64:67], v[88:91], v[112:127]
    v_exp_f32 v158, v158
    v_exp_f32 v159, v159
    v_cvt_pk_bf16_f32 v92, v152, v153
    v_cvt_pk_bf16_f32 v93, v154, v155
    v_cvt_pk_bf16_f32 v94, v156, v157
    v_cvt_pk_bf16_f32 v95, v158, v159
    v_exp_f32 v160, v160
    v_exp_f32 v161, v161
    v_mfma_f32_32x32x16_bf16 v[112:127], v[68:71], v[92:95], v[112:127]
    ds_read_b128 v[64:67], v10 offset:10240
    v_exp_f32 v162, v162
    v_exp_f32 v163, v163
    v_exp_f32 v164, v164
    v_exp_f32 v165, v165
    v_exp_f32 v166, v166
    v_exp_f32 v167, v167
    s_waitcnt lgkmcnt(1)
    v_mfma_f32_32x32x16_bf16 v[128:143], v[48:51], v[24:27], 0
    v_cvt_pk_bf16_f32 v80, v160, v161
    v_cvt_pk_bf16_f32 v81, v162, v163
    v_cvt_pk_bf16_f32 v82, v164, v165
    v_cvt_pk_bf16_f32 v83, v166, v167
    v_exp_f32 v168, v168
    v_exp_f32 v169, v169
    v_mfma_f32_32x32x16_bf16 v[144:159], v[48:51], v[28:31], 0
    ds_read_b128 v[68:71], v10 offset:10880
    v_exp_f32 v170, v170
    v_exp_f32 v171, v171
    v_exp_f32 v172, v172
    v_exp_f32 v173, v173
    v_exp_f32 v174, v174
    v_exp_f32 v175, v175
    v_mfma_f32_32x32x16_bf16 v[96:111], v[72:75], v[80:83], v[96:111]
    v_cvt_pk_bf16_f32 v84, v168, v169
    v_cvt_pk_bf16_f32 v85, v170, v171
    v_cvt_pk_bf16_f32 v86, v172, v173
    v_cvt_pk_bf16_f32 v87, v174, v175
    v_exp_f32 v176, v176
    v_exp_f32 v177, v177
    v_mfma_f32_32x32x4_2b_bf16 v[128:159], v[56:57], v[32:33], v[128:159]
    ds_read_b128 v[52:55], v8 offset:9216
    v_exp_f32 v178, v178
    v_exp_f32 v179, v179
    v_exp_f32 v180, v180
    v_exp_f32 v181, v181
    v_exp_f32 v182, v182
    v_exp_f32 v183, v183
    v_cvt_pk_bf16_f32 v88, v176, v177
    v_cvt_pk_bf16_f32 v89, v178, v179
    v_cvt_pk_bf16_f32 v90, v180, v181
    v_mfma_f32_32x32x16_bf16 v[96:111], v[76:79], v[84:87], v[96:111]
    ds_read_b32 v60, v9 offset:1152
    v_cvt_pk_bf16_f32 v91, v182, v183
    v_exp_f32 v184, v184
    v_exp_f32 v185, v185
    v_exp_f32 v186, v186
    v_exp_f32 v187, v187
    v_exp_f32 v188, v188
    v_exp_f32 v189, v189
    v_mfma_f32_32x32x16_bf16 v[112:127], v[72:75], v[88:91], v[112:127]
    v_exp_f32 v190, v190
    v_exp_f32 v191, v191
    v_cvt_pk_bf16_f32 v92, v184, v185
    v_cvt_pk_bf16_f32 v93, v186, v187
    v_cvt_pk_bf16_f32 v94, v188, v189
    v_cvt_pk_bf16_f32 v95, v190, v191
    v_add_u32 v8, 8192, v8
    v_add_u32 v9, 1024, v9
    v_add_u32 v10, 10240, v10
    s_mov_b32 s28, s16
    s_and_b32 s29, s17, 0xffff
    s_mov_b32 s30, 5308416
    s_mov_b32 s31, 0x00020000
    s_bfe_u32 s46, s2, 0x20001
    s_mul_i32 s55, s46, 1327104
    s_lshr_b32 s46, s2, 3
    s_lshl_b32 s46, s46, 2
    s_add_u32 s46, s46, s42
    s_mul_i32 s46, s46, 10368
    s_add_u32 s55, s55, s46
    s_waitcnt vmcnt(0)
    s_barrier
    s_mov_b32 s54, 2
parallel_sum__softmax_full_mha__swiglu_ffn__prompt_kernel_p2loop:
    v_exp_f32 v128, v128
    v_exp_f32 v129, v129
    v_mfma_f32_32x32x16_bf16 v[112:127], v[76:79], v[92:95], v[112:127]
    ds_read_b128 v[72:75], v10 offset:1280
    v_exp_f32 v130, v130
    v_exp_f32 v131, v131
    v_exp_f32 v132, v132
    v_exp_f32 v133, v133
    v_exp_f32 v134, v134
    v_exp_f32 v135, v135
    s_waitcnt lgkmcnt(1)
    v_mfma_f32_32x32x16_bf16 v[160:175], v[52:55], v[24:27], 0
    buffer_load_dwordx4 v[224:227], v2, s[28:31], s55 offen
    s_add_u32 s55, s55, 1024
    v_cvt_pk_bf16_f32 v80, v128, v129
    v_cvt_pk_bf16_f32 v81, v130, v131
    v_cvt_pk_bf16_f32 v82, v132, v133
    v_cvt_pk_bf16_f32 v83, v134, v135
    v_exp_f32 v136, v136
    v_exp_f32 v137, v137
    v_mfma_f32_32x32x16_bf16 v[176:191], v[52:55], v[28:31], 0
    ds_read_b128 v[76:79], v10 offset:1920
    v_exp_f32 v138, v138
    v_exp_f32 v139, v139
    v_exp_f32 v140, v140
    v_exp_f32 v141, v141
    v_exp_f32 v142, v142
    v_exp_f32 v143, v143
    v_mfma_f32_32x32x16_bf16 v[96:111], v[64:67], v[80:83], v[96:111]
    v_cvt_pk_bf16_f32 v84, v136, v137
    v_cvt_pk_bf16_f32 v85, v138, v139
    v_cvt_pk_bf16_f32 v86, v140, v141
    v_cvt_pk_bf16_f32 v87, v142, v143
    v_exp_f32 v144, v144
    v_exp_f32 v145, v145
    v_mfma_f32_32x32x4_2b_bf16 v[160:191], v[60:61], v[32:33], v[160:191]
    ds_read_b128 v[48:51], v8 offset:2048
    v_exp_f32 v146, v146
    v_exp_f32 v147, v147
    v_exp_f32 v148, v148
    v_exp_f32 v149, v149
    v_exp_f32 v150, v150
    v_exp_f32 v151, v151
    v_cvt_pk_bf16_f32 v88, v144, v145
    v_cvt_pk_bf16_f32 v89, v146, v147
    v_cvt_pk_bf16_f32 v90, v148, v149
    v_mfma_f32_32x32x16_bf16 v[96:111], v[68:71], v[84:87], v[96:111]
    ds_read_b32 v56, v9 offset:256
    v_cvt_pk_bf16_f32 v91, v150, v151
    v_exp_f32 v152, v152
    v_exp_f32 v153, v153
    v_exp_f32 v154, v154
    v_exp_f32 v155, v155
    v_exp_f32 v156, v156
    v_exp_f32 v157, v157
    v_mfma_f32_32x32x16_bf16 v[112:127], v[64:67], v[88:91], v[112:127]
    v_exp_f32 v158, v158
    v_exp_f32 v159, v159
    v_cvt_pk_bf16_f32 v92, v152, v153
    v_cvt_pk_bf16_f32 v93, v154, v155
    v_cvt_pk_bf16_f32 v94, v156, v157
    v_cvt_pk_bf16_f32 v95, v158, v159
    v_exp_f32 v160, v160
    v_exp_f32 v161, v161
    v_mfma_f32_32x32x16_bf16 v[112:127], v[68:71], v[92:95], v[112:127]
    ds_read_b128 v[64:67], v10 offset:2560
    v_exp_f32 v162, v162
    v_exp_f32 v163, v163
    v_exp_f32 v164, v164
    v_exp_f32 v165, v165
    v_exp_f32 v166, v166
    v_exp_f32 v167, v167
    s_waitcnt lgkmcnt(1)
    v_mfma_f32_32x32x16_bf16 v[128:143], v[48:51], v[24:27], 0
    v_cvt_pk_bf16_f32 v80, v160, v161
    v_cvt_pk_bf16_f32 v81, v162, v163
    v_cvt_pk_bf16_f32 v82, v164, v165
    v_cvt_pk_bf16_f32 v83, v166, v167
    v_exp_f32 v168, v168
    v_exp_f32 v169, v169
    v_mfma_f32_32x32x16_bf16 v[144:159], v[48:51], v[28:31], 0
    ds_read_b128 v[68:71], v10 offset:3200
    v_exp_f32 v170, v170
    v_exp_f32 v171, v171
    v_exp_f32 v172, v172
    v_exp_f32 v173, v173
    v_exp_f32 v174, v174
    v_exp_f32 v175, v175
    v_mfma_f32_32x32x16_bf16 v[96:111], v[72:75], v[80:83], v[96:111]
    v_cvt_pk_bf16_f32 v84, v168, v169
    v_cvt_pk_bf16_f32 v85, v170, v171
    v_cvt_pk_bf16_f32 v86, v172, v173
    v_cvt_pk_bf16_f32 v87, v174, v175
    v_exp_f32 v176, v176
    v_exp_f32 v177, v177
    v_mfma_f32_32x32x4_2b_bf16 v[128:159], v[56:57], v[32:33], v[128:159]
    ds_read_b128 v[52:55], v8 offset:3072
    v_exp_f32 v178, v178
    v_exp_f32 v179, v179
    v_exp_f32 v180, v180
    v_exp_f32 v181, v181
    v_exp_f32 v182, v182
    v_exp_f32 v183, v183
    v_cvt_pk_bf16_f32 v88, v176, v177
    v_cvt_pk_bf16_f32 v89, v178, v179
    v_cvt_pk_bf16_f32 v90, v180, v181
    v_mfma_f32_32x32x16_bf16 v[96:111], v[76:79], v[84:87], v[96:111]
    ds_read_b32 v60, v9 offset:384
    v_cvt_pk_bf16_f32 v91, v182, v183
    v_exp_f32 v184, v184
    v_exp_f32 v185, v185
    v_exp_f32 v186, v186
    v_exp_f32 v187, v187
    v_exp_f32 v188, v188
    v_exp_f32 v189, v189
    v_mfma_f32_32x32x16_bf16 v[112:127], v[72:75], v[88:91], v[112:127]
    v_exp_f32 v190, v190
    v_exp_f32 v191, v191
    v_cvt_pk_bf16_f32 v92, v184, v185
    v_cvt_pk_bf16_f32 v93, v186, v187
    v_cvt_pk_bf16_f32 v94, v188, v189
    v_cvt_pk_bf16_f32 v95, v190, v191
    v_exp_f32 v128, v128
    v_exp_f32 v129, v129
    v_mfma_f32_32x32x16_bf16 v[112:127], v[76:79], v[92:95], v[112:127]
    ds_read_b128 v[72:75], v10 offset:3840
    v_exp_f32 v130, v130
    v_exp_f32 v131, v131
    v_exp_f32 v132, v132
    v_exp_f32 v133, v133
    v_exp_f32 v134, v134
    v_exp_f32 v135, v135
    s_waitcnt lgkmcnt(1)
    v_mfma_f32_32x32x16_bf16 v[160:175], v[52:55], v[24:27], 0
    buffer_load_dwordx4 v[224:227], v2, s[28:31], s55 offen
    s_add_u32 s55, s55, 1024
    v_cvt_pk_bf16_f32 v80, v128, v129
    v_cvt_pk_bf16_f32 v81, v130, v131
    v_cvt_pk_bf16_f32 v82, v132, v133
    v_cvt_pk_bf16_f32 v83, v134, v135
    v_exp_f32 v136, v136
    v_exp_f32 v137, v137
    v_mfma_f32_32x32x16_bf16 v[176:191], v[52:55], v[28:31], 0
    ds_read_b128 v[76:79], v10 offset:4480
    v_exp_f32 v138, v138
    v_exp_f32 v139, v139
    v_exp_f32 v140, v140
    v_exp_f32 v141, v141
    v_exp_f32 v142, v142
    v_exp_f32 v143, v143
    v_mfma_f32_32x32x16_bf16 v[96:111], v[64:67], v[80:83], v[96:111]
    v_cvt_pk_bf16_f32 v84, v136, v137
    v_cvt_pk_bf16_f32 v85, v138, v139
    v_cvt_pk_bf16_f32 v86, v140, v141
    v_cvt_pk_bf16_f32 v87, v142, v143
    v_exp_f32 v144, v144
    v_exp_f32 v145, v145
    v_mfma_f32_32x32x4_2b_bf16 v[160:191], v[60:61], v[32:33], v[160:191]
    ds_read_b128 v[48:51], v8 offset:4096
    v_exp_f32 v146, v146
    v_exp_f32 v147, v147
    v_exp_f32 v148, v148
    v_exp_f32 v149, v149
    v_exp_f32 v150, v150
    v_exp_f32 v151, v151
    v_cvt_pk_bf16_f32 v88, v144, v145
    v_cvt_pk_bf16_f32 v89, v146, v147
    v_cvt_pk_bf16_f32 v90, v148, v149
    v_mfma_f32_32x32x16_bf16 v[96:111], v[68:71], v[84:87], v[96:111]
    ds_read_b32 v56, v9 offset:512
    v_cvt_pk_bf16_f32 v91, v150, v151
    v_exp_f32 v152, v152
    v_exp_f32 v153, v153
    v_exp_f32 v154, v154
    v_exp_f32 v155, v155
    v_exp_f32 v156, v156
    v_exp_f32 v157, v157
    v_mfma_f32_32x32x16_bf16 v[112:127], v[64:67], v[88:91], v[112:127]
    v_exp_f32 v158, v158
    v_exp_f32 v159, v159
    v_cvt_pk_bf16_f32 v92, v152, v153
    v_cvt_pk_bf16_f32 v93, v154, v155
    v_cvt_pk_bf16_f32 v94, v156, v157
    v_cvt_pk_bf16_f32 v95, v158, v159
    v_exp_f32 v160, v160
    v_exp_f32 v161, v161
    v_mfma_f32_32x32x16_bf16 v[112:127], v[68:71], v[92:95], v[112:127]
    ds_read_b128 v[64:67], v10 offset:5120
    v_exp_f32 v162, v162
    v_exp_f32 v163, v163
    v_exp_f32 v164, v164
    v_exp_f32 v165, v165
    v_exp_f32 v166, v166
    v_exp_f32 v167, v167
    s_waitcnt lgkmcnt(1)
    v_mfma_f32_32x32x16_bf16 v[128:143], v[48:51], v[24:27], 0
    v_cvt_pk_bf16_f32 v80, v160, v161
    v_cvt_pk_bf16_f32 v81, v162, v163
    v_cvt_pk_bf16_f32 v82, v164, v165
    v_cvt_pk_bf16_f32 v83, v166, v167
    v_exp_f32 v168, v168
    v_exp_f32 v169, v169
    v_mfma_f32_32x32x16_bf16 v[144:159], v[48:51], v[28:31], 0
    ds_read_b128 v[68:71], v10 offset:5760
    v_exp_f32 v170, v170
    v_exp_f32 v171, v171
    v_exp_f32 v172, v172
    v_exp_f32 v173, v173
    v_exp_f32 v174, v174
    v_exp_f32 v175, v175
    v_mfma_f32_32x32x16_bf16 v[96:111], v[72:75], v[80:83], v[96:111]
    v_cvt_pk_bf16_f32 v84, v168, v169
    v_cvt_pk_bf16_f32 v85, v170, v171
    v_cvt_pk_bf16_f32 v86, v172, v173
    v_cvt_pk_bf16_f32 v87, v174, v175
    v_exp_f32 v176, v176
    v_exp_f32 v177, v177
    v_mfma_f32_32x32x4_2b_bf16 v[128:159], v[56:57], v[32:33], v[128:159]
    ds_read_b128 v[52:55], v8 offset:5120
    v_exp_f32 v178, v178
    v_exp_f32 v179, v179
    v_exp_f32 v180, v180
    v_exp_f32 v181, v181
    v_exp_f32 v182, v182
    v_exp_f32 v183, v183
    v_cvt_pk_bf16_f32 v88, v176, v177
    v_cvt_pk_bf16_f32 v89, v178, v179
    v_cvt_pk_bf16_f32 v90, v180, v181
    v_mfma_f32_32x32x16_bf16 v[96:111], v[76:79], v[84:87], v[96:111]
    ds_read_b32 v60, v9 offset:640
    v_cvt_pk_bf16_f32 v91, v182, v183
    v_exp_f32 v184, v184
    v_exp_f32 v185, v185
    v_exp_f32 v186, v186
    v_exp_f32 v187, v187
    v_exp_f32 v188, v188
    v_exp_f32 v189, v189
    v_mfma_f32_32x32x16_bf16 v[112:127], v[72:75], v[88:91], v[112:127]
    v_exp_f32 v190, v190
    v_exp_f32 v191, v191
    v_cvt_pk_bf16_f32 v92, v184, v185
    v_cvt_pk_bf16_f32 v93, v186, v187
    v_cvt_pk_bf16_f32 v94, v188, v189
    v_cvt_pk_bf16_f32 v95, v190, v191
    v_exp_f32 v128, v128
    v_exp_f32 v129, v129
    v_mfma_f32_32x32x16_bf16 v[112:127], v[76:79], v[92:95], v[112:127]
    ds_read_b128 v[72:75], v10 offset:6400
    v_exp_f32 v130, v130
    v_exp_f32 v131, v131
    v_exp_f32 v132, v132
    v_exp_f32 v133, v133
    v_exp_f32 v134, v134
    v_exp_f32 v135, v135
    s_waitcnt lgkmcnt(1)
    v_mfma_f32_32x32x16_bf16 v[160:175], v[52:55], v[24:27], 0
    buffer_load_dwordx4 v[224:227], v2, s[28:31], s55 offen
    s_add_u32 s55, s55, 1024
    v_cvt_pk_bf16_f32 v80, v128, v129
    v_cvt_pk_bf16_f32 v81, v130, v131
    v_cvt_pk_bf16_f32 v82, v132, v133
    v_cvt_pk_bf16_f32 v83, v134, v135
    v_exp_f32 v136, v136
    v_exp_f32 v137, v137
    v_mfma_f32_32x32x16_bf16 v[176:191], v[52:55], v[28:31], 0
    ds_read_b128 v[76:79], v10 offset:7040
    v_exp_f32 v138, v138
    v_exp_f32 v139, v139
    v_exp_f32 v140, v140
    v_exp_f32 v141, v141
    v_exp_f32 v142, v142
    v_exp_f32 v143, v143
    v_mfma_f32_32x32x16_bf16 v[96:111], v[64:67], v[80:83], v[96:111]
    v_cvt_pk_bf16_f32 v84, v136, v137
    v_cvt_pk_bf16_f32 v85, v138, v139
    v_cvt_pk_bf16_f32 v86, v140, v141
    v_cvt_pk_bf16_f32 v87, v142, v143
    v_exp_f32 v144, v144
    v_exp_f32 v145, v145
    v_mfma_f32_32x32x4_2b_bf16 v[160:191], v[60:61], v[32:33], v[160:191]
    ds_read_b128 v[48:51], v8 offset:6144
    v_exp_f32 v146, v146
    v_exp_f32 v147, v147
    v_exp_f32 v148, v148
    v_exp_f32 v149, v149
    v_exp_f32 v150, v150
    v_exp_f32 v151, v151
    v_cvt_pk_bf16_f32 v88, v144, v145
    v_cvt_pk_bf16_f32 v89, v146, v147
    v_cvt_pk_bf16_f32 v90, v148, v149
    v_mfma_f32_32x32x16_bf16 v[96:111], v[68:71], v[84:87], v[96:111]
    ds_read_b32 v56, v9 offset:768
    v_cvt_pk_bf16_f32 v91, v150, v151
    v_exp_f32 v152, v152
    v_exp_f32 v153, v153
    v_exp_f32 v154, v154
    v_exp_f32 v155, v155
    v_exp_f32 v156, v156
    v_exp_f32 v157, v157
    v_mfma_f32_32x32x16_bf16 v[112:127], v[64:67], v[88:91], v[112:127]
    v_exp_f32 v158, v158
    v_exp_f32 v159, v159
    v_cvt_pk_bf16_f32 v92, v152, v153
    v_cvt_pk_bf16_f32 v93, v154, v155
    v_cvt_pk_bf16_f32 v94, v156, v157
    v_cvt_pk_bf16_f32 v95, v158, v159
    v_exp_f32 v160, v160
    v_exp_f32 v161, v161
    v_mfma_f32_32x32x16_bf16 v[112:127], v[68:71], v[92:95], v[112:127]
    ds_read_b128 v[64:67], v10 offset:7680
    v_exp_f32 v162, v162
    v_exp_f32 v163, v163
    v_exp_f32 v164, v164
    v_exp_f32 v165, v165
    v_exp_f32 v166, v166
    v_exp_f32 v167, v167
    s_waitcnt lgkmcnt(1)
    v_mfma_f32_32x32x16_bf16 v[128:143], v[48:51], v[24:27], 0
    v_cvt_pk_bf16_f32 v80, v160, v161
    v_cvt_pk_bf16_f32 v81, v162, v163
    v_cvt_pk_bf16_f32 v82, v164, v165
    v_cvt_pk_bf16_f32 v83, v166, v167
    v_exp_f32 v168, v168
    v_exp_f32 v169, v169
    v_mfma_f32_32x32x16_bf16 v[144:159], v[48:51], v[28:31], 0
    ds_read_b128 v[68:71], v10 offset:8320
    v_exp_f32 v170, v170
    v_exp_f32 v171, v171
    v_exp_f32 v172, v172
    v_exp_f32 v173, v173
    v_exp_f32 v174, v174
    v_exp_f32 v175, v175
    v_mfma_f32_32x32x16_bf16 v[96:111], v[72:75], v[80:83], v[96:111]
    v_cvt_pk_bf16_f32 v84, v168, v169
    v_cvt_pk_bf16_f32 v85, v170, v171
    v_cvt_pk_bf16_f32 v86, v172, v173
    v_cvt_pk_bf16_f32 v87, v174, v175
    v_exp_f32 v176, v176
    v_exp_f32 v177, v177
    v_mfma_f32_32x32x4_2b_bf16 v[128:159], v[56:57], v[32:33], v[128:159]
    ds_read_b128 v[52:55], v8 offset:7168
    v_exp_f32 v178, v178
    v_exp_f32 v179, v179
    v_exp_f32 v180, v180
    v_exp_f32 v181, v181
    v_exp_f32 v182, v182
    v_exp_f32 v183, v183
    v_cvt_pk_bf16_f32 v88, v176, v177
    v_cvt_pk_bf16_f32 v89, v178, v179
    v_cvt_pk_bf16_f32 v90, v180, v181
    v_mfma_f32_32x32x16_bf16 v[96:111], v[76:79], v[84:87], v[96:111]
    ds_read_b32 v60, v9 offset:896
    v_cvt_pk_bf16_f32 v91, v182, v183
    v_exp_f32 v184, v184
    v_exp_f32 v185, v185
    v_exp_f32 v186, v186
    v_exp_f32 v187, v187
    v_exp_f32 v188, v188
    v_exp_f32 v189, v189
    v_mfma_f32_32x32x16_bf16 v[112:127], v[72:75], v[88:91], v[112:127]
    v_exp_f32 v190, v190
    v_exp_f32 v191, v191
    v_cvt_pk_bf16_f32 v92, v184, v185
    v_cvt_pk_bf16_f32 v93, v186, v187
    v_cvt_pk_bf16_f32 v94, v188, v189
    v_cvt_pk_bf16_f32 v95, v190, v191
    v_exp_f32 v128, v128
    v_exp_f32 v129, v129
    v_mfma_f32_32x32x16_bf16 v[112:127], v[76:79], v[92:95], v[112:127]
    ds_read_b128 v[72:75], v10 offset:8960
    v_exp_f32 v130, v130
    v_exp_f32 v131, v131
    v_exp_f32 v132, v132
    v_exp_f32 v133, v133
    v_exp_f32 v134, v134
    v_exp_f32 v135, v135
    s_waitcnt lgkmcnt(1)
    v_mfma_f32_32x32x16_bf16 v[160:175], v[52:55], v[24:27], 0
    v_cvt_pk_bf16_f32 v80, v128, v129
    v_cvt_pk_bf16_f32 v81, v130, v131
    v_cvt_pk_bf16_f32 v82, v132, v133
    v_cvt_pk_bf16_f32 v83, v134, v135
    v_exp_f32 v136, v136
    v_exp_f32 v137, v137
    v_mfma_f32_32x32x16_bf16 v[176:191], v[52:55], v[28:31], 0
    ds_read_b128 v[76:79], v10 offset:9600
    v_exp_f32 v138, v138
    v_exp_f32 v139, v139
    v_exp_f32 v140, v140
    v_exp_f32 v141, v141
    v_exp_f32 v142, v142
    v_exp_f32 v143, v143
    v_mfma_f32_32x32x16_bf16 v[96:111], v[64:67], v[80:83], v[96:111]
    v_cvt_pk_bf16_f32 v84, v136, v137
    v_cvt_pk_bf16_f32 v85, v138, v139
    v_cvt_pk_bf16_f32 v86, v140, v141
    v_cvt_pk_bf16_f32 v87, v142, v143
    v_exp_f32 v144, v144
    v_exp_f32 v145, v145
    v_mfma_f32_32x32x4_2b_bf16 v[160:191], v[60:61], v[32:33], v[160:191]
    ds_read_b128 v[48:51], v8 offset:8192
    v_exp_f32 v146, v146
    v_exp_f32 v147, v147
    v_exp_f32 v148, v148
    v_exp_f32 v149, v149
    v_exp_f32 v150, v150
    v_exp_f32 v151, v151
    v_cvt_pk_bf16_f32 v88, v144, v145
    v_cvt_pk_bf16_f32 v89, v146, v147
    v_cvt_pk_bf16_f32 v90, v148, v149
    v_mfma_f32_32x32x16_bf16 v[96:111], v[68:71], v[84:87], v[96:111]
    ds_read_b32 v56, v9 offset:1024
    v_cvt_pk_bf16_f32 v91, v150, v151
    v_exp_f32 v152, v152
    v_exp_f32 v153, v153
    v_exp_f32 v154, v154
    v_exp_f32 v155, v155
    v_exp_f32 v156, v156
    v_exp_f32 v157, v157
    v_mfma_f32_32x32x16_bf16 v[112:127], v[64:67], v[88:91], v[112:127]
    v_exp_f32 v158, v158
    v_exp_f32 v159, v159
    v_cvt_pk_bf16_f32 v92, v152, v153
    v_cvt_pk_bf16_f32 v93, v154, v155
    v_cvt_pk_bf16_f32 v94, v156, v157
    v_cvt_pk_bf16_f32 v95, v158, v159
    v_exp_f32 v160, v160
    v_exp_f32 v161, v161
    v_mfma_f32_32x32x16_bf16 v[112:127], v[68:71], v[92:95], v[112:127]
    ds_read_b128 v[64:67], v10 offset:10240
    v_exp_f32 v162, v162
    v_exp_f32 v163, v163
    v_exp_f32 v164, v164
    v_exp_f32 v165, v165
    v_exp_f32 v166, v166
    v_exp_f32 v167, v167
    s_waitcnt lgkmcnt(1)
    v_mfma_f32_32x32x16_bf16 v[128:143], v[48:51], v[24:27], 0
    v_cvt_pk_bf16_f32 v80, v160, v161
    v_cvt_pk_bf16_f32 v81, v162, v163
    v_cvt_pk_bf16_f32 v82, v164, v165
    v_cvt_pk_bf16_f32 v83, v166, v167
    v_exp_f32 v168, v168
    v_exp_f32 v169, v169
    v_mfma_f32_32x32x16_bf16 v[144:159], v[48:51], v[28:31], 0
    ds_read_b128 v[68:71], v10 offset:10880
    v_exp_f32 v170, v170
    v_exp_f32 v171, v171
    v_exp_f32 v172, v172
    v_exp_f32 v173, v173
    v_exp_f32 v174, v174
    v_exp_f32 v175, v175
    v_mfma_f32_32x32x16_bf16 v[96:111], v[72:75], v[80:83], v[96:111]
    v_cvt_pk_bf16_f32 v84, v168, v169
    v_cvt_pk_bf16_f32 v85, v170, v171
    v_cvt_pk_bf16_f32 v86, v172, v173
    v_cvt_pk_bf16_f32 v87, v174, v175
    v_exp_f32 v176, v176
    v_exp_f32 v177, v177
    v_mfma_f32_32x32x4_2b_bf16 v[128:159], v[56:57], v[32:33], v[128:159]
    ds_read_b128 v[52:55], v8 offset:9216
    v_exp_f32 v178, v178
    v_exp_f32 v179, v179
    v_exp_f32 v180, v180
    v_exp_f32 v181, v181
    v_exp_f32 v182, v182
    v_exp_f32 v183, v183
    v_cvt_pk_bf16_f32 v88, v176, v177
    v_cvt_pk_bf16_f32 v89, v178, v179
    v_cvt_pk_bf16_f32 v90, v180, v181
    v_mfma_f32_32x32x16_bf16 v[96:111], v[76:79], v[84:87], v[96:111]
    ds_read_b32 v60, v9 offset:1152
    v_cvt_pk_bf16_f32 v91, v182, v183
    v_exp_f32 v184, v184
    v_exp_f32 v185, v185
    v_exp_f32 v186, v186
    v_exp_f32 v187, v187
    v_exp_f32 v188, v188
    v_exp_f32 v189, v189
    v_mfma_f32_32x32x16_bf16 v[112:127], v[72:75], v[88:91], v[112:127]
    v_exp_f32 v190, v190
    v_exp_f32 v191, v191
    v_cvt_pk_bf16_f32 v92, v184, v185
    v_cvt_pk_bf16_f32 v93, v186, v187
    v_cvt_pk_bf16_f32 v94, v188, v189
    v_cvt_pk_bf16_f32 v95, v190, v191
    v_add_u32 v8, 8192, v8
    v_add_u32 v9, 1024, v9
    v_add_u32 v10, 10240, v10
    s_add_u32 s54, s54, 1
    s_cmp_lt_u32 s54, 6
    s_cbranch_scc1 parallel_sum__softmax_full_mha__swiglu_ffn__prompt_kernel_p2loop
    s_waitcnt vmcnt(0)
    v_exp_f32 v128, v128
    v_exp_f32 v129, v129
    v_mfma_f32_32x32x16_bf16 v[112:127], v[76:79], v[92:95], v[112:127]
    ds_read_b128 v[72:75], v10 offset:1280
    v_and_b32 v3, 7, v0
    v_lshlrev_b32 v3, 5, v3
    s_lshr_b32 s47, s2, 6
    s_lshl_b32 s47, s47, 3
    v_add_u32 v3, s47, v3
    s_and_b32 s47, s2, 7
    v_add_u32 v3, s47, v3
    v_lshlrev_b32 v6, 7, v3
    v_add_u32 v6, 16, v6
    s_mov_b64 exec, 255
    buffer_load_dwordx2 v[4:5], v6, s[24:27], 0 offen sc1
    s_mov_b64 exec, -1
    v_exp_f32 v130, v130
    v_exp_f32 v131, v131
    v_exp_f32 v132, v132
    v_exp_f32 v133, v133
    v_exp_f32 v134, v134
    v_exp_f32 v135, v135
    s_waitcnt lgkmcnt(1)
    v_mfma_f32_32x32x16_bf16 v[160:175], v[52:55], v[24:27], 0
    s_bfe_u32 s55, s2, 0x20001
    s_and_b32 s56, s2, 1
    s_lshl_b32 s56, s56, 3
    s_lshr_b32 s46, s2, 5
    s_add_u32 s56, s56, s46
    s_bfe_u32 s57, s2, 0x20003
    s_lshl_b32 s58, s56, 2
    s_add_u32 s58, s58, s42
    v_cvt_pk_bf16_f32 v80, v128, v129
    v_cvt_pk_bf16_f32 v81, v130, v131
    v_cvt_pk_bf16_f32 v82, v132, v133
    v_cvt_pk_bf16_f32 v83, v134, v135
    v_exp_f32 v136, v136
    v_exp_f32 v137, v137
    v_mfma_f32_32x32x16_bf16 v[176:191], v[52:55], v[28:31], 0
    ds_read_b128 v[76:79], v10 offset:1920
    s_mul_i32 s59, s58, 294912
    s_mul_i32 s46, s55, 73728
    s_add_u32 s59, s59, s46
    s_add_u32 s59, s59, 9732096
    v_lshlrev_b32 v12, 2, v0
    v_add_u32 v12, 157696, v12
    ds_read_b32 v222, v12 offset:5120
    v_exp_f32 v138, v138
    v_exp_f32 v139, v139
    v_exp_f32 v140, v140
    v_exp_f32 v141, v141
    v_exp_f32 v142, v142
    v_exp_f32 v143, v143
    v_mfma_f32_32x32x16_bf16 v[96:111], v[64:67], v[80:83], v[96:111]
    v_cvt_pk_bf16_f32 v84, v136, v137
    v_cvt_pk_bf16_f32 v85, v138, v139
    v_cvt_pk_bf16_f32 v86, v140, v141
    v_cvt_pk_bf16_f32 v87, v142, v143
    v_exp_f32 v144, v144
    v_exp_f32 v145, v145
    v_mfma_f32_32x32x4_2b_bf16 v[160:191], v[60:61], v[32:33], v[160:191]
    ds_read_b128 v[48:51], v8 offset:2048
    ds_read_b32 v192, v12 offset:0
    ds_read_b32 v193, v12 offset:256
    ds_read_b32 v194, v12 offset:512
    ds_read_b32 v195, v12 offset:768
    ds_read_b32 v196, v12 offset:1024
    ds_read_b32 v197, v12 offset:1280
    ds_read_b32 v198, v12 offset:1536
    v_exp_f32 v146, v146
    v_exp_f32 v147, v147
    v_exp_f32 v148, v148
    v_exp_f32 v149, v149
    v_exp_f32 v150, v150
    v_exp_f32 v151, v151
    v_cvt_pk_bf16_f32 v88, v144, v145
    v_cvt_pk_bf16_f32 v89, v146, v147
    v_cvt_pk_bf16_f32 v90, v148, v149
    v_mfma_f32_32x32x16_bf16 v[96:111], v[68:71], v[84:87], v[96:111]
    ds_read_b32 v56, v9 offset:256
    ds_read_b32 v199, v12 offset:1792
    ds_read_b32 v200, v12 offset:2048
    ds_read_b32 v201, v12 offset:2304
    ds_read_b32 v210, v12 offset:2560
    ds_read_b32 v211, v12 offset:2816
    ds_read_b32 v212, v12 offset:3072
    ds_read_b32 v213, v12 offset:3328
    v_cvt_pk_bf16_f32 v91, v150, v151
    v_exp_f32 v152, v152
    v_exp_f32 v153, v153
    v_exp_f32 v154, v154
    v_exp_f32 v155, v155
    v_exp_f32 v156, v156
    v_exp_f32 v157, v157
    v_mfma_f32_32x32x16_bf16 v[112:127], v[64:67], v[88:91], v[112:127]
    v_exp_f32 v158, v158
    v_exp_f32 v159, v159
    v_cvt_pk_bf16_f32 v92, v152, v153
    v_cvt_pk_bf16_f32 v93, v154, v155
    v_cvt_pk_bf16_f32 v94, v156, v157
    v_cvt_pk_bf16_f32 v95, v158, v159
    v_exp_f32 v160, v160
    v_exp_f32 v161, v161
    v_mfma_f32_32x32x16_bf16 v[112:127], v[68:71], v[92:95], v[112:127]
    ds_read_b128 v[64:67], v10 offset:2560
    ds_read_b32 v214, v12 offset:3584
    ds_read_b32 v215, v12 offset:3840
    ds_read_b32 v216, v12 offset:4096
    ds_read_b32 v217, v12 offset:4352
    ds_read_b32 v218, v12 offset:4608
    ds_read_b32 v219, v12 offset:4864
    s_mul_i32 s60, s55, 1152
    v_exp_f32 v162, v162
    v_exp_f32 v163, v163
    v_exp_f32 v164, v164
    v_exp_f32 v165, v165
    v_exp_f32 v166, v166
    v_exp_f32 v167, v167
    s_waitcnt lgkmcnt(1)
    v_mfma_f32_32x32x16_bf16 v[128:143], v[48:51], v[24:27], 0
    s_lshl_b32 s46, s42, 5
    s_add_u32 s60, s60, s46
    s_mul_i32 s60, s60, 1152
    s_mov_b32 s62, 0
    s_mov_b32 s63, 73728
    s_mov_b32 s64, 36864
    s_mov_b32 s68, 110592
    v_cvt_pk_bf16_f32 v80, v160, v161
    v_cvt_pk_bf16_f32 v81, v162, v163
    v_cvt_pk_bf16_f32 v82, v164, v165
    v_cvt_pk_bf16_f32 v83, v166, v167
    v_exp_f32 v168, v168
    v_exp_f32 v169, v169
    v_mfma_f32_32x32x16_bf16 v[144:159], v[48:51], v[28:31], 0
    ds_read_b128 v[68:71], v10 offset:3200
    s_waitcnt vmcnt(0)
    s_mov_b64 exec, 255
    v_cmp_ne_u32 vcc, s44, v4
    v_cmp_ne_u32 s[48:49], s45, v5
    s_nop 0
    s_or_b64 vcc, vcc, s[48:49]
    s_nop 1
    s_cbranch_vccnz L_pslow_19
L_pback_20:
    s_mov_b64 exec, -1
    v_exp_f32 v170, v170
    v_exp_f32 v171, v171
    v_exp_f32 v172, v172
    v_exp_f32 v173, v173
    v_exp_f32 v174, v174
    v_exp_f32 v175, v175
    v_mfma_f32_32x32x16_bf16 v[96:111], v[72:75], v[80:83], v[96:111]
    v_cvt_pk_bf16_f32 v84, v168, v169
    v_cvt_pk_bf16_f32 v85, v170, v171
    v_cvt_pk_bf16_f32 v86, v172, v173
    v_cvt_pk_bf16_f32 v87, v174, v175
    v_exp_f32 v176, v176
    v_exp_f32 v177, v177
    v_mfma_f32_32x32x4_2b_bf16 v[128:159], v[56:57], v[32:33], v[128:159]
    ds_read_b128 v[52:55], v8 offset:3072
    buffer_load_dwordx4 a[0:3], v222, s[24:27], s59 offen offset:0 sc1
    v_exp_f32 v178, v178
    v_exp_f32 v179, v179
    v_exp_f32 v180, v180
    v_exp_f32 v181, v181
    v_exp_f32 v182, v182
    v_exp_f32 v183, v183
    v_cvt_pk_bf16_f32 v88, v176, v177
    v_cvt_pk_bf16_f32 v89, v178, v179
    v_cvt_pk_bf16_f32 v90, v180, v181
    v_mfma_f32_32x32x16_bf16 v[96:111], v[76:79], v[84:87], v[96:111]
    ds_read_b32 v60, v9 offset:384
    buffer_load_dwordx4 a[4:7], v222, s[24:27], s59 offen offset:256 sc1
    v_cvt_pk_bf16_f32 v91, v182, v183
    v_exp_f32 v184, v184
    v_exp_f32 v185, v185
    v_exp_f32 v186, v186
    v_exp_f32 v187, v187
    v_exp_f32 v188, v188
    v_exp_f32 v189, v189
    v_mfma_f32_32x32x16_bf16 v[112:127], v[72:75], v[88:91], v[112:127]
    v_exp_f32 v190, v190
    v_exp_f32 v191, v191
    v_cvt_pk_bf16_f32 v92, v184, v185
    v_cvt_pk_bf16_f32 v93, v186, v187
    v_cvt_pk_bf16_f32 v94, v188, v189
    v_cvt_pk_bf16_f32 v95, v190, v191
    v_exp_f32 v128, v128
    v_exp_f32 v129, v129
    v_mfma_f32_32x32x16_bf16 v[112:127], v[76:79], v[92:95], v[112:127]
    ds_read_b128 v[72:75], v10 offset:3840
    buffer_load_dwordx4 a[8:11], v222, s[24:27], s59 offen offset:2048 sc1
    v_exp_f32 v130, v130
    v_exp_f32 v131, v131
    v_exp_f32 v132, v132
    v_exp_f32 v133, v133
    v_exp_f32 v134, v134
    v_exp_f32 v135, v135
    s_waitcnt lgkmcnt(1)
    v_mfma_f32_32x32x16_bf16 v[160:175], v[52:55], v[24:27], 0
    buffer_load_dwordx4 a[12:15], v222, s[24:27], s59 offen offset:2304 sc1
    v_cvt_pk_bf16_f32 v80, v128, v129
    v_cvt_pk_bf16_f32 v81, v130, v131
    v_cvt_pk_bf16_f32 v82, v132, v133
    v_cvt_pk_bf16_f32 v83, v134, v135
    v_exp_f32 v136, v136
    v_exp_f32 v137, v137
    v_mfma_f32_32x32x16_bf16 v[176:191], v[52:55], v[28:31], 0
    ds_read_b128 v[76:79], v10 offset:4480
    s_add_u32 s59, s59, 4096
    buffer_load_dwordx4 a[16:19], v222, s[24:27], s59 offen offset:0 sc1
    v_exp_f32 v138, v138
    v_exp_f32 v139, v139
    v_exp_f32 v140, v140
    v_exp_f32 v141, v141
    v_exp_f32 v142, v142
    v_exp_f32 v143, v143
    v_mfma_f32_32x32x16_bf16 v[96:111], v[64:67], v[80:83], v[96:111]
    v_cvt_pk_bf16_f32 v84, v136, v137
    v_cvt_pk_bf16_f32 v85, v138, v139
    v_cvt_pk_bf16_f32 v86, v140, v141
    v_cvt_pk_bf16_f32 v87, v142, v143
    v_exp_f32 v144, v144
    v_exp_f32 v145, v145
    v_mfma_f32_32x32x4_2b_bf16 v[160:191], v[60:61], v[32:33], v[160:191]
    ds_read_b128 v[48:51], v8 offset:4096
    buffer_load_dwordx4 a[20:23], v222, s[24:27], s59 offen offset:256 sc1
    v_exp_f32 v146, v146
    v_exp_f32 v147, v147
    v_exp_f32 v148, v148
    v_exp_f32 v149, v149
    v_exp_f32 v150, v150
    v_exp_f32 v151, v151
    v_cvt_pk_bf16_f32 v88, v144, v145
    v_cvt_pk_bf16_f32 v89, v146, v147
    v_cvt_pk_bf16_f32 v90, v148, v149
    v_mfma_f32_32x32x16_bf16 v[96:111], v[68:71], v[84:87], v[96:111]
    ds_read_b32 v56, v9 offset:512
    buffer_load_dwordx4 a[24:27], v222, s[24:27], s59 offen offset:2048 sc1
    v_cvt_pk_bf16_f32 v91, v150, v151
    v_exp_f32 v152, v152
    v_exp_f32 v153, v153
    v_exp_f32 v154, v154
    v_exp_f32 v155, v155
    v_exp_f32 v156, v156
    v_exp_f32 v157, v157
    v_mfma_f32_32x32x16_bf16 v[112:127], v[64:67], v[88:91], v[112:127]
    v_exp_f32 v158, v158
    v_exp_f32 v159, v159
    v_cvt_pk_bf16_f32 v92, v152, v153
    v_cvt_pk_bf16_f32 v93, v154, v155
    v_cvt_pk_bf16_f32 v94, v156, v157
    v_cvt_pk_bf16_f32 v95, v158, v159
    v_exp_f32 v160, v160
    v_exp_f32 v161, v161
    v_mfma_f32_32x32x16_bf16 v[112:127], v[68:71], v[92:95], v[112:127]
    ds_read_b128 v[64:67], v10 offset:5120
    buffer_load_dwordx4 a[28:31], v222, s[24:27], s59 offen offset:2304 sc1
    s_add_u32 s59, s59, 4096
    v_exp_f32 v162, v162
    v_exp_f32 v163, v163
    v_exp_f32 v164, v164
    v_exp_f32 v165, v165
    v_exp_f32 v166, v166
    v_exp_f32 v167, v167
    s_waitcnt lgkmcnt(1)
    v_mfma_f32_32x32x16_bf16 v[128:143], v[48:51], v[24:27], 0
    buffer_load_dwordx4 a[32:35], v222, s[24:27], s59 offen offset:0 sc1
    v_cvt_pk_bf16_f32 v80, v160, v161
    v_cvt_pk_bf16_f32 v81, v162, v163
    v_cvt_pk_bf16_f32 v82, v164, v165
    v_cvt_pk_bf16_f32 v83, v166, v167
    v_exp_f32 v168, v168
    v_exp_f32 v169, v169
    v_mfma_f32_32x32x16_bf16 v[144:159], v[48:51], v[28:31], 0
    ds_read_b128 v[68:71], v10 offset:5760
    buffer_load_dwordx4 a[36:39], v222, s[24:27], s59 offen offset:256 sc1
    v_exp_f32 v170, v170
    v_exp_f32 v171, v171
    v_exp_f32 v172, v172
    v_exp_f32 v173, v173
    v_exp_f32 v174, v174
    v_exp_f32 v175, v175
    v_mfma_f32_32x32x16_bf16 v[96:111], v[72:75], v[80:83], v[96:111]
    v_cvt_pk_bf16_f32 v84, v168, v169
    v_cvt_pk_bf16_f32 v85, v170, v171
    v_cvt_pk_bf16_f32 v86, v172, v173
    v_cvt_pk_bf16_f32 v87, v174, v175
    v_exp_f32 v176, v176
    v_exp_f32 v177, v177
    v_mfma_f32_32x32x4_2b_bf16 v[128:159], v[56:57], v[32:33], v[128:159]
    ds_read_b128 v[52:55], v8 offset:5120
    buffer_load_dwordx4 a[40:43], v222, s[24:27], s59 offen offset:2048 sc1
    v_exp_f32 v178, v178
    v_exp_f32 v179, v179
    v_exp_f32 v180, v180
    v_exp_f32 v181, v181
    v_exp_f32 v182, v182
    v_exp_f32 v183, v183
    v_cvt_pk_bf16_f32 v88, v176, v177
    v_cvt_pk_bf16_f32 v89, v178, v179
    v_cvt_pk_bf16_f32 v90, v180, v181
    v_mfma_f32_32x32x16_bf16 v[96:111], v[76:79], v[84:87], v[96:111]
    ds_read_b32 v60, v9 offset:640
    buffer_load_dwordx4 a[44:47], v222, s[24:27], s59 offen offset:2304 sc1
    v_cvt_pk_bf16_f32 v91, v182, v183
    v_exp_f32 v184, v184
    v_exp_f32 v185, v185
    v_exp_f32 v186, v186
    v_exp_f32 v187, v187
    v_exp_f32 v188, v188
    v_exp_f32 v189, v189
    v_mfma_f32_32x32x16_bf16 v[112:127], v[72:75], v[88:91], v[112:127]
    v_exp_f32 v190, v190
    v_exp_f32 v191, v191
    v_cvt_pk_bf16_f32 v92, v184, v185
    v_cvt_pk_bf16_f32 v93, v186, v187
    v_cvt_pk_bf16_f32 v94, v188, v189
    v_cvt_pk_bf16_f32 v95, v190, v191
    v_exp_f32 v128, v128
    v_exp_f32 v129, v129
    v_mfma_f32_32x32x16_bf16 v[112:127], v[76:79], v[92:95], v[112:127]
    ds_read_b128 v[72:75], v10 offset:6400
    s_add_u32 s59, s59, 4096
    buffer_load_dwordx4 a[48:51], v222, s[24:27], s59 offen offset:0 sc1
    v_exp_f32 v130, v130
    v_exp_f32 v131, v131
    v_exp_f32 v132, v132
    v_exp_f32 v133, v133
    v_exp_f32 v134, v134
    v_exp_f32 v135, v135
    s_waitcnt lgkmcnt(1)
    v_mfma_f32_32x32x16_bf16 v[160:175], v[52:55], v[24:27], 0
    buffer_load_dwordx4 a[52:55], v222, s[24:27], s59 offen offset:256 sc1
    v_cvt_pk_bf16_f32 v80, v128, v129
    v_cvt_pk_bf16_f32 v81, v130, v131
    v_cvt_pk_bf16_f32 v82, v132, v133
    v_cvt_pk_bf16_f32 v83, v134, v135
    v_exp_f32 v136, v136
    v_exp_f32 v137, v137
    v_mfma_f32_32x32x16_bf16 v[176:191], v[52:55], v[28:31], 0
    ds_read_b128 v[76:79], v10 offset:7040
    buffer_load_dwordx4 a[56:59], v222, s[24:27], s59 offen offset:2048 sc1
    v_exp_f32 v138, v138
    v_exp_f32 v139, v139
    v_exp_f32 v140, v140
    v_exp_f32 v141, v141
    v_exp_f32 v142, v142
    v_exp_f32 v143, v143
    v_mfma_f32_32x32x16_bf16 v[96:111], v[64:67], v[80:83], v[96:111]
    v_cvt_pk_bf16_f32 v84, v136, v137
    v_cvt_pk_bf16_f32 v85, v138, v139
    v_cvt_pk_bf16_f32 v86, v140, v141
    v_cvt_pk_bf16_f32 v87, v142, v143
    v_exp_f32 v144, v144
    v_exp_f32 v145, v145
    v_mfma_f32_32x32x4_2b_bf16 v[160:191], v[60:61], v[32:33], v[160:191]
    ds_read_b128 v[48:51], v8 offset:6144
    buffer_load_dwordx4 a[60:63], v222, s[24:27], s59 offen offset:2304 sc1
    s_add_u32 s59, s59, 4096
    v_exp_f32 v146, v146
    v_exp_f32 v147, v147
    v_exp_f32 v148, v148
    v_exp_f32 v149, v149
    v_exp_f32 v150, v150
    v_exp_f32 v151, v151
    v_cvt_pk_bf16_f32 v88, v144, v145
    v_cvt_pk_bf16_f32 v89, v146, v147
    v_cvt_pk_bf16_f32 v90, v148, v149
    v_mfma_f32_32x32x16_bf16 v[96:111], v[68:71], v[84:87], v[96:111]
    ds_read_b32 v56, v9 offset:768
    buffer_load_dwordx4 a[64:67], v222, s[24:27], s59 offen offset:0 sc1
    v_cvt_pk_bf16_f32 v91, v150, v151
    v_exp_f32 v152, v152
    v_exp_f32 v153, v153
    v_exp_f32 v154, v154
    v_exp_f32 v155, v155
    v_exp_f32 v156, v156
    v_exp_f32 v157, v157
    v_mfma_f32_32x32x16_bf16 v[112:127], v[64:67], v[88:91], v[112:127]
    v_exp_f32 v158, v158
    v_exp_f32 v159, v159
    v_cvt_pk_bf16_f32 v92, v152, v153
    v_cvt_pk_bf16_f32 v93, v154, v155
    v_cvt_pk_bf16_f32 v94, v156, v157
    v_cvt_pk_bf16_f32 v95, v158, v159
    v_exp_f32 v160, v160
    v_exp_f32 v161, v161
    v_mfma_f32_32x32x16_bf16 v[112:127], v[68:71], v[92:95], v[112:127]
    ds_read_b128 v[64:67], v10 offset:7680
    buffer_load_dwordx4 a[68:71], v222, s[24:27], s59 offen offset:256 sc1
    v_exp_f32 v162, v162
    v_exp_f32 v163, v163
    v_exp_f32 v164, v164
    v_exp_f32 v165, v165
    v_exp_f32 v166, v166
    v_exp_f32 v167, v167
    s_waitcnt lgkmcnt(1)
    v_mfma_f32_32x32x16_bf16 v[128:143], v[48:51], v[24:27], 0
    buffer_load_dwordx4 a[72:75], v222, s[24:27], s59 offen offset:2048 sc1
    v_cvt_pk_bf16_f32 v80, v160, v161
    v_cvt_pk_bf16_f32 v81, v162, v163
    v_cvt_pk_bf16_f32 v82, v164, v165
    v_cvt_pk_bf16_f32 v83, v166, v167
    v_exp_f32 v168, v168
    v_exp_f32 v169, v169
    v_mfma_f32_32x32x16_bf16 v[144:159], v[48:51], v[28:31], 0
    ds_read_b128 v[68:71], v10 offset:8320
    buffer_load_dwordx4 a[76:79], v222, s[24:27], s59 offen offset:2304 sc1
    v_exp_f32 v170, v170
    v_exp_f32 v171, v171
    v_exp_f32 v172, v172
    v_exp_f32 v173, v173
    v_exp_f32 v174, v174
    v_exp_f32 v175, v175
    v_mfma_f32_32x32x16_bf16 v[96:111], v[72:75], v[80:83], v[96:111]
    v_cvt_pk_bf16_f32 v84, v168, v169
    v_cvt_pk_bf16_f32 v85, v170, v171
    v_cvt_pk_bf16_f32 v86, v172, v173
    v_cvt_pk_bf16_f32 v87, v174, v175
    v_exp_f32 v176, v176
    v_exp_f32 v177, v177
    v_mfma_f32_32x32x4_2b_bf16 v[128:159], v[56:57], v[32:33], v[128:159]
    ds_read_b128 v[52:55], v8 offset:7168
    s_add_u32 s59, s59, 4096
    buffer_load_dwordx4 a[80:83], v222, s[24:27], s59 offen offset:0 sc1
    v_exp_f32 v178, v178
    v_exp_f32 v179, v179
    v_exp_f32 v180, v180
    v_exp_f32 v181, v181
    v_exp_f32 v182, v182
    v_exp_f32 v183, v183
    v_cvt_pk_bf16_f32 v88, v176, v177
    v_cvt_pk_bf16_f32 v89, v178, v179
    v_cvt_pk_bf16_f32 v90, v180, v181
    v_mfma_f32_32x32x16_bf16 v[96:111], v[76:79], v[84:87], v[96:111]
    ds_read_b32 v60, v9 offset:896
    buffer_load_dwordx4 a[84:87], v222, s[24:27], s59 offen offset:256 sc1
    v_cvt_pk_bf16_f32 v91, v182, v183
    v_exp_f32 v184, v184
    v_exp_f32 v185, v185
    v_exp_f32 v186, v186
    v_exp_f32 v187, v187
    v_exp_f32 v188, v188
    v_exp_f32 v189, v189
    v_mfma_f32_32x32x16_bf16 v[112:127], v[72:75], v[88:91], v[112:127]
    v_exp_f32 v190, v190
    v_exp_f32 v191, v191
    v_cvt_pk_bf16_f32 v92, v184, v185
    v_cvt_pk_bf16_f32 v93, v186, v187
    v_cvt_pk_bf16_f32 v94, v188, v189
    v_cvt_pk_bf16_f32 v95, v190, v191
    v_exp_f32 v128, v128
    v_exp_f32 v129, v129
    v_mfma_f32_32x32x16_bf16 v[112:127], v[76:79], v[92:95], v[112:127]
    ds_read_b128 v[72:75], v10 offset:8960
    buffer_load_dwordx4 a[88:91], v222, s[24:27], s59 offen offset:2048 sc1
    v_exp_f32 v130, v130
    v_exp_f32 v131, v131
    v_exp_f32 v132, v132
    v_exp_f32 v133, v133
    v_exp_f32 v134, v134
    v_exp_f32 v135, v135
    s_waitcnt lgkmcnt(1)
    v_mfma_f32_32x32x16_bf16 v[160:175], v[52:55], v[24:27], 0
    buffer_load_dwordx4 a[92:95], v222, s[24:27], s59 offen offset:2304 sc1
    s_add_u32 s59, s59, 4096
    v_cvt_pk_bf16_f32 v80, v128, v129
    v_cvt_pk_bf16_f32 v81, v130, v131
    v_cvt_pk_bf16_f32 v82, v132, v133
    v_cvt_pk_bf16_f32 v83, v134, v135
    v_exp_f32 v136, v136
    v_exp_f32 v137, v137
    v_mfma_f32_32x32x16_bf16 v[176:191], v[52:55], v[28:31], 0
    ds_read_b128 v[76:79], v10 offset:9600
    buffer_load_dwordx4 a[96:99], v222, s[24:27], s59 offen offset:0 sc1
    v_exp_f32 v138, v138
    v_exp_f32 v139, v139
    v_exp_f32 v140, v140
    v_exp_f32 v141, v141
    v_exp_f32 v142, v142
    v_exp_f32 v143, v143
    v_mfma_f32_32x32x16_bf16 v[96:111], v[64:67], v[80:83], v[96:111]
    v_cvt_pk_bf16_f32 v84, v136, v137
    v_cvt_pk_bf16_f32 v85, v138, v139
    v_cvt_pk_bf16_f32 v86, v140, v141
    v_cvt_pk_bf16_f32 v87, v142, v143
    v_exp_f32 v144, v144
    v_exp_f32 v145, v145
    v_mfma_f32_32x32x4_2b_bf16 v[160:191], v[60:61], v[32:33], v[160:191]
    ds_read_b128 v[48:51], v8 offset:8192
    buffer_load_dwordx4 a[100:103], v222, s[24:27], s59 offen offset:256 sc1
    v_exp_f32 v146, v146
    v_exp_f32 v147, v147
    v_exp_f32 v148, v148
    v_exp_f32 v149, v149
    v_exp_f32 v150, v150
    v_exp_f32 v151, v151
    v_cvt_pk_bf16_f32 v88, v144, v145
    v_cvt_pk_bf16_f32 v89, v146, v147
    v_cvt_pk_bf16_f32 v90, v148, v149
    v_mfma_f32_32x32x16_bf16 v[96:111], v[68:71], v[84:87], v[96:111]
    ds_read_b32 v56, v9 offset:1024
    buffer_load_dwordx4 a[104:107], v222, s[24:27], s59 offen offset:2048 sc1
    v_cvt_pk_bf16_f32 v91, v150, v151
    v_exp_f32 v152, v152
    v_exp_f32 v153, v153
    v_exp_f32 v154, v154
    v_exp_f32 v155, v155
    v_exp_f32 v156, v156
    v_exp_f32 v157, v157
    v_mfma_f32_32x32x16_bf16 v[112:127], v[64:67], v[88:91], v[112:127]
    v_exp_f32 v158, v158
    v_exp_f32 v159, v159
    v_cvt_pk_bf16_f32 v92, v152, v153
    v_cvt_pk_bf16_f32 v93, v154, v155
    v_cvt_pk_bf16_f32 v94, v156, v157
    v_cvt_pk_bf16_f32 v95, v158, v159
    v_exp_f32 v160, v160
    v_exp_f32 v161, v161
    v_mfma_f32_32x32x16_bf16 v[112:127], v[68:71], v[92:95], v[112:127]
    ds_read_b128 v[64:67], v10 offset:10240
    buffer_load_dwordx4 a[108:111], v222, s[24:27], s59 offen offset:2304 sc1
    v_exp_f32 v162, v162
    v_exp_f32 v163, v163
    v_exp_f32 v164, v164
    v_exp_f32 v165, v165
    v_exp_f32 v166, v166
    v_exp_f32 v167, v167
    s_waitcnt lgkmcnt(1)
    v_mfma_f32_32x32x16_bf16 v[128:143], v[48:51], v[24:27], 0
    s_add_u32 s59, s59, 4096
    buffer_load_dwordx4 a[112:115], v222, s[24:27], s59 offen offset:0 sc1
    v_cvt_pk_bf16_f32 v80, v160, v161
    v_cvt_pk_bf16_f32 v81, v162, v163
    v_cvt_pk_bf16_f32 v82, v164, v165
    v_cvt_pk_bf16_f32 v83, v166, v167
    v_exp_f32 v168, v168
    v_exp_f32 v169, v169
    v_mfma_f32_32x32x16_bf16 v[144:159], v[48:51], v[28:31], 0
    ds_read_b128 v[68:71], v10 offset:10880
    buffer_load_dwordx4 a[116:119], v222, s[24:27], s59 offen offset:256 sc1
    v_exp_f32 v170, v170
    v_exp_f32 v171, v171
    v_exp_f32 v172, v172
    v_exp_f32 v173, v173
    v_exp_f32 v174, v174
    v_exp_f32 v175, v175
    v_mfma_f32_32x32x16_bf16 v[96:111], v[72:75], v[80:83], v[96:111]
    v_cvt_pk_bf16_f32 v84, v168, v169
    v_cvt_pk_bf16_f32 v85, v170, v171
    v_cvt_pk_bf16_f32 v86, v172, v173
    v_cvt_pk_bf16_f32 v87, v174, v175
    v_exp_f32 v176, v176
    v_exp_f32 v177, v177
    v_mfma_f32_32x32x4_2b_bf16 v[128:159], v[56:57], v[32:33], v[128:159]
    ds_read_b128 v[52:55], v8 offset:9216
    buffer_load_dwordx4 a[120:123], v222, s[24:27], s59 offen offset:2048 sc1
    v_exp_f32 v178, v178
    v_exp_f32 v179, v179
    v_exp_f32 v180, v180
    v_exp_f32 v181, v181
    v_exp_f32 v182, v182
    v_exp_f32 v183, v183
    v_cvt_pk_bf16_f32 v88, v176, v177
    v_cvt_pk_bf16_f32 v89, v178, v179
    v_cvt_pk_bf16_f32 v90, v180, v181
    v_mfma_f32_32x32x16_bf16 v[96:111], v[76:79], v[84:87], v[96:111]
    ds_read_b32 v60, v9 offset:1152
    buffer_load_dwordx4 a[124:127], v222, s[24:27], s59 offen offset:2304 sc1
    s_add_u32 s59, s59, 4096
    v_cvt_pk_bf16_f32 v91, v182, v183
    v_exp_f32 v184, v184
    v_exp_f32 v185, v185
    v_exp_f32 v186, v186
    v_exp_f32 v187, v187
    v_exp_f32 v188, v188
    v_exp_f32 v189, v189
    v_mfma_f32_32x32x16_bf16 v[112:127], v[72:75], v[88:91], v[112:127]
    v_exp_f32 v190, v190
    v_exp_f32 v191, v191
    v_cvt_pk_bf16_f32 v92, v184, v185
    v_cvt_pk_bf16_f32 v93, v186, v187
    v_cvt_pk_bf16_f32 v94, v188, v189
    v_cvt_pk_bf16_f32 v95, v190, v191
    v_add_u32 v8, 8192, v8
    v_add_u32 v9, 1024, v9
    v_add_u32 v10, 10240, v10
    s_barrier
    s_mov_b32 s28, s16
    s_and_b32 s29, s17, 0xffff
    s_mov_b32 s30, 5308416
    s_mov_b32 s31, 0x00020000
    s_mov_b32 s32, s8
    s_and_b32 s33, s9, 0xffff
    s_mov_b32 s34, 663552
    s_mov_b32 s35, 0x00020000
    v_exp_f32 v128, v128
    v_exp_f32 v129, v129
    v_mfma_f32_32x32x16_bf16 v[112:127], v[76:79], v[92:95], v[112:127]
    ds_read_b128 v[72:75], v10 offset:1280
    s_mul_i32 s48, s42, 9216
    s_add_u32 s48, s48, s62
    s_add_u32 m0, s48, 0
    s_nop 0
    buffer_load_dwordx4 v192, s[28:31], s60 offen lds
    v_exp_f32 v130, v130
    v_exp_f32 v131, v131
    v_exp_f32 v132, v132
    v_exp_f32 v133, v133
    v_exp_f32 v134, v134
    v_exp_f32 v135, v135
    s_waitcnt lgkmcnt(1)
    v_mfma_f32_32x32x16_bf16 v[160:175], v[52:55], v[24:27], 0
    buffer_load_dwordx4 a[128:131], v222, s[24:27], s59 offen offset:0 sc1
    v_cvt_pk_bf16_f32 v80, v128, v129
    v_cvt_pk_bf16_f32 v81, v130, v131
    v_cvt_pk_bf16_f32 v82, v132, v133
    v_cvt_pk_bf16_f32 v83, v134, v135
    v_exp_f32 v136, v136
    v_exp_f32 v137, v137
    v_mfma_f32_32x32x16_bf16 v[176:191], v[52:55], v[28:31], 0
    ds_read_b128 v[76:79], v10 offset:1920
    buffer_load_dwordx4 a[132:135], v222, s[24:27], s59 offen offset:256 sc1
    v_exp_f32 v138, v138
    v_exp_f32 v139, v139
    v_exp_f32 v140, v140
    v_exp_f32 v141, v141
    v_exp_f32 v142, v142
    v_exp_f32 v143, v143
    v_mfma_f32_32x32x16_bf16 v[96:111], v[64:67], v[80:83], v[96:111]
    s_add_u32 m0, s48, 1024
    s_nop 0
    buffer_load_dwordx4 v193, s[28:31], s60 offen lds
    v_cvt_pk_bf16_f32 v84, v136, v137
    v_cvt_pk_bf16_f32 v85, v138, v139
    v_cvt_pk_bf16_f32 v86, v140, v141
    v_cvt_pk_bf16_f32 v87, v142, v143
    v_exp_f32 v144, v144
    v_exp_f32 v145, v145
    v_mfma_f32_32x32x4_2b_bf16 v[160:191], v[60:61], v[32:33], v[160:191]
    ds_read_b128 v[48:51], v8 offset:2048
    buffer_load_dwordx4 a[136:139], v222, s[24:27], s59 offen offset:2048 sc1
    v_exp_f32 v146, v146
    v_exp_f32 v147, v147
    v_exp_f32 v148, v148
    v_exp_f32 v149, v149
    v_exp_f32 v150, v150
    v_exp_f32 v151, v151
    v_cvt_pk_bf16_f32 v88, v144, v145
    v_cvt_pk_bf16_f32 v89, v146, v147
    v_cvt_pk_bf16_f32 v90, v148, v149
    v_mfma_f32_32x32x16_bf16 v[96:111], v[68:71], v[84:87], v[96:111]
    ds_read_b32 v56, v9 offset:256
    buffer_load_dwordx4 a[140:143], v222, s[24:27], s59 offen offset:2304 sc1
    v_cvt_pk_bf16_f32 v91, v150, v151
    v_exp_f32 v152, v152
    v_exp_f32 v153, v153
    v_exp_f32 v154, v154
    v_exp_f32 v155, v155
    v_exp_f32 v156, v156
    v_exp_f32 v157, v157
    v_mfma_f32_32x32x16_bf16 v[112:127], v[64:67], v[88:91], v[112:127]
    s_add_u32 m0, s48, 2048
    s_nop 0
    buffer_load_dwordx4 v194, s[28:31], s60 offen lds
    v_exp_f32 v158, v158
    v_exp_f32 v159, v159
    v_cvt_pk_bf16_f32 v92, v152, v153
    v_cvt_pk_bf16_f32 v93, v154, v155
    v_cvt_pk_bf16_f32 v94, v156, v157
    v_cvt_pk_bf16_f32 v95, v158, v159
    v_exp_f32 v160, v160
    v_exp_f32 v161, v161
    v_mfma_f32_32x32x16_bf16 v[112:127], v[68:71], v[92:95], v[112:127]
    ds_read_b128 v[64:67], v10 offset:2560
    s_add_u32 s59, s59, 4096
    buffer_load_dwordx4 a[144:147], v222, s[24:27], s59 offen offset:0 sc1
    v_exp_f32 v162, v162
    v_exp_f32 v163, v163
    v_exp_f32 v164, v164
    v_exp_f32 v165, v165
    v_exp_f32 v166, v166
    v_exp_f32 v167, v167
    s_waitcnt lgkmcnt(1)
    v_mfma_f32_32x32x16_bf16 v[128:143], v[48:51], v[24:27], 0
    buffer_load_dwordx4 a[148:151], v222, s[24:27], s59 offen offset:256 sc1
    v_cvt_pk_bf16_f32 v80, v160, v161
    v_cvt_pk_bf16_f32 v81, v162, v163
    v_cvt_pk_bf16_f32 v82, v164, v165
    v_cvt_pk_bf16_f32 v83, v166, v167
    v_exp_f32 v168, v168
    v_exp_f32 v169, v169
    v_mfma_f32_32x32x16_bf16 v[144:159], v[48:51], v[28:31], 0
    ds_read_b128 v[68:71], v10 offset:3200
    s_add_u32 m0, s48, 3072
    s_nop 0
    buffer_load_dwordx4 v195, s[28:31], s60 offen lds
    v_exp_f32 v170, v170
    v_exp_f32 v171, v171
    v_exp_f32 v172, v172
    v_exp_f32 v173, v173
    v_exp_f32 v174, v174
    v_exp_f32 v175, v175
    v_mfma_f32_32x32x16_bf16 v[96:111], v[72:75], v[80:83], v[96:111]
    buffer_load_dwordx4 a[152:155], v222, s[24:27], s59 offen offset:2048 sc1
    v_cvt_pk_bf16_f32 v84, v168, v169
    v_cvt_pk_bf16_f32 v85, v170, v171
    v_cvt_pk_bf16_f32 v86, v172, v173
    v_cvt_pk_bf16_f32 v87, v174, v175
    v_exp_f32 v176, v176
    v_exp_f32 v177, v177
    v_mfma_f32_32x32x4_2b_bf16 v[128:159], v[56:57], v[32:33], v[128:159]
    ds_read_b128 v[52:55], v8 offset:3072
    buffer_load_dwordx4 a[156:159], v222, s[24:27], s59 offen offset:2304 sc1
    s_add_u32 s59, s59, 4096
    v_exp_f32 v178, v178
    v_exp_f32 v179, v179
    v_exp_f32 v180, v180
    v_exp_f32 v181, v181
    v_exp_f32 v182, v182
    v_exp_f32 v183, v183
    v_cvt_pk_bf16_f32 v88, v176, v177
    v_cvt_pk_bf16_f32 v89, v178, v179
    v_cvt_pk_bf16_f32 v90, v180, v181
    v_mfma_f32_32x32x16_bf16 v[96:111], v[76:79], v[84:87], v[96:111]
    ds_read_b32 v60, v9 offset:384
    s_add_u32 m0, s48, 4096
    s_nop 0
    buffer_load_dwordx4 v196, s[28:31], s60 offen lds
    v_cvt_pk_bf16_f32 v91, v182, v183
    v_exp_f32 v184, v184
    v_exp_f32 v185, v185
    v_exp_f32 v186, v186
    v_exp_f32 v187, v187
    v_exp_f32 v188, v188
    v_exp_f32 v189, v189
    v_mfma_f32_32x32x16_bf16 v[112:127], v[72:75], v[88:91], v[112:127]
    v_exp_f32 v190, v190
    v_exp_f32 v191, v191
    v_cvt_pk_bf16_f32 v92, v184, v185
    v_cvt_pk_bf16_f32 v93, v186, v187
    v_cvt_pk_bf16_f32 v94, v188, v189
    v_cvt_pk_bf16_f32 v95, v190, v191
    v_exp_f32 v128, v128
    v_exp_f32 v129, v129
    v_mfma_f32_32x32x16_bf16 v[112:127], v[76:79], v[92:95], v[112:127]
    ds_read_b128 v[72:75], v10 offset:3840
    buffer_load_dwordx4 a[160:163], v222, s[24:27], s59 offen offset:0 sc1
    v_exp_f32 v130, v130
    v_exp_f32 v131, v131
    v_exp_f32 v132, v132
    v_exp_f32 v133, v133
    v_exp_f32 v134, v134
    v_exp_f32 v135, v135
    s_waitcnt lgkmcnt(1)
    v_mfma_f32_32x32x16_bf16 v[160:175], v[52:55], v[24:27], 0
    buffer_load_dwordx4 a[164:167], v222, s[24:27], s59 offen offset:256 sc1
    v_cvt_pk_bf16_f32 v80, v128, v129
    v_cvt_pk_bf16_f32 v81, v130, v131
    v_cvt_pk_bf16_f32 v82, v132, v133
    v_cvt_pk_bf16_f32 v83, v134, v135
    v_exp_f32 v136, v136
    v_exp_f32 v137, v137
    v_mfma_f32_32x32x16_bf16 v[176:191], v[52:55], v[28:31], 0
    ds_read_b128 v[76:79], v10 offset:4480
    s_add_u32 m0, s48, 5120
    s_nop 0
    buffer_load_dwordx4 v197, s[28:31], s60 offen lds
    v_exp_f32 v138, v138
    v_exp_f32 v139, v139
    v_exp_f32 v140, v140
    v_exp_f32 v141, v141
    v_exp_f32 v142, v142
    v_exp_f32 v143, v143
    v_mfma_f32_32x32x16_bf16 v[96:111], v[64:67], v[80:83], v[96:111]
    buffer_load_dwordx4 a[168:171], v222, s[24:27], s59 offen offset:2048 sc1
    v_cvt_pk_bf16_f32 v84, v136, v137
    v_cvt_pk_bf16_f32 v85, v138, v139
    v_cvt_pk_bf16_f32 v86, v140, v141
    v_cvt_pk_bf16_f32 v87, v142, v143
    v_exp_f32 v144, v144
    v_exp_f32 v145, v145
    v_mfma_f32_32x32x4_2b_bf16 v[160:191], v[60:61], v[32:33], v[160:191]
    ds_read_b128 v[48:51], v8 offset:4096
    buffer_load_dwordx4 a[172:175], v222, s[24:27], s59 offen offset:2304 sc1
    v_exp_f32 v146, v146
    v_exp_f32 v147, v147
    v_exp_f32 v148, v148
    v_exp_f32 v149, v149
    v_exp_f32 v150, v150
    v_exp_f32 v151, v151
    v_cvt_pk_bf16_f32 v88, v144, v145
    v_cvt_pk_bf16_f32 v89, v146, v147
    v_cvt_pk_bf16_f32 v90, v148, v149
    v_mfma_f32_32x32x16_bf16 v[96:111], v[68:71], v[84:87], v[96:111]
    ds_read_b32 v56, v9 offset:512
    s_add_u32 m0, s48, 6144
    s_nop 0
    buffer_load_dwordx4 v198, s[28:31], s60 offen lds
    v_cvt_pk_bf16_f32 v91, v150, v151
    v_exp_f32 v152, v152
    v_exp_f32 v153, v153
    v_exp_f32 v154, v154
    v_exp_f32 v155, v155
    v_exp_f32 v156, v156
    v_exp_f32 v157, v157
    v_mfma_f32_32x32x16_bf16 v[112:127], v[64:67], v[88:91], v[112:127]
    s_add_u32 s59, s59, 4096
    buffer_load_dwordx4 a[176:179], v222, s[24:27], s59 offen offset:0 sc1
    v_exp_f32 v158, v158
    v_exp_f32 v159, v159
    v_cvt_pk_bf16_f32 v92, v152, v153
    v_cvt_pk_bf16_f32 v93, v154, v155
    v_cvt_pk_bf16_f32 v94, v156, v157
    v_cvt_pk_bf16_f32 v95, v158, v159
    v_exp_f32 v160, v160
    v_exp_f32 v161, v161
    v_mfma_f32_32x32x16_bf16 v[112:127], v[68:71], v[92:95], v[112:127]
    ds_read_b128 v[64:67], v10 offset:5120
    buffer_load_dwordx4 a[180:183], v222, s[24:27], s59 offen offset:256 sc1
    v_exp_f32 v162, v162
    v_exp_f32 v163, v163
    v_exp_f32 v164, v164
    v_exp_f32 v165, v165
    v_exp_f32 v166, v166
    v_exp_f32 v167, v167
    s_waitcnt lgkmcnt(1)
    v_mfma_f32_32x32x16_bf16 v[128:143], v[48:51], v[24:27], 0
    s_add_u32 m0, s48, 7168
    s_nop 0
    buffer_load_dwordx4 v199, s[28:31], s60 offen lds
    v_cvt_pk_bf16_f32 v80, v160, v161
    v_cvt_pk_bf16_f32 v81, v162, v163
    v_cvt_pk_bf16_f32 v82, v164, v165
    v_cvt_pk_bf16_f32 v83, v166, v167
    v_exp_f32 v168, v168
    v_exp_f32 v169, v169
    v_mfma_f32_32x32x16_bf16 v[144:159], v[48:51], v[28:31], 0
    ds_read_b128 v[68:71], v10 offset:5760
    buffer_load_dwordx4 a[184:187], v222, s[24:27], s59 offen offset:2048 sc1
    v_exp_f32 v170, v170
    v_exp_f32 v171, v171
    v_exp_f32 v172, v172
    v_exp_f32 v173, v173
    v_exp_f32 v174, v174
    v_exp_f32 v175, v175
    v_mfma_f32_32x32x16_bf16 v[96:111], v[72:75], v[80:83], v[96:111]
    buffer_load_dwordx4 a[188:191], v222, s[24:27], s59 offen offset:2304 sc1
    s_add_u32 s59, s59, 4096
    v_cvt_pk_bf16_f32 v84, v168, v169
    v_cvt_pk_bf16_f32 v85, v170, v171
    v_cvt_pk_bf16_f32 v86, v172, v173
    v_cvt_pk_bf16_f32 v87, v174, v175
    v_exp_f32 v176, v176
    v_exp_f32 v177, v177
    v_mfma_f32_32x32x4_2b_bf16 v[128:159], v[56:57], v[32:33], v[128:159]
    ds_read_b128 v[52:55], v8 offset:5120
    s_add_u32 m0, s48, 8192
    s_nop 0
    buffer_load_dwordx4 v200, s[28:31], s60 offen lds
    v_exp_f32 v178, v178
    v_exp_f32 v179, v179
    v_exp_f32 v180, v180
    v_exp_f32 v181, v181
    v_exp_f32 v182, v182
    v_exp_f32 v183, v183
    v_cvt_pk_bf16_f32 v88, v176, v177
    v_cvt_pk_bf16_f32 v89, v178, v179
    v_cvt_pk_bf16_f32 v90, v180, v181
    v_mfma_f32_32x32x16_bf16 v[96:111], v[76:79], v[84:87], v[96:111]
    ds_read_b32 v60, v9 offset:640
    buffer_load_dwordx4 a[192:195], v222, s[24:27], s59 offen offset:0 sc1
    v_cvt_pk_bf16_f32 v91, v182, v183
    v_exp_f32 v184, v184
    v_exp_f32 v185, v185
    v_exp_f32 v186, v186
    v_exp_f32 v187, v187
    v_exp_f32 v188, v188
    v_exp_f32 v189, v189
    v_mfma_f32_32x32x16_bf16 v[112:127], v[72:75], v[88:91], v[112:127]
    v_exp_f32 v190, v190
    v_exp_f32 v191, v191
    v_cvt_pk_bf16_f32 v92, v184, v185
    v_cvt_pk_bf16_f32 v93, v186, v187
    v_cvt_pk_bf16_f32 v94, v188, v189
    v_cvt_pk_bf16_f32 v95, v190, v191
    v_exp_f32 v128, v128
    v_exp_f32 v129, v129
    v_mfma_f32_32x32x16_bf16 v[112:127], v[76:79], v[92:95], v[112:127]
    ds_read_b128 v[72:75], v10 offset:6400
    buffer_load_dwordx4 a[196:199], v222, s[24:27], s59 offen offset:256 sc1
    v_exp_f32 v130, v130
    v_exp_f32 v131, v131
    v_exp_f32 v132, v132
    v_exp_f32 v133, v133
    v_exp_f32 v134, v134
    v_exp_f32 v135, v135
    s_waitcnt lgkmcnt(1)
    v_mfma_f32_32x32x16_bf16 v[160:175], v[52:55], v[24:27], 0
    s_add_u32 s60, s60, 147456
    s_mul_i32 s48, s42, 9216
    s_add_u32 s48, s48, s63
    s_add_u32 m0, s48, 0
    s_nop 0
    buffer_load_dwordx4 v192, s[28:31], s60 offen lds
    v_cvt_pk_bf16_f32 v80, v128, v129
    v_cvt_pk_bf16_f32 v81, v130, v131
    v_cvt_pk_bf16_f32 v82, v132, v133
    v_cvt_pk_bf16_f32 v83, v134, v135
    v_exp_f32 v136, v136
    v_exp_f32 v137, v137
    v_mfma_f32_32x32x16_bf16 v[176:191], v[52:55], v[28:31], 0
    ds_read_b128 v[76:79], v10 offset:7040
    buffer_load_dwordx4 a[200:203], v222, s[24:27], s59 offen offset:2048 sc1
    v_exp_f32 v138, v138
    v_exp_f32 v139, v139
    v_exp_f32 v140, v140
    v_exp_f32 v141, v141
    v_exp_f32 v142, v142
    v_exp_f32 v143, v143
    v_mfma_f32_32x32x16_bf16 v[96:111], v[64:67], v[80:83], v[96:111]
    buffer_load_dwordx4 a[204:207], v222, s[24:27], s59 offen offset:2304 sc1
    v_cvt_pk_bf16_f32 v84, v136, v137
    v_cvt_pk_bf16_f32 v85, v138, v139
    v_cvt_pk_bf16_f32 v86, v140, v141
    v_cvt_pk_bf16_f32 v87, v142, v143
    v_exp_f32 v144, v144
    v_exp_f32 v145, v145
    v_mfma_f32_32x32x4_2b_bf16 v[160:191], v[60:61], v[32:33], v[160:191]
    ds_read_b128 v[48:51], v8 offset:6144
    s_add_u32 m0, s48, 1024
    s_nop 0
    buffer_load_dwordx4 v193, s[28:31], s60 offen lds
    v_exp_f32 v146, v146
    v_exp_f32 v147, v147
    v_exp_f32 v148, v148
    v_exp_f32 v149, v149
    v_exp_f32 v150, v150
    v_exp_f32 v151, v151
    v_cvt_pk_bf16_f32 v88, v144, v145
    v_cvt_pk_bf16_f32 v89, v146, v147
    v_cvt_pk_bf16_f32 v90, v148, v149
    v_mfma_f32_32x32x16_bf16 v[96:111], v[68:71], v[84:87], v[96:111]
    ds_read_b32 v56, v9 offset:768
    s_add_u32 s59, s59, 4096
    buffer_load_dwordx4 a[208:211], v222, s[24:27], s59 offen offset:0 sc1
    v_cvt_pk_bf16_f32 v91, v150, v151
    v_exp_f32 v152, v152
    v_exp_f32 v153, v153
    v_exp_f32 v154, v154
    v_exp_f32 v155, v155
    v_exp_f32 v156, v156
    v_exp_f32 v157, v157
    v_mfma_f32_32x32x16_bf16 v[112:127], v[64:67], v[88:91], v[112:127]
    buffer_load_dwordx4 a[212:215], v222, s[24:27], s59 offen offset:256 sc1
    v_exp_f32 v158, v158
    v_exp_f32 v159, v159
    v_cvt_pk_bf16_f32 v92, v152, v153
    v_cvt_pk_bf16_f32 v93, v154, v155
    v_cvt_pk_bf16_f32 v94, v156, v157
    v_cvt_pk_bf16_f32 v95, v158, v159
    v_exp_f32 v160, v160
    v_exp_f32 v161, v161
    v_mfma_f32_32x32x16_bf16 v[112:127], v[68:71], v[92:95], v[112:127]
    ds_read_b128 v[64:67], v10 offset:7680
    s_add_u32 m0, s48, 2048
    s_nop 0
    buffer_load_dwordx4 v194, s[28:31], s60 offen lds
    v_exp_f32 v162, v162
    v_exp_f32 v163, v163
    v_exp_f32 v164, v164
    v_exp_f32 v165, v165
    v_exp_f32 v166, v166
    v_exp_f32 v167, v167
    s_waitcnt lgkmcnt(1)
    v_mfma_f32_32x32x16_bf16 v[128:143], v[48:51], v[24:27], 0
    buffer_load_dwordx4 a[216:219], v222, s[24:27], s59 offen offset:2048 sc1
    v_cvt_pk_bf16_f32 v80, v160, v161
    v_cvt_pk_bf16_f32 v81, v162, v163
    v_cvt_pk_bf16_f32 v82, v164, v165
    v_cvt_pk_bf16_f32 v83, v166, v167
    v_exp_f32 v168, v168
    v_exp_f32 v169, v169
    v_mfma_f32_32x32x16_bf16 v[144:159], v[48:51], v[28:31], 0
    ds_read_b128 v[68:71], v10 offset:8320
    buffer_load_dwordx4 a[220:223], v222, s[24:27], s59 offen offset:2304 sc1
    s_add_u32 s59, s59, 4096
    v_exp_f32 v170, v170
    v_exp_f32 v171, v171
    v_exp_f32 v172, v172
    v_exp_f32 v173, v173
    v_exp_f32 v174, v174
    v_exp_f32 v175, v175
    v_mfma_f32_32x32x16_bf16 v[96:111], v[72:75], v[80:83], v[96:111]
    s_add_u32 m0, s48, 3072
    s_nop 0
    buffer_load_dwordx4 v195, s[28:31], s60 offen lds
    v_cvt_pk_bf16_f32 v84, v168, v169
    v_cvt_pk_bf16_f32 v85, v170, v171
    v_cvt_pk_bf16_f32 v86, v172, v173
    v_cvt_pk_bf16_f32 v87, v174, v175
    v_exp_f32 v176, v176
    v_exp_f32 v177, v177
    v_mfma_f32_32x32x4_2b_bf16 v[128:159], v[56:57], v[32:33], v[128:159]
    ds_read_b128 v[52:55], v8 offset:7168
    buffer_load_dwordx4 a[224:227], v222, s[24:27], s59 offen offset:0 sc1
    v_exp_f32 v178, v178
    v_exp_f32 v179, v179
    v_exp_f32 v180, v180
    v_exp_f32 v181, v181
    v_exp_f32 v182, v182
    v_exp_f32 v183, v183
    v_cvt_pk_bf16_f32 v88, v176, v177
    v_cvt_pk_bf16_f32 v89, v178, v179
    v_cvt_pk_bf16_f32 v90, v180, v181
    v_mfma_f32_32x32x16_bf16 v[96:111], v[76:79], v[84:87], v[96:111]
    ds_read_b32 v60, v9 offset:896
    buffer_load_dwordx4 a[228:231], v222, s[24:27], s59 offen offset:256 sc1
    v_cvt_pk_bf16_f32 v91, v182, v183
    v_exp_f32 v184, v184
    v_exp_f32 v185, v185
    v_exp_f32 v186, v186
    v_exp_f32 v187, v187
    v_exp_f32 v188, v188
    v_exp_f32 v189, v189
    v_mfma_f32_32x32x16_bf16 v[112:127], v[72:75], v[88:91], v[112:127]
    v_exp_f32 v190, v190
    v_exp_f32 v191, v191
    v_cvt_pk_bf16_f32 v92, v184, v185
    v_cvt_pk_bf16_f32 v93, v186, v187
    v_cvt_pk_bf16_f32 v94, v188, v189
    v_cvt_pk_bf16_f32 v95, v190, v191
    v_exp_f32 v128, v128
    v_exp_f32 v129, v129
    v_mfma_f32_32x32x16_bf16 v[112:127], v[76:79], v[92:95], v[112:127]
    ds_read_b128 v[72:75], v10 offset:8960
    s_add_u32 m0, s48, 4096
    s_nop 0
    buffer_load_dwordx4 v196, s[28:31], s60 offen lds
    v_exp_f32 v130, v130
    v_exp_f32 v131, v131
    v_exp_f32 v132, v132
    v_exp_f32 v133, v133
    v_exp_f32 v134, v134
    v_exp_f32 v135, v135
    s_waitcnt lgkmcnt(1)
    v_mfma_f32_32x32x16_bf16 v[160:175], v[52:55], v[24:27], 0
    buffer_load_dwordx4 a[232:235], v222, s[24:27], s59 offen offset:2048 sc1
    v_cvt_pk_bf16_f32 v80, v128, v129
    v_cvt_pk_bf16_f32 v81, v130, v131
    v_cvt_pk_bf16_f32 v82, v132, v133
    v_cvt_pk_bf16_f32 v83, v134, v135
    v_exp_f32 v136, v136
    v_exp_f32 v137, v137
    v_mfma_f32_32x32x16_bf16 v[176:191], v[52:55], v[28:31], 0
    ds_read_b128 v[76:79], v10 offset:9600
    buffer_load_dwordx4 a[236:239], v222, s[24:27], s59 offen offset:2304 sc1
    v_exp_f32 v138, v138
    v_exp_f32 v139, v139
    v_exp_f32 v140, v140
    v_exp_f32 v141, v141
    v_exp_f32 v142, v142
    v_exp_f32 v143, v143
    v_mfma_f32_32x32x16_bf16 v[96:111], v[64:67], v[80:83], v[96:111]
    s_add_u32 m0, s48, 5120
    s_nop 0
    buffer_load_dwordx4 v197, s[28:31], s60 offen lds
    v_cvt_pk_bf16_f32 v84, v136, v137
    v_cvt_pk_bf16_f32 v85, v138, v139
    v_cvt_pk_bf16_f32 v86, v140, v141
    v_cvt_pk_bf16_f32 v87, v142, v143
    v_exp_f32 v144, v144
    v_exp_f32 v145, v145
    v_mfma_f32_32x32x4_2b_bf16 v[160:191], v[60:61], v[32:33], v[160:191]
    ds_read_b128 v[48:51], v8 offset:8192
    s_add_u32 s59, s59, 4096
    buffer_load_dwordx4 a[240:243], v222, s[24:27], s59 offen offset:0 sc1
    v_exp_f32 v146, v146
    v_exp_f32 v147, v147
    v_exp_f32 v148, v148
    v_exp_f32 v149, v149
    v_exp_f32 v150, v150
    v_exp_f32 v151, v151
    v_cvt_pk_bf16_f32 v88, v144, v145
    v_cvt_pk_bf16_f32 v89, v146, v147
    v_cvt_pk_bf16_f32 v90, v148, v149
    v_mfma_f32_32x32x16_bf16 v[96:111], v[68:71], v[84:87], v[96:111]
    ds_read_b32 v56, v9 offset:1024
    buffer_load_dwordx4 a[244:247], v222, s[24:27], s59 offen offset:256 sc1
    v_cvt_pk_bf16_f32 v91, v150, v151
    v_exp_f32 v152, v152
    v_exp_f32 v153, v153
    v_exp_f32 v154, v154
    v_exp_f32 v155, v155
    v_exp_f32 v156, v156
    v_exp_f32 v157, v157
    v_mfma_f32_32x32x16_bf16 v[112:127], v[64:67], v[88:91], v[112:127]
    v_exp_f32 v158, v158
    v_exp_f32 v159, v159
    v_cvt_pk_bf16_f32 v92, v152, v153
    v_cvt_pk_bf16_f32 v93, v154, v155
    v_cvt_pk_bf16_f32 v94, v156, v157
    v_cvt_pk_bf16_f32 v95, v158, v159
    v_exp_f32 v160, v160
    v_exp_f32 v161, v161
    v_mfma_f32_32x32x16_bf16 v[112:127], v[68:71], v[92:95], v[112:127]
    ds_read_b128 v[64:67], v10 offset:10240
    s_add_u32 m0, s48, 6144
    s_nop 0
    buffer_load_dwordx4 v198, s[28:31], s60 offen lds
    v_exp_f32 v162, v162
    v_exp_f32 v163, v163
    v_exp_f32 v164, v164
    v_exp_f32 v165, v165
    v_exp_f32 v166, v166
    v_exp_f32 v167, v167
    s_waitcnt lgkmcnt(1)
    v_mfma_f32_32x32x16_bf16 v[128:143], v[48:51], v[24:27], 0
    buffer_load_dwordx4 a[248:251], v222, s[24:27], s59 offen offset:2048 sc1
    v_cvt_pk_bf16_f32 v80, v160, v161
    v_cvt_pk_bf16_f32 v81, v162, v163
    v_cvt_pk_bf16_f32 v82, v164, v165
    v_cvt_pk_bf16_f32 v83, v166, v167
    v_exp_f32 v168, v168
    v_exp_f32 v169, v169
    v_mfma_f32_32x32x16_bf16 v[144:159], v[48:51], v[28:31], 0
    ds_read_b128 v[68:71], v10 offset:10880
    buffer_load_dwordx4 a[252:255], v222, s[24:27], s59 offen offset:2304 sc1
    s_add_u32 s59, s59, 4096
    v_exp_f32 v170, v170
    v_exp_f32 v171, v171
    v_exp_f32 v172, v172
    v_exp_f32 v173, v173
    v_exp_f32 v174, v174
    v_exp_f32 v175, v175
    v_mfma_f32_32x32x16_bf16 v[96:111], v[72:75], v[80:83], v[96:111]
    v_cvt_pk_bf16_f32 v84, v168, v169
    v_cvt_pk_bf16_f32 v85, v170, v171
    v_cvt_pk_bf16_f32 v86, v172, v173
    v_cvt_pk_bf16_f32 v87, v174, v175
    v_exp_f32 v176, v176
    v_exp_f32 v177, v177
    v_mfma_f32_32x32x4_2b_bf16 v[128:159], v[56:57], v[32:33], v[128:159]
    ds_read_b128 v[52:55], v8 offset:9216
    s_add_u32 m0, s48, 7168
    s_nop 0
    buffer_load_dwordx4 v199, s[28:31], s60 offen lds
    v_exp_f32 v178, v178
    v_exp_f32 v179, v179
    v_exp_f32 v180, v180
    v_exp_f32 v181, v181
    v_exp_f32 v182, v182
    v_exp_f32 v183, v183
    v_cvt_pk_bf16_f32 v88, v176, v177
    v_cvt_pk_bf16_f32 v89, v178, v179
    v_cvt_pk_bf16_f32 v90, v180, v181
    v_mfma_f32_32x32x16_bf16 v[96:111], v[76:79], v[84:87], v[96:111]
    ds_read_b32 v60, v9 offset:1152
    s_add_u32 m0, s48, 8192
    s_nop 0
    buffer_load_dwordx4 v200, s[28:31], s60 offen lds
    v_cvt_pk_bf16_f32 v91, v182, v183
    v_exp_f32 v184, v184
    v_exp_f32 v185, v185
    v_exp_f32 v186, v186
    v_exp_f32 v187, v187
    v_exp_f32 v188, v188
    v_exp_f32 v189, v189
    v_mfma_f32_32x32x16_bf16 v[112:127], v[72:75], v[88:91], v[112:127]
    v_exp_f32 v190, v190
    v_exp_f32 v191, v191
    v_cvt_pk_bf16_f32 v92, v184, v185
    v_cvt_pk_bf16_f32 v93, v186, v187
    v_cvt_pk_bf16_f32 v94, v188, v189
    v_cvt_pk_bf16_f32 v95, v190, v191
    v_add_u32 v8, 8192, v8
    v_add_u32 v9, 1024, v9
    v_add_u32 v10, 10240, v10
    s_add_u32 s60, s60, 147456
    v_mfma_f32_32x32x16_bf16 v[112:127], v[76:79], v[92:95], v[112:127]
    s_mov_b32 s46, 0x7b800000
    v_mov_b32 v12, v106
    v_mov_b32 v14, v106
    v_max3_f32 v16, |v96|, |v97|, |v98|
    v_max3_f32 v16, v16, |v99|, |v100|
    v_max3_f32 v16, v16, |v101|, |v102|
    v_max3_f32 v16, v16, |v103|, |v104|
    v_max3_f32 v16, v16, |v105|, |v106|
    v_permlane32_swap_b32 v12, v14
    s_nop 2
    v_mov_b32 v13, v122
    v_mov_b32 v15, v122
    v_max3_f32 v17, |v112|, |v113|, |v114|
    v_max3_f32 v17, v17, |v115|, |v116|
    v_max3_f32 v17, v17, |v117|, |v118|
    v_max3_f32 v17, v17, |v119|, |v120|
    v_max3_f32 v17, v17, |v121|, |v122|
    v_permlane32_swap_b32 v13, v15
    v_cmp_nge_f32 vcc, s46, v16
    s_nop 0
    s_mov_b64 s[48:49], vcc
    v_cmp_nge_f32 vcc, s46, v17
    s_nop 0
    s_or_b64 s[48:49], vcc, s[48:49]
    s_mov_b32 s46, 0xd800000
    v_cmp_nle_f32 vcc, s46, v12
    s_nop 0
    s_or_b64 s[48:49], vcc, s[48:49]
    v_cmp_nle_f32 vcc, s46, v13
    s_nop 0
    s_or_b64 vcc, vcc, s[48:49]
    s_cmp_lg_u64 vcc, 0
    s_cselect_b32 s46, 1, 0
    v_mov_b32 v19, s46
    s_lshl_b32 s47, s42, 2
    s_add_u32 s47, s47, 163600
    v_mov_b32 v20, s47
    ds_write_b32 v20, v19
parallel_sum__softmax_full_mha__swiglu_ffn__prompt_kernel_p2fin:
    v_rcp_f32 v12, v12
    s_nop 0
    v_mul_f32 v96, v96, v12
    v_mul_f32 v97, v97, v12
    v_mul_f32 v98, v98, v12
    v_mul_f32 v99, v99, v12
    v_mul_f32 v100, v100, v12
    v_mul_f32 v101, v101, v12
    v_mul_f32 v102, v102, v12
    v_mul_f32 v103, v103, v12
    v_mul_f32 v104, v104, v12
    v_mul_f32 v105, v105, v12
    v_cvt_pk_bf16_f32 v128, v96, v97
    v_cvt_pk_bf16_f32 v129, v98, v99
    v_cvt_pk_bf16_f32 v130, v100, v101
    v_cvt_pk_bf16_f32 v131, v102, v103
    v_cvt_pk_bf16_f32 v132, v104, v105
    s_add_u32 s47, s50, 0
    s_mul_i32 s47, s47, 36864
    s_add_u32 s47, s47, 28606464
    s_lshl_b32 s48, s41, 10
    s_add_u32 s48, s48, s47
    buffer_store_dwordx4 v[128:131], v2, s[24:27], s48 offen sc1
    s_lshr_b32 s48, s41, 3
    s_add_u32 s48, s48, 32
    s_lshl_b32 s48, s48, 10
    s_add_u32 s47, s47, s48
    s_bfe_u32 s48, s41, 0x10002
    s_lshl_b32 s48, s48, 9
    s_add_u32 s47, s47, s48
    s_and_b32 s48, s41, 3
    s_lshl_b32 s48, s48, 2
    s_add_u32 s47, s47, s48
    v_mov_b32 v18, 0x7ff00000
    v_cmp_gt_u32 vcc, 32, v0
    s_nop 1
    v_cndmask_b32 v18, v18, v2, vcc
    buffer_store_dword v132, v18, s[24:27], s47 offen sc1
    v_rcp_f32 v13, v13
    s_nop 0
    v_mul_f32 v112, v112, v13
    v_mul_f32 v113, v113, v13
    v_mul_f32 v114, v114, v13
    v_mul_f32 v115, v115, v13
    v_mul_f32 v116, v116, v13
    v_mul_f32 v117, v117, v13
    v_mul_f32 v118, v118, v13
    v_mul_f32 v119, v119, v13
    v_mul_f32 v120, v120, v13
    v_mul_f32 v121, v121, v13
    v_cvt_pk_bf16_f32 v136, v112, v113
    v_cvt_pk_bf16_f32 v137, v114, v115
    v_cvt_pk_bf16_f32 v138, v116, v117
    v_cvt_pk_bf16_f32 v139, v118, v119
    v_cvt_pk_bf16_f32 v140, v120, v121
    s_add_u32 s47, s50, 1
    s_mul_i32 s47, s47, 36864
    s_add_u32 s47, s47, 28606464
    s_lshl_b32 s48, s41, 10
    s_add_u32 s48, s48, s47
    buffer_store_dwordx4 v[136:139], v2, s[24:27], s48 offen sc1
    s_lshr_b32 s48, s41, 3
    s_add_u32 s48, s48, 32
    s_lshl_b32 s48, s48, 10
    s_add_u32 s47, s47, s48
    s_bfe_u32 s48, s41, 0x10002
    s_lshl_b32 s48, s48, 9
    s_add_u32 s47, s47, s48
    s_and_b32 s48, s41, 3
    s_lshl_b32 s48, s48, 2
    s_add_u32 s47, s47, s48
    buffer_store_dword v140, v18, s[24:27], s47 offen sc1
    s_waitcnt vmcnt(4) lgkmcnt(0)
    s_barrier
    v_mov_b32 v20, 163600
    ds_read_b128 v[16:19], v20
    s_waitcnt lgkmcnt(0)
    v_or3_b32 v16, v16, v17, v18
    v_or_b32 v16, v16, v19
    s_nop 0
    v_readfirstlane_b32 s46, v16
    s_nop 0
    s_cmp_lg_u32 s46, 0
    s_cbranch_scc1 parallel_sum__softmax_full_mha__swiglu_ffn__prompt_kernel_p2slow
parallel_sum__softmax_full_mha__swiglu_ffn__prompt_kernel_p2ok:
    v_add_u32 v220, s62, v219
    ds_read_b64_tr_b16 v[32:33], v220 offset:0
    ds_read_b64_tr_b16 v[34:35], v220 offset:2304
    ds_read_b64_tr_b16 v[36:37], v220 offset:32
    ds_read_b64_tr_b16 v[38:39], v220 offset:2336
    ds_read_b64_tr_b16 v[40:41], v220 offset:64
    ds_read_b64_tr_b16 v[42:43], v220 offset:2368
    ds_read_b64_tr_b16 v[44:45], v220 offset:96
    ds_read_b64_tr_b16 v[46:47], v220 offset:2400
    ds_read_b64_tr_b16 v[48:49], v220 offset:128
    ds_read_b64_tr_b16 v[50:51], v220 offset:2432
    ds_read_b64_tr_b16 v[52:53], v220 offset:160
    ds_read_b64_tr_b16 v[54:55], v220 offset:2464
    v_add_u32 v221, s63, v219
    s_waitcnt lgkmcnt(6)
    v_mfma_f32_16x16x32_bf16 v[96:99], v[32:35], a[0:3], 0
    ds_read_b64_tr_b16 v[56:57], v220 offset:192
    v_mfma_f32_16x16x32_bf16 v[132:135], v[32:35], a[4:7], 0
    ds_read_b64_tr_b16 v[58:59], v220 offset:2496
    v_mfma_f32_16x16x32_bf16 v[100:103], v[36:39], a[0:3], 0
    s_mul_i32 s48, s42, 9216
    s_add_u32 s48, s48, s64
    s_add_u32 m0, s48, 0
    ds_read_b64_tr_b16 v[60:61], v220 offset:224
    v_mfma_f32_16x16x32_bf16 v[136:139], v[36:39], a[4:7], 0
    ds_read_b64_tr_b16 v[62:63], v220 offset:2528
    buffer_load_dwordx4 v192, s[28:31], s60 offen lds
    v_mfma_f32_16x16x32_bf16 v[104:107], v[40:43], a[0:3], 0
    ds_read_b64_tr_b16 v[64:65], v220 offset:256
    v_mfma_f32_16x16x32_bf16 v[140:143], v[40:43], a[4:7], 0
    ds_read_b64_tr_b16 v[66:67], v220 offset:2560
    s_waitcnt lgkmcnt(6)
    v_mfma_f32_16x16x32_bf16 v[108:111], v[44:47], a[0:3], 0
    ds_read_b64_tr_b16 v[32:33], v220 offset:9216
    v_mfma_f32_16x16x32_bf16 v[144:147], v[44:47], a[4:7], 0
    ds_read_b64_tr_b16 v[34:35], v220 offset:11520
    v_mfma_f32_16x16x32_bf16 v[112:115], v[48:51], a[0:3], 0
    s_add_u32 m0, s48, 1024
    ds_read_b64_tr_b16 v[36:37], v220 offset:9248
    v_mfma_f32_16x16x32_bf16 v[148:151], v[48:51], a[4:7], 0
    ds_read_b64_tr_b16 v[38:39], v220 offset:11552
    buffer_load_dwordx4 v193, s[28:31], s60 offen lds
    v_mfma_f32_16x16x32_bf16 v[116:119], v[52:55], a[0:3], 0
    ds_read_b64_tr_b16 v[40:41], v220 offset:9280
    v_mfma_f32_16x16x32_bf16 v[152:155], v[52:55], a[4:7], 0
    ds_read_b64_tr_b16 v[42:43], v220 offset:11584
    s_waitcnt lgkmcnt(6)
    v_mfma_f32_16x16x32_bf16 v[120:123], v[56:59], a[0:3], 0
    ds_read_b64_tr_b16 v[44:45], v220 offset:9312
    v_mfma_f32_16x16x32_bf16 v[156:159], v[56:59], a[4:7], 0
    ds_read_b64_tr_b16 v[46:47], v220 offset:11616
    v_mfma_f32_16x16x32_bf16 v[124:127], v[60:63], a[0:3], 0
    s_add_u32 m0, s48, 2048
    ds_read_b64_tr_b16 v[48:49], v220 offset:9344
    v_mfma_f32_16x16x32_bf16 v[160:163], v[60:63], a[4:7], 0
    ds_read_b64_tr_b16 v[50:51], v220 offset:11648
    buffer_load_dwordx4 v194, s[28:31], s60 offen lds
    v_mfma_f32_16x16x32_bf16 v[128:131], v[64:67], a[0:3], 0
    ds_read_b64_tr_b16 v[52:53], v220 offset:9376
    v_mfma_f32_16x16x32_bf16 v[164:167], v[64:67], a[4:7], 0
    ds_read_b64_tr_b16 v[54:55], v220 offset:11680
    s_waitcnt lgkmcnt(6)
    v_mfma_f32_16x16x32_bf16 v[96:99], v[32:35], a[8:11], v[96:99]
    ds_read_b64_tr_b16 v[56:57], v220 offset:9408
    v_mfma_f32_16x16x32_bf16 v[132:135], v[32:35], a[12:15], v[132:135]
    ds_read_b64_tr_b16 v[58:59], v220 offset:11712
    v_mfma_f32_16x16x32_bf16 v[100:103], v[36:39], a[8:11], v[100:103]
    s_add_u32 m0, s48, 3072
    ds_read_b64_tr_b16 v[60:61], v220 offset:9440
    v_mfma_f32_16x16x32_bf16 v[136:139], v[36:39], a[12:15], v[136:139]
    ds_read_b64_tr_b16 v[62:63], v220 offset:11744
    buffer_load_dwordx4 v195, s[28:31], s60 offen lds
    v_mfma_f32_16x16x32_bf16 v[104:107], v[40:43], a[8:11], v[104:107]
    ds_read_b64_tr_b16 v[64:65], v220 offset:9472
    v_mfma_f32_16x16x32_bf16 v[140:143], v[40:43], a[12:15], v[140:143]
    ds_read_b64_tr_b16 v[66:67], v220 offset:11776
    s_waitcnt lgkmcnt(6)
    v_mfma_f32_16x16x32_bf16 v[108:111], v[44:47], a[8:11], v[108:111]
    ds_read_b64_tr_b16 v[32:33], v220 offset:18432
    v_mfma_f32_16x16x32_bf16 v[144:147], v[44:47], a[12:15], v[144:147]
    ds_read_b64_tr_b16 v[34:35], v220 offset:20736
    v_mfma_f32_16x16x32_bf16 v[112:115], v[48:51], a[8:11], v[112:115]
    s_add_u32 m0, s48, 4096
    ds_read_b64_tr_b16 v[36:37], v220 offset:18464
    v_mfma_f32_16x16x32_bf16 v[148:151], v[48:51], a[12:15], v[148:151]
    ds_read_b64_tr_b16 v[38:39], v220 offset:20768
    buffer_load_dwordx4 v196, s[28:31], s60 offen lds
    v_mfma_f32_16x16x32_bf16 v[116:119], v[52:55], a[8:11], v[116:119]
    ds_read_b64_tr_b16 v[40:41], v220 offset:18496
    v_mfma_f32_16x16x32_bf16 v[152:155], v[52:55], a[12:15], v[152:155]
    ds_read_b64_tr_b16 v[42:43], v220 offset:20800
    s_waitcnt lgkmcnt(6)
    v_mfma_f32_16x16x32_bf16 v[120:123], v[56:59], a[8:11], v[120:123]
    ds_read_b64_tr_b16 v[44:45], v220 offset:18528
    v_mfma_f32_16x16x32_bf16 v[156:159], v[56:59], a[12:15], v[156:159]
    ds_read_b64_tr_b16 v[46:47], v220 offset:20832
    v_mfma_f32_16x16x32_bf16 v[124:127], v[60:63], a[8:11], v[124:127]
    s_add_u32 m0, s48, 5120
    ds_read_b64_tr_b16 v[48:49], v220 offset:18560
    v_mfma_f32_16x16x32_bf16 v[160:163], v[60:63], a[12:15], v[160:163]
    ds_read_b64_tr_b16 v[50:51], v220 offset:20864
    buffer_load_dwordx4 v197, s[28:31], s60 offen lds
    v_mfma_f32_16x16x32_bf16 v[128:131], v[64:67], a[8:11], v[128:131]
    ds_read_b64_tr_b16 v[52:53], v220 offset:18592
    v_mfma_f32_16x16x32_bf16 v[164:167], v[64:67], a[12:15], v[164:167]
    ds_read_b64_tr_b16 v[54:55], v220 offset:20896
    s_waitcnt lgkmcnt(6)
    v_mfma_f32_16x16x32_bf16 v[96:99], v[32:35], a[16:19], v[96:99]
    ds_read_b64_tr_b16 v[56:57], v220 offset:18624
    v_mfma_f32_16x16x32_bf16 v[132:135], v[32:35], a[20:23], v[132:135]
    ds_read_b64_tr_b16 v[58:59], v220 offset:20928
    v_mfma_f32_16x16x32_bf16 v[100:103], v[36:39], a[16:19], v[100:103]
    s_add_u32 m0, s48, 6144
    ds_read_b64_tr_b16 v[60:61], v220 offset:18656
    v_mfma_f32_16x16x32_bf16 v[136:139], v[36:39], a[20:23], v[136:139]
    ds_read_b64_tr_b16 v[62:63], v220 offset:20960
    buffer_load_dwordx4 v198, s[28:31], s60 offen lds
    v_mfma_f32_16x16x32_bf16 v[104:107], v[40:43], a[16:19], v[104:107]
    ds_read_b64_tr_b16 v[64:65], v220 offset:18688
    v_mfma_f32_16x16x32_bf16 v[140:143], v[40:43], a[20:23], v[140:143]
    ds_read_b64_tr_b16 v[66:67], v220 offset:20992
    s_waitcnt lgkmcnt(6)
    v_mfma_f32_16x16x32_bf16 v[108:111], v[44:47], a[16:19], v[108:111]
    ds_read_b64_tr_b16 v[32:33], v220 offset:27648
    v_mfma_f32_16x16x32_bf16 v[144:147], v[44:47], a[20:23], v[144:147]
    ds_read_b64_tr_b16 v[34:35], v220 offset:29952
    v_mfma_f32_16x16x32_bf16 v[112:115], v[48:51], a[16:19], v[112:115]
    s_add_u32 m0, s48, 7168
    ds_read_b64_tr_b16 v[36:37], v220 offset:27680
    v_mfma_f32_16x16x32_bf16 v[148:151], v[48:51], a[20:23], v[148:151]
    ds_read_b64_tr_b16 v[38:39], v220 offset:29984
    buffer_load_dwordx4 v199, s[28:31], s60 offen lds
    v_mfma_f32_16x16x32_bf16 v[116:119], v[52:55], a[16:19], v[116:119]
    ds_read_b64_tr_b16 v[40:41], v220 offset:27712
    v_mfma_f32_16x16x32_bf16 v[152:155], v[52:55], a[20:23], v[152:155]
    ds_read_b64_tr_b16 v[42:43], v220 offset:30016
    s_waitcnt lgkmcnt(6)
    v_mfma_f32_16x16x32_bf16 v[120:123], v[56:59], a[16:19], v[120:123]
    ds_read_b64_tr_b16 v[44:45], v220 offset:27744
    v_mfma_f32_16x16x32_bf16 v[156:159], v[56:59], a[20:23], v[156:159]
    ds_read_b64_tr_b16 v[46:47], v220 offset:30048
    v_mfma_f32_16x16x32_bf16 v[124:127], v[60:63], a[16:19], v[124:127]
    s_add_u32 m0, s48, 8192
    ds_read_b64_tr_b16 v[48:49], v220 offset:27776
    v_mfma_f32_16x16x32_bf16 v[160:163], v[60:63], a[20:23], v[160:163]
    ds_read_b64_tr_b16 v[50:51], v220 offset:30080
    buffer_load_dwordx4 v200, s[28:31], s60 offen lds
    v_mfma_f32_16x16x32_bf16 v[128:131], v[64:67], a[16:19], v[128:131]
    ds_read_b64_tr_b16 v[52:53], v220 offset:27808
    v_mfma_f32_16x16x32_bf16 v[164:167], v[64:67], a[20:23], v[164:167]
    ds_read_b64_tr_b16 v[54:55], v220 offset:30112
    s_waitcnt lgkmcnt(6)
    v_mfma_f32_16x16x32_bf16 v[96:99], v[32:35], a[24:27], v[96:99]
    ds_read_b64_tr_b16 v[56:57], v220 offset:27840
    v_mfma_f32_16x16x32_bf16 v[132:135], v[32:35], a[28:31], v[132:135]
    ds_read_b64_tr_b16 v[58:59], v220 offset:30144
    v_mfma_f32_16x16x32_bf16 v[100:103], v[36:39], a[24:27], v[100:103]
    ds_read_b64_tr_b16 v[60:61], v220 offset:27872
    v_mfma_f32_16x16x32_bf16 v[136:139], v[36:39], a[28:31], v[136:139]
    ds_read_b64_tr_b16 v[62:63], v220 offset:30176
    v_mfma_f32_16x16x32_bf16 v[104:107], v[40:43], a[24:27], v[104:107]
    ds_read_b64_tr_b16 v[64:65], v220 offset:27904
    v_mfma_f32_16x16x32_bf16 v[140:143], v[40:43], a[28:31], v[140:143]
    ds_read_b64_tr_b16 v[66:67], v220 offset:30208
    s_waitcnt vmcnt(9)
    s_barrier
    s_waitcnt lgkmcnt(6)
    v_mfma_f32_16x16x32_bf16 v[108:111], v[44:47], a[24:27], v[108:111]
    ds_read_b64_tr_b16 v[32:33], v221 offset:0
    v_mfma_f32_16x16x32_bf16 v[144:147], v[44:47], a[28:31], v[144:147]
    ds_read_b64_tr_b16 v[34:35], v221 offset:2304
    v_mfma_f32_16x16x32_bf16 v[112:115], v[48:51], a[24:27], v[112:115]
    ds_read_b64_tr_b16 v[36:37], v221 offset:32
    v_mfma_f32_16x16x32_bf16 v[148:151], v[48:51], a[28:31], v[148:151]
    ds_read_b64_tr_b16 v[38:39], v221 offset:2336
    v_mfma_f32_16x16x32_bf16 v[116:119], v[52:55], a[24:27], v[116:119]
    ds_read_b64_tr_b16 v[40:41], v221 offset:64
    v_mfma_f32_16x16x32_bf16 v[152:155], v[52:55], a[28:31], v[152:155]
    ds_read_b64_tr_b16 v[42:43], v221 offset:2368
    s_waitcnt lgkmcnt(6)
    v_mfma_f32_16x16x32_bf16 v[120:123], v[56:59], a[24:27], v[120:123]
    ds_read_b64_tr_b16 v[44:45], v221 offset:96
    v_mfma_f32_16x16x32_bf16 v[156:159], v[56:59], a[28:31], v[156:159]
    ds_read_b64_tr_b16 v[46:47], v221 offset:2400
    v_mfma_f32_16x16x32_bf16 v[124:127], v[60:63], a[24:27], v[124:127]
    ds_read_b64_tr_b16 v[48:49], v221 offset:128
    v_mfma_f32_16x16x32_bf16 v[160:163], v[60:63], a[28:31], v[160:163]
    ds_read_b64_tr_b16 v[50:51], v221 offset:2432
    v_mfma_f32_16x16x32_bf16 v[128:131], v[64:67], a[24:27], v[128:131]
    ds_read_b64_tr_b16 v[52:53], v221 offset:160
    v_mfma_f32_16x16x32_bf16 v[164:167], v[64:67], a[28:31], v[164:167]
    ds_read_b64_tr_b16 v[54:55], v221 offset:2464
    v_mov_b32 v220, v221
    s_mov_b32 s46, s62
    s_mov_b32 s62, s63
    s_mov_b32 s63, s64
    s_mov_b32 s64, s68
    s_mov_b32 s68, s46
    s_cmp_lg_u32 s42, 0
    s_cbranch_scc1 L_pub_21
    s_lshl_b32 s49, s2, 7
    s_add_u32 s49, s49, 24
    v_mov_b32 v4, s44
    v_mov_b32 v5, s45
    v_mov_b32 v6, 0
    s_mov_b64 exec, 1
    buffer_store_dwordx2 v[4:5], v6, s[24:27], s49 offen sc1
    s_mov_b64 exec, -1
L_pub_21:
    s_add_u32 s60, s60, 147456
    v_add_u32 v221, s63, v219
    s_waitcnt lgkmcnt(6)
    v_mfma_f32_16x16x32_bf16 v[96:99], v[32:35], a[32:35], v[96:99]
    ds_read_b64_tr_b16 v[56:57], v220 offset:192
    v_mfma_f32_16x16x32_bf16 v[132:135], v[32:35], a[36:39], v[132:135]
    ds_read_b64_tr_b16 v[58:59], v220 offset:2496
    v_mfma_f32_16x16x32_bf16 v[100:103], v[36:39], a[32:35], v[100:103]
    s_mul_i32 s48, s42, 9216
    s_add_u32 s48, s48, s64
    s_add_u32 m0, s48, 0
    ds_read_b64_tr_b16 v[60:61], v220 offset:224
    v_mfma_f32_16x16x32_bf16 v[136:139], v[36:39], a[36:39], v[136:139]
    ds_read_b64_tr_b16 v[62:63], v220 offset:2528
    buffer_load_dwordx4 v192, s[28:31], s60 offen lds
    v_mfma_f32_16x16x32_bf16 v[104:107], v[40:43], a[32:35], v[104:107]
    ds_read_b64_tr_b16 v[64:65], v220 offset:256
    v_mfma_f32_16x16x32_bf16 v[140:143], v[40:43], a[36:39], v[140:143]
    ds_read_b64_tr_b16 v[66:67], v220 offset:2560
    s_waitcnt lgkmcnt(6)
    v_mfma_f32_16x16x32_bf16 v[108:111], v[44:47], a[32:35], v[108:111]
    ds_read_b64_tr_b16 v[32:33], v220 offset:9216
    v_mfma_f32_16x16x32_bf16 v[144:147], v[44:47], a[36:39], v[144:147]
    ds_read_b64_tr_b16 v[34:35], v220 offset:11520
    buffer_load_dwordx4 a[0:3], v222, s[24:27], s59 offen offset:0 sc1
    v_mfma_f32_16x16x32_bf16 v[112:115], v[48:51], a[32:35], v[112:115]
    s_add_u32 m0, s48, 1024
    ds_read_b64_tr_b16 v[36:37], v220 offset:9248
    v_mfma_f32_16x16x32_bf16 v[148:151], v[48:51], a[36:39], v[148:151]
    ds_read_b64_tr_b16 v[38:39], v220 offset:11552
    buffer_load_dwordx4 v193, s[28:31], s60 offen lds
    v_mfma_f32_16x16x32_bf16 v[116:119], v[52:55], a[32:35], v[116:119]
    ds_read_b64_tr_b16 v[40:41], v220 offset:9280
    v_mfma_f32_16x16x32_bf16 v[152:155], v[52:55], a[36:39], v[152:155]
    ds_read_b64_tr_b16 v[42:43], v220 offset:11584
    s_waitcnt lgkmcnt(6)
    v_mfma_f32_16x16x32_bf16 v[120:123], v[56:59], a[32:35], v[120:123]
    ds_read_b64_tr_b16 v[44:45], v220 offset:9312
    v_mfma_f32_16x16x32_bf16 v[156:159], v[56:59], a[36:39], v[156:159]
    ds_read_b64_tr_b16 v[46:47], v220 offset:11616
    v_mfma_f32_16x16x32_bf16 v[124:127], v[60:63], a[32:35], v[124:127]
    s_add_u32 m0, s48, 2048
    ds_read_b64_tr_b16 v[48:49], v220 offset:9344
    v_mfma_f32_16x16x32_bf16 v[160:163], v[60:63], a[36:39], v[160:163]
    ds_read_b64_tr_b16 v[50:51], v220 offset:11648
    buffer_load_dwordx4 v194, s[28:31], s60 offen lds
    buffer_load_dwordx4 a[4:7], v222, s[24:27], s59 offen offset:256 sc1
    v_mfma_f32_16x16x32_bf16 v[128:131], v[64:67], a[32:35], v[128:131]
    ds_read_b64_tr_b16 v[52:53], v220 offset:9376
    v_mfma_f32_16x16x32_bf16 v[164:167], v[64:67], a[36:39], v[164:167]
    ds_read_b64_tr_b16 v[54:55], v220 offset:11680
    s_waitcnt lgkmcnt(6)
    v_mfma_f32_16x16x32_bf16 v[96:99], v[32:35], a[40:43], v[96:99]
    ds_read_b64_tr_b16 v[56:57], v220 offset:9408
    v_mfma_f32_16x16x32_bf16 v[132:135], v[32:35], a[44:47], v[132:135]
    ds_read_b64_tr_b16 v[58:59], v220 offset:11712
    v_mfma_f32_16x16x32_bf16 v[100:103], v[36:39], a[40:43], v[100:103]
    s_add_u32 m0, s48, 3072
    ds_read_b64_tr_b16 v[60:61], v220 offset:9440
    v_mfma_f32_16x16x32_bf16 v[136:139], v[36:39], a[44:47], v[136:139]
    ds_read_b64_tr_b16 v[62:63], v220 offset:11744
    buffer_load_dwordx4 v195, s[28:31], s60 offen lds
    v_mfma_f32_16x16x32_bf16 v[104:107], v[40:43], a[40:43], v[104:107]
    ds_read_b64_tr_b16 v[64:65], v220 offset:9472
    v_mfma_f32_16x16x32_bf16 v[140:143], v[40:43], a[44:47], v[140:143]
    ds_read_b64_tr_b16 v[66:67], v220 offset:11776
    buffer_load_dwordx4 a[8:11], v222, s[24:27], s59 offen offset:2048 sc1
    s_waitcnt lgkmcnt(6)
    v_mfma_f32_16x16x32_bf16 v[108:111], v[44:47], a[40:43], v[108:111]
    ds_read_b64_tr_b16 v[32:33], v220 offset:18432
    v_mfma_f32_16x16x32_bf16 v[144:147], v[44:47], a[44:47], v[144:147]
    ds_read_b64_tr_b16 v[34:35], v220 offset:20736
    v_mfma_f32_16x16x32_bf16 v[112:115], v[48:51], a[40:43], v[112:115]
    s_add_u32 m0, s48, 4096
    ds_read_b64_tr_b16 v[36:37], v220 offset:18464
    v_mfma_f32_16x16x32_bf16 v[148:151], v[48:51], a[44:47], v[148:151]
    ds_read_b64_tr_b16 v[38:39], v220 offset:20768
    buffer_load_dwordx4 v196, s[28:31], s60 offen lds
    v_mfma_f32_16x16x32_bf16 v[116:119], v[52:55], a[40:43], v[116:119]
    ds_read_b64_tr_b16 v[40:41], v220 offset:18496
    v_mfma_f32_16x16x32_bf16 v[152:155], v[52:55], a[44:47], v[152:155]
    ds_read_b64_tr_b16 v[42:43], v220 offset:20800
    s_waitcnt lgkmcnt(6)
    v_mfma_f32_16x16x32_bf16 v[120:123], v[56:59], a[40:43], v[120:123]
    ds_read_b64_tr_b16 v[44:45], v220 offset:18528
    v_mfma_f32_16x16x32_bf16 v[156:159], v[56:59], a[44:47], v[156:159]
    ds_read_b64_tr_b16 v[46:47], v220 offset:20832
    buffer_load_dwordx4 a[12:15], v222, s[24:27], s59 offen offset:2304 sc1
    v_mfma_f32_16x16x32_bf16 v[124:127], v[60:63], a[40:43], v[124:127]
    s_add_u32 m0, s48, 5120
    ds_read_b64_tr_b16 v[48:49], v220 offset:18560
    v_mfma_f32_16x16x32_bf16 v[160:163], v[60:63], a[44:47], v[160:163]
    ds_read_b64_tr_b16 v[50:51], v220 offset:20864
    buffer_load_dwordx4 v197, s[28:31], s60 offen lds
    v_mfma_f32_16x16x32_bf16 v[128:131], v[64:67], a[40:43], v[128:131]
    ds_read_b64_tr_b16 v[52:53], v220 offset:18592
    v_mfma_f32_16x16x32_bf16 v[164:167], v[64:67], a[44:47], v[164:167]
    ds_read_b64_tr_b16 v[54:55], v220 offset:20896
    s_waitcnt lgkmcnt(6)
    v_mfma_f32_16x16x32_bf16 v[96:99], v[32:35], a[48:51], v[96:99]
    ds_read_b64_tr_b16 v[56:57], v220 offset:18624
    v_mfma_f32_16x16x32_bf16 v[132:135], v[32:35], a[52:55], v[132:135]
    ds_read_b64_tr_b16 v[58:59], v220 offset:20928
    v_mfma_f32_16x16x32_bf16 v[100:103], v[36:39], a[48:51], v[100:103]
    s_add_u32 m0, s48, 6144
    ds_read_b64_tr_b16 v[60:61], v220 offset:18656
    v_mfma_f32_16x16x32_bf16 v[136:139], v[36:39], a[52:55], v[136:139]
    ds_read_b64_tr_b16 v[62:63], v220 offset:20960
    buffer_load_dwordx4 v198, s[28:31], s60 offen lds
    s_add_u32 s59, s59, 4096
    buffer_load_dwordx4 a[16:19], v222, s[24:27], s59 offen offset:0 sc1
    v_mfma_f32_16x16x32_bf16 v[104:107], v[40:43], a[48:51], v[104:107]
    ds_read_b64_tr_b16 v[64:65], v220 offset:18688
    v_mfma_f32_16x16x32_bf16 v[140:143], v[40:43], a[52:55], v[140:143]
    ds_read_b64_tr_b16 v[66:67], v220 offset:20992
    s_waitcnt lgkmcnt(6)
    v_mfma_f32_16x16x32_bf16 v[108:111], v[44:47], a[48:51], v[108:111]
    ds_read_b64_tr_b16 v[32:33], v220 offset:27648
    v_mfma_f32_16x16x32_bf16 v[144:147], v[44:47], a[52:55], v[144:147]
    ds_read_b64_tr_b16 v[34:35], v220 offset:29952
    v_mfma_f32_16x16x32_bf16 v[112:115], v[48:51], a[48:51], v[112:115]
    s_add_u32 m0, s48, 7168
    ds_read_b64_tr_b16 v[36:37], v220 offset:27680
    v_mfma_f32_16x16x32_bf16 v[148:151], v[48:51], a[52:55], v[148:151]
    ds_read_b64_tr_b16 v[38:39], v220 offset:29984
    buffer_load_dwordx4 v199, s[28:31], s60 offen lds
    v_mfma_f32_16x16x32_bf16 v[116:119], v[52:55], a[48:51], v[116:119]
    ds_read_b64_tr_b16 v[40:41], v220 offset:27712
    v_mfma_f32_16x16x32_bf16 v[152:155], v[52:55], a[52:55], v[152:155]
    ds_read_b64_tr_b16 v[42:43], v220 offset:30016
    buffer_load_dwordx4 a[20:23], v222, s[24:27], s59 offen offset:256 sc1
    s_waitcnt lgkmcnt(6)
    v_mfma_f32_16x16x32_bf16 v[120:123], v[56:59], a[48:51], v[120:123]
    ds_read_b64_tr_b16 v[44:45], v220 offset:27744
    v_mfma_f32_16x16x32_bf16 v[156:159], v[56:59], a[52:55], v[156:159]
    ds_read_b64_tr_b16 v[46:47], v220 offset:30048
    v_mfma_f32_16x16x32_bf16 v[124:127], v[60:63], a[48:51], v[124:127]
    s_add_u32 m0, s48, 8192
    ds_read_b64_tr_b16 v[48:49], v220 offset:27776
    v_mfma_f32_16x16x32_bf16 v[160:163], v[60:63], a[52:55], v[160:163]
    ds_read_b64_tr_b16 v[50:51], v220 offset:30080
    buffer_load_dwordx4 v200, s[28:31], s60 offen lds
    v_mfma_f32_16x16x32_bf16 v[128:131], v[64:67], a[48:51], v[128:131]
    ds_read_b64_tr_b16 v[52:53], v220 offset:27808
    v_mfma_f32_16x16x32_bf16 v[164:167], v[64:67], a[52:55], v[164:167]
    ds_read_b64_tr_b16 v[54:55], v220 offset:30112
    s_waitcnt lgkmcnt(6)
    v_mfma_f32_16x16x32_bf16 v[96:99], v[32:35], a[56:59], v[96:99]
    ds_read_b64_tr_b16 v[56:57], v220 offset:27840
    v_mfma_f32_16x16x32_bf16 v[132:135], v[32:35], a[60:63], v[132:135]
    ds_read_b64_tr_b16 v[58:59], v220 offset:30144
    buffer_load_dwordx4 a[24:27], v222, s[24:27], s59 offen offset:2048 sc1
    v_mfma_f32_16x16x32_bf16 v[100:103], v[36:39], a[56:59], v[100:103]
    ds_read_b64_tr_b16 v[60:61], v220 offset:27872
    v_mfma_f32_16x16x32_bf16 v[136:139], v[36:39], a[60:63], v[136:139]
    ds_read_b64_tr_b16 v[62:63], v220 offset:30176
    v_mfma_f32_16x16x32_bf16 v[104:107], v[40:43], a[56:59], v[104:107]
    ds_read_b64_tr_b16 v[64:65], v220 offset:27904
    v_mfma_f32_16x16x32_bf16 v[140:143], v[40:43], a[60:63], v[140:143]
    ds_read_b64_tr_b16 v[66:67], v220 offset:30208
    s_waitcnt vmcnt(17)
    s_barrier
    s_waitcnt lgkmcnt(6)
    v_mfma_f32_16x16x32_bf16 v[108:111], v[44:47], a[56:59], v[108:111]
    ds_read_b64_tr_b16 v[32:33], v221 offset:0
    v_mfma_f32_16x16x32_bf16 v[144:147], v[44:47], a[60:63], v[144:147]
    ds_read_b64_tr_b16 v[34:35], v221 offset:2304
    v_mfma_f32_16x16x32_bf16 v[112:115], v[48:51], a[56:59], v[112:115]
    ds_read_b64_tr_b16 v[36:37], v221 offset:32
    v_mfma_f32_16x16x32_bf16 v[148:151], v[48:51], a[60:63], v[148:151]
    ds_read_b64_tr_b16 v[38:39], v221 offset:2336
    buffer_load_dwordx4 a[28:31], v222, s[24:27], s59 offen offset:2304 sc1
    s_add_u32 s59, s59, 4096
    v_mfma_f32_16x16x32_bf16 v[116:119], v[52:55], a[56:59], v[116:119]
    ds_read_b64_tr_b16 v[40:41], v221 offset:64
    v_mfma_f32_16x16x32_bf16 v[152:155], v[52:55], a[60:63], v[152:155]
    ds_read_b64_tr_b16 v[42:43], v221 offset:2368
    s_waitcnt lgkmcnt(6)
    v_mfma_f32_16x16x32_bf16 v[120:123], v[56:59], a[56:59], v[120:123]
    ds_read_b64_tr_b16 v[44:45], v221 offset:96
    v_mfma_f32_16x16x32_bf16 v[156:159], v[56:59], a[60:63], v[156:159]
    ds_read_b64_tr_b16 v[46:47], v221 offset:2400
    v_mfma_f32_16x16x32_bf16 v[124:127], v[60:63], a[56:59], v[124:127]
    ds_read_b64_tr_b16 v[48:49], v221 offset:128
    v_mfma_f32_16x16x32_bf16 v[160:163], v[60:63], a[60:63], v[160:163]
    ds_read_b64_tr_b16 v[50:51], v221 offset:2432
    v_mfma_f32_16x16x32_bf16 v[128:131], v[64:67], a[56:59], v[128:131]
    ds_read_b64_tr_b16 v[52:53], v221 offset:160
    v_mfma_f32_16x16x32_bf16 v[164:167], v[64:67], a[60:63], v[164:167]
    ds_read_b64_tr_b16 v[54:55], v221 offset:2464
    v_mov_b32 v220, v221
    s_mov_b32 s46, s62
    s_mov_b32 s62, s63
    s_mov_b32 s63, s64
    s_mov_b32 s64, s68
    s_mov_b32 s68, s46
    s_add_u32 s60, s60, 147456
    v_add_u32 v221, s63, v219
    s_waitcnt lgkmcnt(6)
    v_mfma_f32_16x16x32_bf16 v[96:99], v[32:35], a[64:67], v[96:99]
    ds_read_b64_tr_b16 v[56:57], v220 offset:192
    v_mfma_f32_16x16x32_bf16 v[132:135], v[32:35], a[68:71], v[132:135]
    ds_read_b64_tr_b16 v[58:59], v220 offset:2496
    v_mfma_f32_16x16x32_bf16 v[100:103], v[36:39], a[64:67], v[100:103]
    s_mul_i32 s48, s42, 9216
    s_add_u32 s48, s48, s64
    s_add_u32 m0, s48, 0
    ds_read_b64_tr_b16 v[60:61], v220 offset:224
    v_mfma_f32_16x16x32_bf16 v[136:139], v[36:39], a[68:71], v[136:139]
    ds_read_b64_tr_b16 v[62:63], v220 offset:2528
    buffer_load_dwordx4 v192, s[28:31], s60 offen lds
    v_mfma_f32_16x16x32_bf16 v[104:107], v[40:43], a[64:67], v[104:107]
    ds_read_b64_tr_b16 v[64:65], v220 offset:256
    v_mfma_f32_16x16x32_bf16 v[140:143], v[40:43], a[68:71], v[140:143]
    ds_read_b64_tr_b16 v[66:67], v220 offset:2560
    s_waitcnt lgkmcnt(6)
    v_mfma_f32_16x16x32_bf16 v[108:111], v[44:47], a[64:67], v[108:111]
    ds_read_b64_tr_b16 v[32:33], v220 offset:9216
    v_mfma_f32_16x16x32_bf16 v[144:147], v[44:47], a[68:71], v[144:147]
    ds_read_b64_tr_b16 v[34:35], v220 offset:11520
    v_mfma_f32_16x16x32_bf16 v[112:115], v[48:51], a[64:67], v[112:115]
    s_add_u32 m0, s48, 1024
    ds_read_b64_tr_b16 v[36:37], v220 offset:9248
    v_mfma_f32_16x16x32_bf16 v[148:151], v[48:51], a[68:71], v[148:151]
    ds_read_b64_tr_b16 v[38:39], v220 offset:11552
    buffer_load_dwordx4 v193, s[28:31], s60 offen lds
    v_mfma_f32_16x16x32_bf16 v[116:119], v[52:55], a[64:67], v[116:119]
    ds_read_b64_tr_b16 v[40:41], v220 offset:9280
    v_mfma_f32_16x16x32_bf16 v[152:155], v[52:55], a[68:71], v[152:155]
    ds_read_b64_tr_b16 v[42:43], v220 offset:11584
    s_waitcnt lgkmcnt(6)
    v_mfma_f32_16x16x32_bf16 v[120:123], v[56:59], a[64:67], v[120:123]
    ds_read_b64_tr_b16 v[44:45], v220 offset:9312
    v_mfma_f32_16x16x32_bf16 v[156:159], v[56:59], a[68:71], v[156:159]
    ds_read_b64_tr_b16 v[46:47], v220 offset:11616
    v_mfma_f32_16x16x32_bf16 v[124:127], v[60:63], a[64:67], v[124:127]
    s_add_u32 m0, s48, 2048
    ds_read_b64_tr_b16 v[48:49], v220 offset:9344
    v_mfma_f32_16x16x32_bf16 v[160:163], v[60:63], a[68:71], v[160:163]
    ds_read_b64_tr_b16 v[50:51], v220 offset:11648
    buffer_load_dwordx4 v194, s[28:31], s60 offen lds
    v_mfma_f32_16x16x32_bf16 v[128:131], v[64:67], a[64:67], v[128:131]
    ds_read_b64_tr_b16 v[52:53], v220 offset:9376
    v_mfma_f32_16x16x32_bf16 v[164:167], v[64:67], a[68:71], v[164:167]
    ds_read_b64_tr_b16 v[54:55], v220 offset:11680
    s_waitcnt lgkmcnt(6)
    v_mfma_f32_16x16x32_bf16 v[96:99], v[32:35], a[72:75], v[96:99]
    ds_read_b64_tr_b16 v[56:57], v220 offset:9408
    v_mfma_f32_16x16x32_bf16 v[132:135], v[32:35], a[76:79], v[132:135]
    ds_read_b64_tr_b16 v[58:59], v220 offset:11712
    v_mfma_f32_16x16x32_bf16 v[100:103], v[36:39], a[72:75], v[100:103]
    s_add_u32 m0, s48, 3072
    ds_read_b64_tr_b16 v[60:61], v220 offset:9440
    v_mfma_f32_16x16x32_bf16 v[136:139], v[36:39], a[76:79], v[136:139]
    ds_read_b64_tr_b16 v[62:63], v220 offset:11744
    buffer_load_dwordx4 v195, s[28:31], s60 offen lds
    v_mfma_f32_16x16x32_bf16 v[104:107], v[40:43], a[72:75], v[104:107]
    ds_read_b64_tr_b16 v[64:65], v220 offset:9472
    v_mfma_f32_16x16x32_bf16 v[140:143], v[40:43], a[76:79], v[140:143]
    ds_read_b64_tr_b16 v[66:67], v220 offset:11776
    s_waitcnt lgkmcnt(6)
    v_mfma_f32_16x16x32_bf16 v[108:111], v[44:47], a[72:75], v[108:111]
    ds_read_b64_tr_b16 v[32:33], v220 offset:18432
    v_mfma_f32_16x16x32_bf16 v[144:147], v[44:47], a[76:79], v[144:147]
    ds_read_b64_tr_b16 v[34:35], v220 offset:20736
    v_mfma_f32_16x16x32_bf16 v[112:115], v[48:51], a[72:75], v[112:115]
    s_add_u32 m0, s48, 4096
    ds_read_b64_tr_b16 v[36:37], v220 offset:18464
    v_mfma_f32_16x16x32_bf16 v[148:151], v[48:51], a[76:79], v[148:151]
    ds_read_b64_tr_b16 v[38:39], v220 offset:20768
    buffer_load_dwordx4 v196, s[28:31], s60 offen lds
    v_mfma_f32_16x16x32_bf16 v[116:119], v[52:55], a[72:75], v[116:119]
    ds_read_b64_tr_b16 v[40:41], v220 offset:18496
    v_mfma_f32_16x16x32_bf16 v[152:155], v[52:55], a[76:79], v[152:155]
    ds_read_b64_tr_b16 v[42:43], v220 offset:20800
    s_waitcnt lgkmcnt(6)
    v_mfma_f32_16x16x32_bf16 v[120:123], v[56:59], a[72:75], v[120:123]
    ds_read_b64_tr_b16 v[44:45], v220 offset:18528
    v_mfma_f32_16x16x32_bf16 v[156:159], v[56:59], a[76:79], v[156:159]
    ds_read_b64_tr_b16 v[46:47], v220 offset:20832
    v_mfma_f32_16x16x32_bf16 v[124:127], v[60:63], a[72:75], v[124:127]
    s_add_u32 m0, s48, 5120
    ds_read_b64_tr_b16 v[48:49], v220 offset:18560
    v_mfma_f32_16x16x32_bf16 v[160:163], v[60:63], a[76:79], v[160:163]
    ds_read_b64_tr_b16 v[50:51], v220 offset:20864
    buffer_load_dwordx4 v197, s[28:31], s60 offen lds
    v_mfma_f32_16x16x32_bf16 v[128:131], v[64:67], a[72:75], v[128:131]
    ds_read_b64_tr_b16 v[52:53], v220 offset:18592
    v_mfma_f32_16x16x32_bf16 v[164:167], v[64:67], a[76:79], v[164:167]
    ds_read_b64_tr_b16 v[54:55], v220 offset:20896
    s_waitcnt lgkmcnt(6)
    v_mfma_f32_16x16x32_bf16 v[96:99], v[32:35], a[80:83], v[96:99]
    ds_read_b64_tr_b16 v[56:57], v220 offset:18624
    v_mfma_f32_16x16x32_bf16 v[132:135], v[32:35], a[84:87], v[132:135]
    ds_read_b64_tr_b16 v[58:59], v220 offset:20928
    v_mfma_f32_16x16x32_bf16 v[100:103], v[36:39], a[80:83], v[100:103]
    s_add_u32 m0, s48, 6144
    ds_read_b64_tr_b16 v[60:61], v220 offset:18656
    v_mfma_f32_16x16x32_bf16 v[136:139], v[36:39], a[84:87], v[136:139]
    ds_read_b64_tr_b16 v[62:63], v220 offset:20960
    buffer_load_dwordx4 v198, s[28:31], s60 offen lds
    v_mfma_f32_16x16x32_bf16 v[104:107], v[40:43], a[80:83], v[104:107]
    ds_read_b64_tr_b16 v[64:65], v220 offset:18688
    v_mfma_f32_16x16x32_bf16 v[140:143], v[40:43], a[84:87], v[140:143]
    ds_read_b64_tr_b16 v[66:67], v220 offset:20992
    s_waitcnt lgkmcnt(6)
    v_mfma_f32_16x16x32_bf16 v[108:111], v[44:47], a[80:83], v[108:111]
    ds_read_b64_tr_b16 v[32:33], v220 offset:27648
    v_mfma_f32_16x16x32_bf16 v[144:147], v[44:47], a[84:87], v[144:147]
    ds_read_b64_tr_b16 v[34:35], v220 offset:29952
    v_mfma_f32_16x16x32_bf16 v[112:115], v[48:51], a[80:83], v[112:115]
    s_add_u32 m0, s48, 7168
    ds_read_b64_tr_b16 v[36:37], v220 offset:27680
    v_mfma_f32_16x16x32_bf16 v[148:151], v[48:51], a[84:87], v[148:151]
    ds_read_b64_tr_b16 v[38:39], v220 offset:29984
    buffer_load_dwordx4 v199, s[28:31], s60 offen lds
    v_mfma_f32_16x16x32_bf16 v[116:119], v[52:55], a[80:83], v[116:119]
    ds_read_b64_tr_b16 v[40:41], v220 offset:27712
    v_mfma_f32_16x16x32_bf16 v[152:155], v[52:55], a[84:87], v[152:155]
    ds_read_b64_tr_b16 v[42:43], v220 offset:30016
    s_waitcnt lgkmcnt(6)
    v_mfma_f32_16x16x32_bf16 v[120:123], v[56:59], a[80:83], v[120:123]
    ds_read_b64_tr_b16 v[44:45], v220 offset:27744
    v_mfma_f32_16x16x32_bf16 v[156:159], v[56:59], a[84:87], v[156:159]
    ds_read_b64_tr_b16 v[46:47], v220 offset:30048
    v_mfma_f32_16x16x32_bf16 v[124:127], v[60:63], a[80:83], v[124:127]
    s_add_u32 m0, s48, 8192
    ds_read_b64_tr_b16 v[48:49], v220 offset:27776
    v_mfma_f32_16x16x32_bf16 v[160:163], v[60:63], a[84:87], v[160:163]
    ds_read_b64_tr_b16 v[50:51], v220 offset:30080
    buffer_load_dwordx4 v200, s[28:31], s60 offen lds
    v_mfma_f32_16x16x32_bf16 v[128:131], v[64:67], a[80:83], v[128:131]
    ds_read_b64_tr_b16 v[52:53], v220 offset:27808
    v_mfma_f32_16x16x32_bf16 v[164:167], v[64:67], a[84:87], v[164:167]
    ds_read_b64_tr_b16 v[54:55], v220 offset:30112
    s_waitcnt lgkmcnt(6)
    v_mfma_f32_16x16x32_bf16 v[96:99], v[32:35], a[88:91], v[96:99]
    ds_read_b64_tr_b16 v[56:57], v220 offset:27840
    v_mfma_f32_16x16x32_bf16 v[132:135], v[32:35], a[92:95], v[132:135]
    ds_read_b64_tr_b16 v[58:59], v220 offset:30144
    v_mfma_f32_16x16x32_bf16 v[100:103], v[36:39], a[88:91], v[100:103]
    ds_read_b64_tr_b16 v[60:61], v220 offset:27872
    v_mfma_f32_16x16x32_bf16 v[136:139], v[36:39], a[92:95], v[136:139]
    ds_read_b64_tr_b16 v[62:63], v220 offset:30176
    v_mfma_f32_16x16x32_bf16 v[104:107], v[40:43], a[88:91], v[104:107]
    ds_read_b64_tr_b16 v[64:65], v220 offset:27904
    v_mfma_f32_16x16x32_bf16 v[140:143], v[40:43], a[92:95], v[140:143]
    ds_read_b64_tr_b16 v[66:67], v220 offset:30208
    s_waitcnt vmcnt(11)
    s_barrier
    s_waitcnt lgkmcnt(6)
    v_mfma_f32_16x16x32_bf16 v[108:111], v[44:47], a[88:91], v[108:111]
    ds_read_b64_tr_b16 v[32:33], v221 offset:0
    v_mfma_f32_16x16x32_bf16 v[144:147], v[44:47], a[92:95], v[144:147]
    ds_read_b64_tr_b16 v[34:35], v221 offset:2304
    v_mfma_f32_16x16x32_bf16 v[112:115], v[48:51], a[88:91], v[112:115]
    ds_read_b64_tr_b16 v[36:37], v221 offset:32
    v_mfma_f32_16x16x32_bf16 v[148:151], v[48:51], a[92:95], v[148:151]
    ds_read_b64_tr_b16 v[38:39], v221 offset:2336
    v_mfma_f32_16x16x32_bf16 v[116:119], v[52:55], a[88:91], v[116:119]
    ds_read_b64_tr_b16 v[40:41], v221 offset:64
    v_mfma_f32_16x16x32_bf16 v[152:155], v[52:55], a[92:95], v[152:155]
    ds_read_b64_tr_b16 v[42:43], v221 offset:2368
    s_waitcnt lgkmcnt(6)
    v_mfma_f32_16x16x32_bf16 v[120:123], v[56:59], a[88:91], v[120:123]
    ds_read_b64_tr_b16 v[44:45], v221 offset:96
    v_mfma_f32_16x16x32_bf16 v[156:159], v[56:59], a[92:95], v[156:159]
    ds_read_b64_tr_b16 v[46:47], v221 offset:2400
    v_mfma_f32_16x16x32_bf16 v[124:127], v[60:63], a[88:91], v[124:127]
    ds_read_b64_tr_b16 v[48:49], v221 offset:128
    v_mfma_f32_16x16x32_bf16 v[160:163], v[60:63], a[92:95], v[160:163]
    ds_read_b64_tr_b16 v[50:51], v221 offset:2432
    v_mfma_f32_16x16x32_bf16 v[128:131], v[64:67], a[88:91], v[128:131]
    ds_read_b64_tr_b16 v[52:53], v221 offset:160
    v_mfma_f32_16x16x32_bf16 v[164:167], v[64:67], a[92:95], v[164:167]
    ds_read_b64_tr_b16 v[54:55], v221 offset:2464
    v_mov_b32 v220, v221
    s_mov_b32 s46, s62
    s_mov_b32 s62, s63
    s_mov_b32 s63, s64
    s_mov_b32 s64, s68
    s_mov_b32 s68, s46
    s_add_u32 s60, s60, 147456
    v_add_u32 v221, s63, v219
    s_waitcnt lgkmcnt(6)
    v_mfma_f32_16x16x32_bf16 v[96:99], v[32:35], a[96:99], v[96:99]
    ds_read_b64_tr_b16 v[56:57], v220 offset:192
    v_mfma_f32_16x16x32_bf16 v[132:135], v[32:35], a[100:103], v[132:135]
    ds_read_b64_tr_b16 v[58:59], v220 offset:2496
    v_mfma_f32_16x16x32_bf16 v[100:103], v[36:39], a[96:99], v[100:103]
    s_mul_i32 s48, s42, 9216
    s_add_u32 s48, s48, s64
    s_add_u32 m0, s48, 0
    ds_read_b64_tr_b16 v[60:61], v220 offset:224
    v_mfma_f32_16x16x32_bf16 v[136:139], v[36:39], a[100:103], v[136:139]
    ds_read_b64_tr_b16 v[62:63], v220 offset:2528
    buffer_load_dwordx4 v192, s[28:31], s60 offen lds
    v_mfma_f32_16x16x32_bf16 v[104:107], v[40:43], a[96:99], v[104:107]
    ds_read_b64_tr_b16 v[64:65], v220 offset:256
    v_mfma_f32_16x16x32_bf16 v[140:143], v[40:43], a[100:103], v[140:143]
    ds_read_b64_tr_b16 v[66:67], v220 offset:2560
    s_waitcnt lgkmcnt(6)
    v_mfma_f32_16x16x32_bf16 v[108:111], v[44:47], a[96:99], v[108:111]
    ds_read_b64_tr_b16 v[32:33], v220 offset:9216
    v_mfma_f32_16x16x32_bf16 v[144:147], v[44:47], a[100:103], v[144:147]
    ds_read_b64_tr_b16 v[34:35], v220 offset:11520
    v_mfma_f32_16x16x32_bf16 v[112:115], v[48:51], a[96:99], v[112:115]
    s_add_u32 m0, s48, 1024
    ds_read_b64_tr_b16 v[36:37], v220 offset:9248
    v_mfma_f32_16x16x32_bf16 v[148:151], v[48:51], a[100:103], v[148:151]
    ds_read_b64_tr_b16 v[38:39], v220 offset:11552
    buffer_load_dwordx4 v193, s[28:31], s60 offen lds
    v_mfma_f32_16x16x32_bf16 v[116:119], v[52:55], a[96:99], v[116:119]
    ds_read_b64_tr_b16 v[40:41], v220 offset:9280
    v_mfma_f32_16x16x32_bf16 v[152:155], v[52:55], a[100:103], v[152:155]
    ds_read_b64_tr_b16 v[42:43], v220 offset:11584
    s_waitcnt lgkmcnt(6)
    v_mfma_f32_16x16x32_bf16 v[120:123], v[56:59], a[96:99], v[120:123]
    ds_read_b64_tr_b16 v[44:45], v220 offset:9312
    v_mfma_f32_16x16x32_bf16 v[156:159], v[56:59], a[100:103], v[156:159]
    ds_read_b64_tr_b16 v[46:47], v220 offset:11616
    v_mfma_f32_16x16x32_bf16 v[124:127], v[60:63], a[96:99], v[124:127]
    s_add_u32 m0, s48, 2048
    ds_read_b64_tr_b16 v[48:49], v220 offset:9344
    v_mfma_f32_16x16x32_bf16 v[160:163], v[60:63], a[100:103], v[160:163]
    ds_read_b64_tr_b16 v[50:51], v220 offset:11648
    buffer_load_dwordx4 v194, s[28:31], s60 offen lds
    v_mfma_f32_16x16x32_bf16 v[128:131], v[64:67], a[96:99], v[128:131]
    ds_read_b64_tr_b16 v[52:53], v220 offset:9376
    v_mfma_f32_16x16x32_bf16 v[164:167], v[64:67], a[100:103], v[164:167]
    ds_read_b64_tr_b16 v[54:55], v220 offset:11680
    s_waitcnt lgkmcnt(6)
    v_mfma_f32_16x16x32_bf16 v[96:99], v[32:35], a[104:107], v[96:99]
    ds_read_b64_tr_b16 v[56:57], v220 offset:9408
    v_mfma_f32_16x16x32_bf16 v[132:135], v[32:35], a[108:111], v[132:135]
    ds_read_b64_tr_b16 v[58:59], v220 offset:11712
    v_mfma_f32_16x16x32_bf16 v[100:103], v[36:39], a[104:107], v[100:103]
    s_add_u32 m0, s48, 3072
    ds_read_b64_tr_b16 v[60:61], v220 offset:9440
    v_mfma_f32_16x16x32_bf16 v[136:139], v[36:39], a[108:111], v[136:139]
    ds_read_b64_tr_b16 v[62:63], v220 offset:11744
    buffer_load_dwordx4 v195, s[28:31], s60 offen lds
    v_mfma_f32_16x16x32_bf16 v[104:107], v[40:43], a[104:107], v[104:107]
    ds_read_b64_tr_b16 v[64:65], v220 offset:9472
    v_mfma_f32_16x16x32_bf16 v[140:143], v[40:43], a[108:111], v[140:143]
    ds_read_b64_tr_b16 v[66:67], v220 offset:11776
    s_waitcnt lgkmcnt(6)
    v_mfma_f32_16x16x32_bf16 v[108:111], v[44:47], a[104:107], v[108:111]
    ds_read_b64_tr_b16 v[32:33], v220 offset:18432
    v_mfma_f32_16x16x32_bf16 v[144:147], v[44:47], a[108:111], v[144:147]
    ds_read_b64_tr_b16 v[34:35], v220 offset:20736
    v_mfma_f32_16x16x32_bf16 v[112:115], v[48:51], a[104:107], v[112:115]
    s_add_u32 m0, s48, 4096
    ds_read_b64_tr_b16 v[36:37], v220 offset:18464
    v_mfma_f32_16x16x32_bf16 v[148:151], v[48:51], a[108:111], v[148:151]
    ds_read_b64_tr_b16 v[38:39], v220 offset:20768
    buffer_load_dwordx4 v196, s[28:31], s60 offen lds
    v_mfma_f32_16x16x32_bf16 v[116:119], v[52:55], a[104:107], v[116:119]
    ds_read_b64_tr_b16 v[40:41], v220 offset:18496
    v_mfma_f32_16x16x32_bf16 v[152:155], v[52:55], a[108:111], v[152:155]
    ds_read_b64_tr_b16 v[42:43], v220 offset:20800
    s_waitcnt lgkmcnt(6)
    v_mfma_f32_16x16x32_bf16 v[120:123], v[56:59], a[104:107], v[120:123]
    ds_read_b64_tr_b16 v[44:45], v220 offset:18528
    v_mfma_f32_16x16x32_bf16 v[156:159], v[56:59], a[108:111], v[156:159]
    ds_read_b64_tr_b16 v[46:47], v220 offset:20832
    v_mfma_f32_16x16x32_bf16 v[124:127], v[60:63], a[104:107], v[124:127]
    s_add_u32 m0, s48, 5120
    ds_read_b64_tr_b16 v[48:49], v220 offset:18560
    v_mfma_f32_16x16x32_bf16 v[160:163], v[60:63], a[108:111], v[160:163]
    ds_read_b64_tr_b16 v[50:51], v220 offset:20864
    buffer_load_dwordx4 v197, s[28:31], s60 offen lds
    v_mfma_f32_16x16x32_bf16 v[128:131], v[64:67], a[104:107], v[128:131]
    ds_read_b64_tr_b16 v[52:53], v220 offset:18592
    v_mfma_f32_16x16x32_bf16 v[164:167], v[64:67], a[108:111], v[164:167]
    ds_read_b64_tr_b16 v[54:55], v220 offset:20896
    s_waitcnt lgkmcnt(6)
    v_mfma_f32_16x16x32_bf16 v[96:99], v[32:35], a[112:115], v[96:99]
    ds_read_b64_tr_b16 v[56:57], v220 offset:18624
    v_mfma_f32_16x16x32_bf16 v[132:135], v[32:35], a[116:119], v[132:135]
    ds_read_b64_tr_b16 v[58:59], v220 offset:20928
    v_mfma_f32_16x16x32_bf16 v[100:103], v[36:39], a[112:115], v[100:103]
    s_add_u32 m0, s48, 6144
    ds_read_b64_tr_b16 v[60:61], v220 offset:18656
    v_mfma_f32_16x16x32_bf16 v[136:139], v[36:39], a[116:119], v[136:139]
    ds_read_b64_tr_b16 v[62:63], v220 offset:20960
    buffer_load_dwordx4 v198, s[28:31], s60 offen lds
    v_mfma_f32_16x16x32_bf16 v[104:107], v[40:43], a[112:115], v[104:107]
    ds_read_b64_tr_b16 v[64:65], v220 offset:18688
    v_mfma_f32_16x16x32_bf16 v[140:143], v[40:43], a[116:119], v[140:143]
    ds_read_b64_tr_b16 v[66:67], v220 offset:20992
    s_waitcnt lgkmcnt(6)
    v_mfma_f32_16x16x32_bf16 v[108:111], v[44:47], a[112:115], v[108:111]
    ds_read_b64_tr_b16 v[32:33], v220 offset:27648
    v_mfma_f32_16x16x32_bf16 v[144:147], v[44:47], a[116:119], v[144:147]
    ds_read_b64_tr_b16 v[34:35], v220 offset:29952
    v_mfma_f32_16x16x32_bf16 v[112:115], v[48:51], a[112:115], v[112:115]
    s_add_u32 m0, s48, 7168
    ds_read_b64_tr_b16 v[36:37], v220 offset:27680
    v_mfma_f32_16x16x32_bf16 v[148:151], v[48:51], a[116:119], v[148:151]
    ds_read_b64_tr_b16 v[38:39], v220 offset:29984
    buffer_load_dwordx4 v199, s[28:31], s60 offen lds
    v_mfma_f32_16x16x32_bf16 v[116:119], v[52:55], a[112:115], v[116:119]
    ds_read_b64_tr_b16 v[40:41], v220 offset:27712
    v_mfma_f32_16x16x32_bf16 v[152:155], v[52:55], a[116:119], v[152:155]
    ds_read_b64_tr_b16 v[42:43], v220 offset:30016
    s_waitcnt lgkmcnt(6)
    v_mfma_f32_16x16x32_bf16 v[120:123], v[56:59], a[112:115], v[120:123]
    ds_read_b64_tr_b16 v[44:45], v220 offset:27744
    v_mfma_f32_16x16x32_bf16 v[156:159], v[56:59], a[116:119], v[156:159]
    ds_read_b64_tr_b16 v[46:47], v220 offset:30048
    v_mfma_f32_16x16x32_bf16 v[124:127], v[60:63], a[112:115], v[124:127]
    s_add_u32 m0, s48, 8192
    ds_read_b64_tr_b16 v[48:49], v220 offset:27776
    v_mfma_f32_16x16x32_bf16 v[160:163], v[60:63], a[116:119], v[160:163]
    ds_read_b64_tr_b16 v[50:51], v220 offset:30080
    buffer_load_dwordx4 v200, s[28:31], s60 offen lds
    v_mfma_f32_16x16x32_bf16 v[128:131], v[64:67], a[112:115], v[128:131]
    ds_read_b64_tr_b16 v[52:53], v220 offset:27808
    v_mfma_f32_16x16x32_bf16 v[164:167], v[64:67], a[116:119], v[164:167]
    ds_read_b64_tr_b16 v[54:55], v220 offset:30112
    s_waitcnt lgkmcnt(6)
    v_mfma_f32_16x16x32_bf16 v[96:99], v[32:35], a[120:123], v[96:99]
    ds_read_b64_tr_b16 v[56:57], v220 offset:27840
    v_mfma_f32_16x16x32_bf16 v[132:135], v[32:35], a[124:127], v[132:135]
    ds_read_b64_tr_b16 v[58:59], v220 offset:30144
    v_mfma_f32_16x16x32_bf16 v[100:103], v[36:39], a[120:123], v[100:103]
    ds_read_b64_tr_b16 v[60:61], v220 offset:27872
    v_mfma_f32_16x16x32_bf16 v[136:139], v[36:39], a[124:127], v[136:139]
    ds_read_b64_tr_b16 v[62:63], v220 offset:30176
    v_mfma_f32_16x16x32_bf16 v[104:107], v[40:43], a[120:123], v[104:107]
    ds_read_b64_tr_b16 v[64:65], v220 offset:27904
    v_mfma_f32_16x16x32_bf16 v[140:143], v[40:43], a[124:127], v[140:143]
    ds_read_b64_tr_b16 v[66:67], v220 offset:30208
    s_waitcnt vmcnt(9)
    s_barrier
    s_waitcnt lgkmcnt(6)
    v_mfma_f32_16x16x32_bf16 v[108:111], v[44:47], a[120:123], v[108:111]
    ds_read_b64_tr_b16 v[32:33], v221 offset:0
    v_mfma_f32_16x16x32_bf16 v[144:147], v[44:47], a[124:127], v[144:147]
    ds_read_b64_tr_b16 v[34:35], v221 offset:2304
    v_mfma_f32_16x16x32_bf16 v[112:115], v[48:51], a[120:123], v[112:115]
    ds_read_b64_tr_b16 v[36:37], v221 offset:32
    v_mfma_f32_16x16x32_bf16 v[148:151], v[48:51], a[124:127], v[148:151]
    ds_read_b64_tr_b16 v[38:39], v221 offset:2336
    v_mfma_f32_16x16x32_bf16 v[116:119], v[52:55], a[120:123], v[116:119]
    ds_read_b64_tr_b16 v[40:41], v221 offset:64
    v_mfma_f32_16x16x32_bf16 v[152:155], v[52:55], a[124:127], v[152:155]
    ds_read_b64_tr_b16 v[42:43], v221 offset:2368
    s_waitcnt lgkmcnt(6)
    v_mfma_f32_16x16x32_bf16 v[120:123], v[56:59], a[120:123], v[120:123]
    ds_read_b64_tr_b16 v[44:45], v221 offset:96
    v_mfma_f32_16x16x32_bf16 v[156:159], v[56:59], a[124:127], v[156:159]
    ds_read_b64_tr_b16 v[46:47], v221 offset:2400
    v_mfma_f32_16x16x32_bf16 v[124:127], v[60:63], a[120:123], v[124:127]
    ds_read_b64_tr_b16 v[48:49], v221 offset:128
    v_mfma_f32_16x16x32_bf16 v[160:163], v[60:63], a[124:127], v[160:163]
    ds_read_b64_tr_b16 v[50:51], v221 offset:2432
    v_mfma_f32_16x16x32_bf16 v[128:131], v[64:67], a[120:123], v[128:131]
    ds_read_b64_tr_b16 v[52:53], v221 offset:160
    v_mfma_f32_16x16x32_bf16 v[164:167], v[64:67], a[124:127], v[164:167]
    ds_read_b64_tr_b16 v[54:55], v221 offset:2464
    v_mov_b32 v220, v221
    s_mov_b32 s46, s62
    s_mov_b32 s62, s63
    s_mov_b32 s63, s64
    s_mov_b32 s64, s68
    s_mov_b32 s68, s46
    s_add_u32 s60, s60, 147456
    v_add_u32 v221, s63, v219
    s_waitcnt lgkmcnt(6)
    v_mfma_f32_16x16x32_bf16 v[96:99], v[32:35], a[128:131], v[96:99]
    ds_read_b64_tr_b16 v[56:57], v220 offset:192
    v_mfma_f32_16x16x32_bf16 v[132:135], v[32:35], a[132:135], v[132:135]
    ds_read_b64_tr_b16 v[58:59], v220 offset:2496
    v_mfma_f32_16x16x32_bf16 v[100:103], v[36:39], a[128:131], v[100:103]
    s_mul_i32 s48, s42, 9216
    s_add_u32 s48, s48, s64
    s_add_u32 m0, s48, 0
    ds_read_b64_tr_b16 v[60:61], v220 offset:224
    v_mfma_f32_16x16x32_bf16 v[136:139], v[36:39], a[132:135], v[136:139]
    ds_read_b64_tr_b16 v[62:63], v220 offset:2528
    buffer_load_dwordx4 v192, s[28:31], s60 offen lds
    v_mfma_f32_16x16x32_bf16 v[104:107], v[40:43], a[128:131], v[104:107]
    ds_read_b64_tr_b16 v[64:65], v220 offset:256
    v_mfma_f32_16x16x32_bf16 v[140:143], v[40:43], a[132:135], v[140:143]
    ds_read_b64_tr_b16 v[66:67], v220 offset:2560
    s_waitcnt lgkmcnt(6)
    v_mfma_f32_16x16x32_bf16 v[108:111], v[44:47], a[128:131], v[108:111]
    ds_read_b64_tr_b16 v[32:33], v220 offset:9216
    v_mfma_f32_16x16x32_bf16 v[144:147], v[44:47], a[132:135], v[144:147]
    ds_read_b64_tr_b16 v[34:35], v220 offset:11520
    v_mfma_f32_16x16x32_bf16 v[112:115], v[48:51], a[128:131], v[112:115]
    s_add_u32 m0, s48, 1024
    ds_read_b64_tr_b16 v[36:37], v220 offset:9248
    v_mfma_f32_16x16x32_bf16 v[148:151], v[48:51], a[132:135], v[148:151]
    ds_read_b64_tr_b16 v[38:39], v220 offset:11552
    buffer_load_dwordx4 v193, s[28:31], s60 offen lds
    v_mfma_f32_16x16x32_bf16 v[116:119], v[52:55], a[128:131], v[116:119]
    ds_read_b64_tr_b16 v[40:41], v220 offset:9280
    v_mfma_f32_16x16x32_bf16 v[152:155], v[52:55], a[132:135], v[152:155]
    ds_read_b64_tr_b16 v[42:43], v220 offset:11584
    s_waitcnt lgkmcnt(6)
    v_mfma_f32_16x16x32_bf16 v[120:123], v[56:59], a[128:131], v[120:123]
    ds_read_b64_tr_b16 v[44:45], v220 offset:9312
    v_mfma_f32_16x16x32_bf16 v[156:159], v[56:59], a[132:135], v[156:159]
    ds_read_b64_tr_b16 v[46:47], v220 offset:11616
    v_mfma_f32_16x16x32_bf16 v[124:127], v[60:63], a[128:131], v[124:127]
    s_add_u32 m0, s48, 2048
    ds_read_b64_tr_b16 v[48:49], v220 offset:9344
    v_mfma_f32_16x16x32_bf16 v[160:163], v[60:63], a[132:135], v[160:163]
    ds_read_b64_tr_b16 v[50:51], v220 offset:11648
    buffer_load_dwordx4 v194, s[28:31], s60 offen lds
    v_mfma_f32_16x16x32_bf16 v[128:131], v[64:67], a[128:131], v[128:131]
    ds_read_b64_tr_b16 v[52:53], v220 offset:9376
    v_mfma_f32_16x16x32_bf16 v[164:167], v[64:67], a[132:135], v[164:167]
    ds_read_b64_tr_b16 v[54:55], v220 offset:11680
    s_waitcnt lgkmcnt(6)
    v_mfma_f32_16x16x32_bf16 v[96:99], v[32:35], a[136:139], v[96:99]
    ds_read_b64_tr_b16 v[56:57], v220 offset:9408
    v_mfma_f32_16x16x32_bf16 v[132:135], v[32:35], a[140:143], v[132:135]
    ds_read_b64_tr_b16 v[58:59], v220 offset:11712
    v_mfma_f32_16x16x32_bf16 v[100:103], v[36:39], a[136:139], v[100:103]
    s_add_u32 m0, s48, 3072
    ds_read_b64_tr_b16 v[60:61], v220 offset:9440
    v_mfma_f32_16x16x32_bf16 v[136:139], v[36:39], a[140:143], v[136:139]
    ds_read_b64_tr_b16 v[62:63], v220 offset:11744
    buffer_load_dwordx4 v195, s[28:31], s60 offen lds
    v_mfma_f32_16x16x32_bf16 v[104:107], v[40:43], a[136:139], v[104:107]
    ds_read_b64_tr_b16 v[64:65], v220 offset:9472
    v_mfma_f32_16x16x32_bf16 v[140:143], v[40:43], a[140:143], v[140:143]
    ds_read_b64_tr_b16 v[66:67], v220 offset:11776
    s_waitcnt lgkmcnt(6)
    v_mfma_f32_16x16x32_bf16 v[108:111], v[44:47], a[136:139], v[108:111]
    ds_read_b64_tr_b16 v[32:33], v220 offset:18432
    v_mfma_f32_16x16x32_bf16 v[144:147], v[44:47], a[140:143], v[144:147]
    ds_read_b64_tr_b16 v[34:35], v220 offset:20736
    v_mfma_f32_16x16x32_bf16 v[112:115], v[48:51], a[136:139], v[112:115]
    s_add_u32 m0, s48, 4096
    ds_read_b64_tr_b16 v[36:37], v220 offset:18464
    v_mfma_f32_16x16x32_bf16 v[148:151], v[48:51], a[140:143], v[148:151]
    ds_read_b64_tr_b16 v[38:39], v220 offset:20768
    buffer_load_dwordx4 v196, s[28:31], s60 offen lds
    v_mfma_f32_16x16x32_bf16 v[116:119], v[52:55], a[136:139], v[116:119]
    ds_read_b64_tr_b16 v[40:41], v220 offset:18496
    v_mfma_f32_16x16x32_bf16 v[152:155], v[52:55], a[140:143], v[152:155]
    ds_read_b64_tr_b16 v[42:43], v220 offset:20800
    s_waitcnt lgkmcnt(6)
    v_mfma_f32_16x16x32_bf16 v[120:123], v[56:59], a[136:139], v[120:123]
    ds_read_b64_tr_b16 v[44:45], v220 offset:18528
    v_mfma_f32_16x16x32_bf16 v[156:159], v[56:59], a[140:143], v[156:159]
    ds_read_b64_tr_b16 v[46:47], v220 offset:20832
    v_mfma_f32_16x16x32_bf16 v[124:127], v[60:63], a[136:139], v[124:127]
    s_add_u32 m0, s48, 5120
    ds_read_b64_tr_b16 v[48:49], v220 offset:18560
    v_mfma_f32_16x16x32_bf16 v[160:163], v[60:63], a[140:143], v[160:163]
    ds_read_b64_tr_b16 v[50:51], v220 offset:20864
    buffer_load_dwordx4 v197, s[28:31], s60 offen lds
    v_mfma_f32_16x16x32_bf16 v[128:131], v[64:67], a[136:139], v[128:131]
    ds_read_b64_tr_b16 v[52:53], v220 offset:18592
    v_mfma_f32_16x16x32_bf16 v[164:167], v[64:67], a[140:143], v[164:167]
    ds_read_b64_tr_b16 v[54:55], v220 offset:20896
    s_waitcnt lgkmcnt(6)
    v_mfma_f32_16x16x32_bf16 v[96:99], v[32:35], a[144:147], v[96:99]
    ds_read_b64_tr_b16 v[56:57], v220 offset:18624
    v_mfma_f32_16x16x32_bf16 v[132:135], v[32:35], a[148:151], v[132:135]
    ds_read_b64_tr_b16 v[58:59], v220 offset:20928
    v_mfma_f32_16x16x32_bf16 v[100:103], v[36:39], a[144:147], v[100:103]
    s_add_u32 m0, s48, 6144
    ds_read_b64_tr_b16 v[60:61], v220 offset:18656
    v_mfma_f32_16x16x32_bf16 v[136:139], v[36:39], a[148:151], v[136:139]
    ds_read_b64_tr_b16 v[62:63], v220 offset:20960
    buffer_load_dwordx4 v198, s[28:31], s60 offen lds
    v_mfma_f32_16x16x32_bf16 v[104:107], v[40:43], a[144:147], v[104:107]
    ds_read_b64_tr_b16 v[64:65], v220 offset:18688
    v_mfma_f32_16x16x32_bf16 v[140:143], v[40:43], a[148:151], v[140:143]
    ds_read_b64_tr_b16 v[66:67], v220 offset:20992
    s_waitcnt lgkmcnt(6)
    v_mfma_f32_16x16x32_bf16 v[108:111], v[44:47], a[144:147], v[108:111]
    ds_read_b64_tr_b16 v[32:33], v220 offset:27648
    v_mfma_f32_16x16x32_bf16 v[144:147], v[44:47], a[148:151], v[144:147]
    ds_read_b64_tr_b16 v[34:35], v220 offset:29952
    v_mfma_f32_16x16x32_bf16 v[112:115], v[48:51], a[144:147], v[112:115]
    s_add_u32 m0, s48, 7168
    ds_read_b64_tr_b16 v[36:37], v220 offset:27680
    v_mfma_f32_16x16x32_bf16 v[148:151], v[48:51], a[148:151], v[148:151]
    ds_read_b64_tr_b16 v[38:39], v220 offset:29984
    buffer_load_dwordx4 v199, s[28:31], s60 offen lds
    v_mfma_f32_16x16x32_bf16 v[116:119], v[52:55], a[144:147], v[116:119]
    ds_read_b64_tr_b16 v[40:41], v220 offset:27712
    v_mfma_f32_16x16x32_bf16 v[152:155], v[52:55], a[148:151], v[152:155]
    ds_read_b64_tr_b16 v[42:43], v220 offset:30016
    s_waitcnt lgkmcnt(6)
    v_mfma_f32_16x16x32_bf16 v[120:123], v[56:59], a[144:147], v[120:123]
    ds_read_b64_tr_b16 v[44:45], v220 offset:27744
    v_mfma_f32_16x16x32_bf16 v[156:159], v[56:59], a[148:151], v[156:159]
    ds_read_b64_tr_b16 v[46:47], v220 offset:30048
    v_mfma_f32_16x16x32_bf16 v[124:127], v[60:63], a[144:147], v[124:127]
    s_add_u32 m0, s48, 8192
    ds_read_b64_tr_b16 v[48:49], v220 offset:27776
    v_mfma_f32_16x16x32_bf16 v[160:163], v[60:63], a[148:151], v[160:163]
    ds_read_b64_tr_b16 v[50:51], v220 offset:30080
    buffer_load_dwordx4 v200, s[28:31], s60 offen lds
    v_mfma_f32_16x16x32_bf16 v[128:131], v[64:67], a[144:147], v[128:131]
    ds_read_b64_tr_b16 v[52:53], v220 offset:27808
    v_mfma_f32_16x16x32_bf16 v[164:167], v[64:67], a[148:151], v[164:167]
    ds_read_b64_tr_b16 v[54:55], v220 offset:30112
    s_waitcnt lgkmcnt(6)
    v_mfma_f32_16x16x32_bf16 v[96:99], v[32:35], a[152:155], v[96:99]
    ds_read_b64_tr_b16 v[56:57], v220 offset:27840
    v_mfma_f32_16x16x32_bf16 v[132:135], v[32:35], a[156:159], v[132:135]
    ds_read_b64_tr_b16 v[58:59], v220 offset:30144
    v_mfma_f32_16x16x32_bf16 v[100:103], v[36:39], a[152:155], v[100:103]
    ds_read_b64_tr_b16 v[60:61], v220 offset:27872
    v_mfma_f32_16x16x32_bf16 v[136:139], v[36:39], a[156:159], v[136:139]
    ds_read_b64_tr_b16 v[62:63], v220 offset:30176
    v_mfma_f32_16x16x32_bf16 v[104:107], v[40:43], a[152:155], v[104:107]
    ds_read_b64_tr_b16 v[64:65], v220 offset:27904
    v_mfma_f32_16x16x32_bf16 v[140:143], v[40:43], a[156:159], v[140:143]
    ds_read_b64_tr_b16 v[66:67], v220 offset:30208
    s_waitcnt vmcnt(9)
    s_barrier
    s_waitcnt lgkmcnt(6)
    v_mfma_f32_16x16x32_bf16 v[108:111], v[44:47], a[152:155], v[108:111]
    ds_read_b64_tr_b16 v[32:33], v221 offset:0
    v_mfma_f32_16x16x32_bf16 v[144:147], v[44:47], a[156:159], v[144:147]
    ds_read_b64_tr_b16 v[34:35], v221 offset:2304
    v_mfma_f32_16x16x32_bf16 v[112:115], v[48:51], a[152:155], v[112:115]
    ds_read_b64_tr_b16 v[36:37], v221 offset:32
    v_mfma_f32_16x16x32_bf16 v[148:151], v[48:51], a[156:159], v[148:151]
    ds_read_b64_tr_b16 v[38:39], v221 offset:2336
    v_mfma_f32_16x16x32_bf16 v[116:119], v[52:55], a[152:155], v[116:119]
    ds_read_b64_tr_b16 v[40:41], v221 offset:64
    v_mfma_f32_16x16x32_bf16 v[152:155], v[52:55], a[156:159], v[152:155]
    ds_read_b64_tr_b16 v[42:43], v221 offset:2368
    s_waitcnt lgkmcnt(6)
    v_mfma_f32_16x16x32_bf16 v[120:123], v[56:59], a[152:155], v[120:123]
    ds_read_b64_tr_b16 v[44:45], v221 offset:96
    v_mfma_f32_16x16x32_bf16 v[156:159], v[56:59], a[156:159], v[156:159]
    ds_read_b64_tr_b16 v[46:47], v221 offset:2400
    v_mfma_f32_16x16x32_bf16 v[124:127], v[60:63], a[152:155], v[124:127]
    ds_read_b64_tr_b16 v[48:49], v221 offset:128
    v_mfma_f32_16x16x32_bf16 v[160:163], v[60:63], a[156:159], v[160:163]
    ds_read_b64_tr_b16 v[50:51], v221 offset:2432
    v_mfma_f32_16x16x32_bf16 v[128:131], v[64:67], a[152:155], v[128:131]
    ds_read_b64_tr_b16 v[52:53], v221 offset:160
    v_mfma_f32_16x16x32_bf16 v[164:167], v[64:67], a[156:159], v[164:167]
    ds_read_b64_tr_b16 v[54:55], v221 offset:2464
    v_mov_b32 v220, v221
    s_mov_b32 s46, s62
    s_mov_b32 s62, s63
    s_mov_b32 s63, s64
    s_mov_b32 s64, s68
    s_mov_b32 s68, s46
    s_add_u32 s60, s60, 147456
    v_add_u32 v221, s63, v219
    s_waitcnt lgkmcnt(6)
    v_mfma_f32_16x16x32_bf16 v[96:99], v[32:35], a[160:163], v[96:99]
    ds_read_b64_tr_b16 v[56:57], v220 offset:192
    v_mfma_f32_16x16x32_bf16 v[132:135], v[32:35], a[164:167], v[132:135]
    ds_read_b64_tr_b16 v[58:59], v220 offset:2496
    v_mfma_f32_16x16x32_bf16 v[100:103], v[36:39], a[160:163], v[100:103]
    s_mul_i32 s48, s42, 9216
    s_add_u32 s48, s48, s64
    s_add_u32 m0, s48, 0
    ds_read_b64_tr_b16 v[60:61], v220 offset:224
    v_mfma_f32_16x16x32_bf16 v[136:139], v[36:39], a[164:167], v[136:139]
    ds_read_b64_tr_b16 v[62:63], v220 offset:2528
    buffer_load_dwordx4 v192, s[28:31], s60 offen lds
    v_mfma_f32_16x16x32_bf16 v[104:107], v[40:43], a[160:163], v[104:107]
    ds_read_b64_tr_b16 v[64:65], v220 offset:256
    v_mfma_f32_16x16x32_bf16 v[140:143], v[40:43], a[164:167], v[140:143]
    ds_read_b64_tr_b16 v[66:67], v220 offset:2560
    s_waitcnt lgkmcnt(6)
    v_mfma_f32_16x16x32_bf16 v[108:111], v[44:47], a[160:163], v[108:111]
    ds_read_b64_tr_b16 v[32:33], v220 offset:9216
    v_mfma_f32_16x16x32_bf16 v[144:147], v[44:47], a[164:167], v[144:147]
    ds_read_b64_tr_b16 v[34:35], v220 offset:11520
    v_mfma_f32_16x16x32_bf16 v[112:115], v[48:51], a[160:163], v[112:115]
    s_add_u32 m0, s48, 1024
    ds_read_b64_tr_b16 v[36:37], v220 offset:9248
    v_mfma_f32_16x16x32_bf16 v[148:151], v[48:51], a[164:167], v[148:151]
    ds_read_b64_tr_b16 v[38:39], v220 offset:11552
    buffer_load_dwordx4 v193, s[28:31], s60 offen lds
    v_mfma_f32_16x16x32_bf16 v[116:119], v[52:55], a[160:163], v[116:119]
    ds_read_b64_tr_b16 v[40:41], v220 offset:9280
    v_mfma_f32_16x16x32_bf16 v[152:155], v[52:55], a[164:167], v[152:155]
    ds_read_b64_tr_b16 v[42:43], v220 offset:11584
    s_waitcnt lgkmcnt(6)
    v_mfma_f32_16x16x32_bf16 v[120:123], v[56:59], a[160:163], v[120:123]
    ds_read_b64_tr_b16 v[44:45], v220 offset:9312
    v_mfma_f32_16x16x32_bf16 v[156:159], v[56:59], a[164:167], v[156:159]
    ds_read_b64_tr_b16 v[46:47], v220 offset:11616
    v_mfma_f32_16x16x32_bf16 v[124:127], v[60:63], a[160:163], v[124:127]
    s_add_u32 m0, s48, 2048
    ds_read_b64_tr_b16 v[48:49], v220 offset:9344
    v_mfma_f32_16x16x32_bf16 v[160:163], v[60:63], a[164:167], v[160:163]
    ds_read_b64_tr_b16 v[50:51], v220 offset:11648
    buffer_load_dwordx4 v194, s[28:31], s60 offen lds
    v_mfma_f32_16x16x32_bf16 v[128:131], v[64:67], a[160:163], v[128:131]
    ds_read_b64_tr_b16 v[52:53], v220 offset:9376
    v_mfma_f32_16x16x32_bf16 v[164:167], v[64:67], a[164:167], v[164:167]
    ds_read_b64_tr_b16 v[54:55], v220 offset:11680
    s_waitcnt lgkmcnt(6)
    v_mfma_f32_16x16x32_bf16 v[96:99], v[32:35], a[168:171], v[96:99]
    ds_read_b64_tr_b16 v[56:57], v220 offset:9408
    v_mfma_f32_16x16x32_bf16 v[132:135], v[32:35], a[172:175], v[132:135]
    ds_read_b64_tr_b16 v[58:59], v220 offset:11712
    v_mfma_f32_16x16x32_bf16 v[100:103], v[36:39], a[168:171], v[100:103]
    s_add_u32 m0, s48, 3072
    ds_read_b64_tr_b16 v[60:61], v220 offset:9440
    v_mfma_f32_16x16x32_bf16 v[136:139], v[36:39], a[172:175], v[136:139]
    ds_read_b64_tr_b16 v[62:63], v220 offset:11744
    buffer_load_dwordx4 v195, s[28:31], s60 offen lds
    v_mfma_f32_16x16x32_bf16 v[104:107], v[40:43], a[168:171], v[104:107]
    ds_read_b64_tr_b16 v[64:65], v220 offset:9472
    v_mfma_f32_16x16x32_bf16 v[140:143], v[40:43], a[172:175], v[140:143]
    ds_read_b64_tr_b16 v[66:67], v220 offset:11776
    s_waitcnt lgkmcnt(6)
    v_mfma_f32_16x16x32_bf16 v[108:111], v[44:47], a[168:171], v[108:111]
    ds_read_b64_tr_b16 v[32:33], v220 offset:18432
    v_mfma_f32_16x16x32_bf16 v[144:147], v[44:47], a[172:175], v[144:147]
    ds_read_b64_tr_b16 v[34:35], v220 offset:20736
    v_mfma_f32_16x16x32_bf16 v[112:115], v[48:51], a[168:171], v[112:115]
    s_add_u32 m0, s48, 4096
    ds_read_b64_tr_b16 v[36:37], v220 offset:18464
    v_mfma_f32_16x16x32_bf16 v[148:151], v[48:51], a[172:175], v[148:151]
    ds_read_b64_tr_b16 v[38:39], v220 offset:20768
    buffer_load_dwordx4 v196, s[28:31], s60 offen lds
    v_mfma_f32_16x16x32_bf16 v[116:119], v[52:55], a[168:171], v[116:119]
    ds_read_b64_tr_b16 v[40:41], v220 offset:18496
    v_mfma_f32_16x16x32_bf16 v[152:155], v[52:55], a[172:175], v[152:155]
    ds_read_b64_tr_b16 v[42:43], v220 offset:20800
    s_waitcnt lgkmcnt(6)
    v_mfma_f32_16x16x32_bf16 v[120:123], v[56:59], a[168:171], v[120:123]
    ds_read_b64_tr_b16 v[44:45], v220 offset:18528
    v_mfma_f32_16x16x32_bf16 v[156:159], v[56:59], a[172:175], v[156:159]
    ds_read_b64_tr_b16 v[46:47], v220 offset:20832
    v_mfma_f32_16x16x32_bf16 v[124:127], v[60:63], a[168:171], v[124:127]
    s_add_u32 m0, s48, 5120
    ds_read_b64_tr_b16 v[48:49], v220 offset:18560
    v_mfma_f32_16x16x32_bf16 v[160:163], v[60:63], a[172:175], v[160:163]
    ds_read_b64_tr_b16 v[50:51], v220 offset:20864
    buffer_load_dwordx4 v197, s[28:31], s60 offen lds
    v_mfma_f32_16x16x32_bf16 v[128:131], v[64:67], a[168:171], v[128:131]
    ds_read_b64_tr_b16 v[52:53], v220 offset:18592
    v_mfma_f32_16x16x32_bf16 v[164:167], v[64:67], a[172:175], v[164:167]
    ds_read_b64_tr_b16 v[54:55], v220 offset:20896
    s_waitcnt lgkmcnt(6)
    v_mfma_f32_16x16x32_bf16 v[96:99], v[32:35], a[176:179], v[96:99]
    ds_read_b64_tr_b16 v[56:57], v220 offset:18624
    v_mfma_f32_16x16x32_bf16 v[132:135], v[32:35], a[180:183], v[132:135]
    ds_read_b64_tr_b16 v[58:59], v220 offset:20928
    v_mfma_f32_16x16x32_bf16 v[100:103], v[36:39], a[176:179], v[100:103]
    s_add_u32 m0, s48, 6144
    ds_read_b64_tr_b16 v[60:61], v220 offset:18656
    v_mfma_f32_16x16x32_bf16 v[136:139], v[36:39], a[180:183], v[136:139]
    ds_read_b64_tr_b16 v[62:63], v220 offset:20960
    buffer_load_dwordx4 v198, s[28:31], s60 offen lds
    v_mfma_f32_16x16x32_bf16 v[104:107], v[40:43], a[176:179], v[104:107]
    ds_read_b64_tr_b16 v[64:65], v220 offset:18688
    v_mfma_f32_16x16x32_bf16 v[140:143], v[40:43], a[180:183], v[140:143]
    ds_read_b64_tr_b16 v[66:67], v220 offset:20992
    s_waitcnt lgkmcnt(6)
    v_mfma_f32_16x16x32_bf16 v[108:111], v[44:47], a[176:179], v[108:111]
    ds_read_b64_tr_b16 v[32:33], v220 offset:27648
    v_mfma_f32_16x16x32_bf16 v[144:147], v[44:47], a[180:183], v[144:147]
    ds_read_b64_tr_b16 v[34:35], v220 offset:29952
    v_mfma_f32_16x16x32_bf16 v[112:115], v[48:51], a[176:179], v[112:115]
    s_add_u32 m0, s48, 7168
    ds_read_b64_tr_b16 v[36:37], v220 offset:27680
    v_mfma_f32_16x16x32_bf16 v[148:151], v[48:51], a[180:183], v[148:151]
    ds_read_b64_tr_b16 v[38:39], v220 offset:29984
    buffer_load_dwordx4 v199, s[28:31], s60 offen lds
    v_mfma_f32_16x16x32_bf16 v[116:119], v[52:55], a[176:179], v[116:119]
    ds_read_b64_tr_b16 v[40:41], v220 offset:27712
    v_mfma_f32_16x16x32_bf16 v[152:155], v[52:55], a[180:183], v[152:155]
    ds_read_b64_tr_b16 v[42:43], v220 offset:30016
    s_waitcnt lgkmcnt(6)
    v_mfma_f32_16x16x32_bf16 v[120:123], v[56:59], a[176:179], v[120:123]
    ds_read_b64_tr_b16 v[44:45], v220 offset:27744
    v_mfma_f32_16x16x32_bf16 v[156:159], v[56:59], a[180:183], v[156:159]
    ds_read_b64_tr_b16 v[46:47], v220 offset:30048
    v_mfma_f32_16x16x32_bf16 v[124:127], v[60:63], a[176:179], v[124:127]
    s_add_u32 m0, s48, 8192
    ds_read_b64_tr_b16 v[48:49], v220 offset:27776
    v_mfma_f32_16x16x32_bf16 v[160:163], v[60:63], a[180:183], v[160:163]
    ds_read_b64_tr_b16 v[50:51], v220 offset:30080
    buffer_load_dwordx4 v200, s[28:31], s60 offen lds
    v_mfma_f32_16x16x32_bf16 v[128:131], v[64:67], a[176:179], v[128:131]
    ds_read_b64_tr_b16 v[52:53], v220 offset:27808
    v_mfma_f32_16x16x32_bf16 v[164:167], v[64:67], a[180:183], v[164:167]
    ds_read_b64_tr_b16 v[54:55], v220 offset:30112
    s_waitcnt lgkmcnt(6)
    v_mfma_f32_16x16x32_bf16 v[96:99], v[32:35], a[184:187], v[96:99]
    ds_read_b64_tr_b16 v[56:57], v220 offset:27840
    v_mfma_f32_16x16x32_bf16 v[132:135], v[32:35], a[188:191], v[132:135]
    ds_read_b64_tr_b16 v[58:59], v220 offset:30144
    v_mfma_f32_16x16x32_bf16 v[100:103], v[36:39], a[184:187], v[100:103]
    ds_read_b64_tr_b16 v[60:61], v220 offset:27872
    v_mfma_f32_16x16x32_bf16 v[136:139], v[36:39], a[188:191], v[136:139]
    ds_read_b64_tr_b16 v[62:63], v220 offset:30176
    v_mfma_f32_16x16x32_bf16 v[104:107], v[40:43], a[184:187], v[104:107]
    ds_read_b64_tr_b16 v[64:65], v220 offset:27904
    v_mfma_f32_16x16x32_bf16 v[140:143], v[40:43], a[188:191], v[140:143]
    ds_read_b64_tr_b16 v[66:67], v220 offset:30208
    s_waitcnt vmcnt(9)
    s_barrier
    s_waitcnt lgkmcnt(6)
    v_mfma_f32_16x16x32_bf16 v[108:111], v[44:47], a[184:187], v[108:111]
    ds_read_b64_tr_b16 v[32:33], v221 offset:0
    v_mfma_f32_16x16x32_bf16 v[144:147], v[44:47], a[188:191], v[144:147]
    ds_read_b64_tr_b16 v[34:35], v221 offset:2304
    v_mfma_f32_16x16x32_bf16 v[112:115], v[48:51], a[184:187], v[112:115]
    ds_read_b64_tr_b16 v[36:37], v221 offset:32
    v_mfma_f32_16x16x32_bf16 v[148:151], v[48:51], a[188:191], v[148:151]
    ds_read_b64_tr_b16 v[38:39], v221 offset:2336
    v_mfma_f32_16x16x32_bf16 v[116:119], v[52:55], a[184:187], v[116:119]
    ds_read_b64_tr_b16 v[40:41], v221 offset:64
    v_mfma_f32_16x16x32_bf16 v[152:155], v[52:55], a[188:191], v[152:155]
    ds_read_b64_tr_b16 v[42:43], v221 offset:2368
    s_waitcnt lgkmcnt(6)
    v_mfma_f32_16x16x32_bf16 v[120:123], v[56:59], a[184:187], v[120:123]
    ds_read_b64_tr_b16 v[44:45], v221 offset:96
    v_mfma_f32_16x16x32_bf16 v[156:159], v[56:59], a[188:191], v[156:159]
    ds_read_b64_tr_b16 v[46:47], v221 offset:2400
    v_mfma_f32_16x16x32_bf16 v[124:127], v[60:63], a[184:187], v[124:127]
    ds_read_b64_tr_b16 v[48:49], v221 offset:128
    v_mfma_f32_16x16x32_bf16 v[160:163], v[60:63], a[188:191], v[160:163]
    ds_read_b64_tr_b16 v[50:51], v221 offset:2432
    v_mfma_f32_16x16x32_bf16 v[128:131], v[64:67], a[184:187], v[128:131]
    ds_read_b64_tr_b16 v[52:53], v221 offset:160
    v_mfma_f32_16x16x32_bf16 v[164:167], v[64:67], a[188:191], v[164:167]
    ds_read_b64_tr_b16 v[54:55], v221 offset:2464
    v_mov_b32 v220, v221
    s_mov_b32 s46, s62
    s_mov_b32 s62, s63
    s_mov_b32 s63, s64
    s_mov_b32 s64, s68
    s_mov_b32 s68, s46
    s_add_u32 s60, s60, 147456
    v_and_b32 v3, 7, v0
    v_lshlrev_b32 v3, 5, v3
    s_lshr_b32 s46, s2, 6
    s_lshl_b32 s46, s46, 3
    v_add_u32 v3, s46, v3
    s_and_b32 s46, s2, 7
    v_add_u32 v3, s46, v3
    v_lshlrev_b32 v10, 7, v3
    v_add_u32 v10, 24, v10
    s_mov_b64 exec, 255
    buffer_load_dwordx2 v[8:9], v10, s[24:27], 0 offen sc1
    s_mov_b64 exec, -1
    v_add_u32 v221, s63, v219
    s_waitcnt lgkmcnt(6)
    v_mfma_f32_16x16x32_bf16 v[96:99], v[32:35], a[192:195], v[96:99]
    ds_read_b64_tr_b16 v[56:57], v220 offset:192
    v_mfma_f32_16x16x32_bf16 v[132:135], v[32:35], a[196:199], v[132:135]
    ds_read_b64_tr_b16 v[58:59], v220 offset:2496
    v_mfma_f32_16x16x32_bf16 v[100:103], v[36:39], a[192:195], v[100:103]
    s_mul_i32 s48, s42, 9216
    s_add_u32 s48, s48, s64
    s_add_u32 m0, s48, 0
    ds_read_b64_tr_b16 v[60:61], v220 offset:224
    v_mfma_f32_16x16x32_bf16 v[136:139], v[36:39], a[196:199], v[136:139]
    ds_read_b64_tr_b16 v[62:63], v220 offset:2528
    buffer_load_dwordx4 v192, s[28:31], s60 offen lds
    v_mfma_f32_16x16x32_bf16 v[104:107], v[40:43], a[192:195], v[104:107]
    ds_read_b64_tr_b16 v[64:65], v220 offset:256
    v_mfma_f32_16x16x32_bf16 v[140:143], v[40:43], a[196:199], v[140:143]
    ds_read_b64_tr_b16 v[66:67], v220 offset:2560
    s_waitcnt lgkmcnt(6)
    v_mfma_f32_16x16x32_bf16 v[108:111], v[44:47], a[192:195], v[108:111]
    ds_read_b64_tr_b16 v[32:33], v220 offset:9216
    v_mfma_f32_16x16x32_bf16 v[144:147], v[44:47], a[196:199], v[144:147]
    ds_read_b64_tr_b16 v[34:35], v220 offset:11520
    v_mfma_f32_16x16x32_bf16 v[112:115], v[48:51], a[192:195], v[112:115]
    s_add_u32 m0, s48, 1024
    ds_read_b64_tr_b16 v[36:37], v220 offset:9248
    v_mfma_f32_16x16x32_bf16 v[148:151], v[48:51], a[196:199], v[148:151]
    ds_read_b64_tr_b16 v[38:39], v220 offset:11552
    buffer_load_dwordx4 v193, s[28:31], s60 offen lds
    v_mfma_f32_16x16x32_bf16 v[116:119], v[52:55], a[192:195], v[116:119]
    ds_read_b64_tr_b16 v[40:41], v220 offset:9280
    v_mfma_f32_16x16x32_bf16 v[152:155], v[52:55], a[196:199], v[152:155]
    ds_read_b64_tr_b16 v[42:43], v220 offset:11584
    s_waitcnt lgkmcnt(6)
    v_mfma_f32_16x16x32_bf16 v[120:123], v[56:59], a[192:195], v[120:123]
    ds_read_b64_tr_b16 v[44:45], v220 offset:9312
    v_mfma_f32_16x16x32_bf16 v[156:159], v[56:59], a[196:199], v[156:159]
    ds_read_b64_tr_b16 v[46:47], v220 offset:11616
    v_mfma_f32_16x16x32_bf16 v[124:127], v[60:63], a[192:195], v[124:127]
    s_add_u32 m0, s48, 2048
    ds_read_b64_tr_b16 v[48:49], v220 offset:9344
    v_mfma_f32_16x16x32_bf16 v[160:163], v[60:63], a[196:199], v[160:163]
    ds_read_b64_tr_b16 v[50:51], v220 offset:11648
    buffer_load_dwordx4 v194, s[28:31], s60 offen lds
    v_mfma_f32_16x16x32_bf16 v[128:131], v[64:67], a[192:195], v[128:131]
    ds_read_b64_tr_b16 v[52:53], v220 offset:9376
    v_mfma_f32_16x16x32_bf16 v[164:167], v[64:67], a[196:199], v[164:167]
    ds_read_b64_tr_b16 v[54:55], v220 offset:11680
    s_waitcnt lgkmcnt(6)
    v_mfma_f32_16x16x32_bf16 v[96:99], v[32:35], a[200:203], v[96:99]
    ds_read_b64_tr_b16 v[56:57], v220 offset:9408
    v_mfma_f32_16x16x32_bf16 v[132:135], v[32:35], a[204:207], v[132:135]
    ds_read_b64_tr_b16 v[58:59], v220 offset:11712
    v_mfma_f32_16x16x32_bf16 v[100:103], v[36:39], a[200:203], v[100:103]
    s_add_u32 m0, s48, 3072
    ds_read_b64_tr_b16 v[60:61], v220 offset:9440
    v_mfma_f32_16x16x32_bf16 v[136:139], v[36:39], a[204:207], v[136:139]
    ds_read_b64_tr_b16 v[62:63], v220 offset:11744
    buffer_load_dwordx4 v195, s[28:31], s60 offen lds
    v_mfma_f32_16x16x32_bf16 v[104:107], v[40:43], a[200:203], v[104:107]
    ds_read_b64_tr_b16 v[64:65], v220 offset:9472
    v_mfma_f32_16x16x32_bf16 v[140:143], v[40:43], a[204:207], v[140:143]
    ds_read_b64_tr_b16 v[66:67], v220 offset:11776
    s_waitcnt lgkmcnt(6)
    v_mfma_f32_16x16x32_bf16 v[108:111], v[44:47], a[200:203], v[108:111]
    ds_read_b64_tr_b16 v[32:33], v220 offset:18432
    v_mfma_f32_16x16x32_bf16 v[144:147], v[44:47], a[204:207], v[144:147]
    ds_read_b64_tr_b16 v[34:35], v220 offset:20736
    v_mfma_f32_16x16x32_bf16 v[112:115], v[48:51], a[200:203], v[112:115]
    s_add_u32 m0, s48, 4096
    ds_read_b64_tr_b16 v[36:37], v220 offset:18464
    v_mfma_f32_16x16x32_bf16 v[148:151], v[48:51], a[204:207], v[148:151]
    ds_read_b64_tr_b16 v[38:39], v220 offset:20768
    buffer_load_dwordx4 v196, s[28:31], s60 offen lds
    v_mfma_f32_16x16x32_bf16 v[116:119], v[52:55], a[200:203], v[116:119]
    ds_read_b64_tr_b16 v[40:41], v220 offset:18496
    v_mfma_f32_16x16x32_bf16 v[152:155], v[52:55], a[204:207], v[152:155]
    ds_read_b64_tr_b16 v[42:43], v220 offset:20800
    s_waitcnt lgkmcnt(6)
    v_mfma_f32_16x16x32_bf16 v[120:123], v[56:59], a[200:203], v[120:123]
    ds_read_b64_tr_b16 v[44:45], v220 offset:18528
    v_mfma_f32_16x16x32_bf16 v[156:159], v[56:59], a[204:207], v[156:159]
    ds_read_b64_tr_b16 v[46:47], v220 offset:20832
    v_mfma_f32_16x16x32_bf16 v[124:127], v[60:63], a[200:203], v[124:127]
    s_add_u32 m0, s48, 5120
    ds_read_b64_tr_b16 v[48:49], v220 offset:18560
    v_mfma_f32_16x16x32_bf16 v[160:163], v[60:63], a[204:207], v[160:163]
    ds_read_b64_tr_b16 v[50:51], v220 offset:20864
    buffer_load_dwordx4 v197, s[28:31], s60 offen lds
    v_mfma_f32_16x16x32_bf16 v[128:131], v[64:67], a[200:203], v[128:131]
    ds_read_b64_tr_b16 v[52:53], v220 offset:18592
    v_mfma_f32_16x16x32_bf16 v[164:167], v[64:67], a[204:207], v[164:167]
    ds_read_b64_tr_b16 v[54:55], v220 offset:20896
    s_waitcnt lgkmcnt(6)
    v_mfma_f32_16x16x32_bf16 v[96:99], v[32:35], a[208:211], v[96:99]
    ds_read_b64_tr_b16 v[56:57], v220 offset:18624
    v_mfma_f32_16x16x32_bf16 v[132:135], v[32:35], a[212:215], v[132:135]
    ds_read_b64_tr_b16 v[58:59], v220 offset:20928
    v_mfma_f32_16x16x32_bf16 v[100:103], v[36:39], a[208:211], v[100:103]
    s_add_u32 m0, s48, 6144
    ds_read_b64_tr_b16 v[60:61], v220 offset:18656
    v_mfma_f32_16x16x32_bf16 v[136:139], v[36:39], a[212:215], v[136:139]
    ds_read_b64_tr_b16 v[62:63], v220 offset:20960
    buffer_load_dwordx4 v198, s[28:31], s60 offen lds
    v_mfma_f32_16x16x32_bf16 v[104:107], v[40:43], a[208:211], v[104:107]
    ds_read_b64_tr_b16 v[64:65], v220 offset:18688
    v_mfma_f32_16x16x32_bf16 v[140:143], v[40:43], a[212:215], v[140:143]
    ds_read_b64_tr_b16 v[66:67], v220 offset:20992
    s_waitcnt lgkmcnt(6)
    v_mfma_f32_16x16x32_bf16 v[108:111], v[44:47], a[208:211], v[108:111]
    ds_read_b64_tr_b16 v[32:33], v220 offset:27648
    v_mfma_f32_16x16x32_bf16 v[144:147], v[44:47], a[212:215], v[144:147]
    ds_read_b64_tr_b16 v[34:35], v220 offset:29952
    v_mfma_f32_16x16x32_bf16 v[112:115], v[48:51], a[208:211], v[112:115]
    s_add_u32 m0, s48, 7168
    ds_read_b64_tr_b16 v[36:37], v220 offset:27680
    v_mfma_f32_16x16x32_bf16 v[148:151], v[48:51], a[212:215], v[148:151]
    ds_read_b64_tr_b16 v[38:39], v220 offset:29984
    buffer_load_dwordx4 v199, s[28:31], s60 offen lds
    v_mfma_f32_16x16x32_bf16 v[116:119], v[52:55], a[208:211], v[116:119]
    ds_read_b64_tr_b16 v[40:41], v220 offset:27712
    v_mfma_f32_16x16x32_bf16 v[152:155], v[52:55], a[212:215], v[152:155]
    ds_read_b64_tr_b16 v[42:43], v220 offset:30016
    s_waitcnt lgkmcnt(6)
    v_mfma_f32_16x16x32_bf16 v[120:123], v[56:59], a[208:211], v[120:123]
    ds_read_b64_tr_b16 v[44:45], v220 offset:27744
    v_mfma_f32_16x16x32_bf16 v[156:159], v[56:59], a[212:215], v[156:159]
    ds_read_b64_tr_b16 v[46:47], v220 offset:30048
    v_mfma_f32_16x16x32_bf16 v[124:127], v[60:63], a[208:211], v[124:127]
    s_add_u32 m0, s48, 8192
    ds_read_b64_tr_b16 v[48:49], v220 offset:27776
    v_mfma_f32_16x16x32_bf16 v[160:163], v[60:63], a[212:215], v[160:163]
    ds_read_b64_tr_b16 v[50:51], v220 offset:30080
    buffer_load_dwordx4 v200, s[28:31], s60 offen lds
    v_mfma_f32_16x16x32_bf16 v[128:131], v[64:67], a[208:211], v[128:131]
    ds_read_b64_tr_b16 v[52:53], v220 offset:27808
    v_mfma_f32_16x16x32_bf16 v[164:167], v[64:67], a[212:215], v[164:167]
    ds_read_b64_tr_b16 v[54:55], v220 offset:30112
    s_waitcnt lgkmcnt(6)
    v_mfma_f32_16x16x32_bf16 v[96:99], v[32:35], a[216:219], v[96:99]
    ds_read_b64_tr_b16 v[56:57], v220 offset:27840
    v_mfma_f32_16x16x32_bf16 v[132:135], v[32:35], a[220:223], v[132:135]
    ds_read_b64_tr_b16 v[58:59], v220 offset:30144
    v_mfma_f32_16x16x32_bf16 v[100:103], v[36:39], a[216:219], v[100:103]
    ds_read_b64_tr_b16 v[60:61], v220 offset:27872
    v_mfma_f32_16x16x32_bf16 v[136:139], v[36:39], a[220:223], v[136:139]
    ds_read_b64_tr_b16 v[62:63], v220 offset:30176
    v_mfma_f32_16x16x32_bf16 v[104:107], v[40:43], a[216:219], v[104:107]
    ds_read_b64_tr_b16 v[64:65], v220 offset:27904
    v_mfma_f32_16x16x32_bf16 v[140:143], v[40:43], a[220:223], v[140:143]
    ds_read_b64_tr_b16 v[66:67], v220 offset:30208
    s_waitcnt vmcnt(10)
    s_barrier
    s_waitcnt lgkmcnt(6)
    v_mfma_f32_16x16x32_bf16 v[108:111], v[44:47], a[216:219], v[108:111]
    ds_read_b64_tr_b16 v[32:33], v221 offset:0
    v_mfma_f32_16x16x32_bf16 v[144:147], v[44:47], a[220:223], v[144:147]
    ds_read_b64_tr_b16 v[34:35], v221 offset:2304
    v_mfma_f32_16x16x32_bf16 v[112:115], v[48:51], a[216:219], v[112:115]
    ds_read_b64_tr_b16 v[36:37], v221 offset:32
    v_mfma_f32_16x16x32_bf16 v[148:151], v[48:51], a[220:223], v[148:151]
    ds_read_b64_tr_b16 v[38:39], v221 offset:2336
    v_mfma_f32_16x16x32_bf16 v[116:119], v[52:55], a[216:219], v[116:119]
    ds_read_b64_tr_b16 v[40:41], v221 offset:64
    v_mfma_f32_16x16x32_bf16 v[152:155], v[52:55], a[220:223], v[152:155]
    ds_read_b64_tr_b16 v[42:43], v221 offset:2368
    s_waitcnt lgkmcnt(6)
    v_mfma_f32_16x16x32_bf16 v[120:123], v[56:59], a[216:219], v[120:123]
    ds_read_b64_tr_b16 v[44:45], v221 offset:96
    v_mfma_f32_16x16x32_bf16 v[156:159], v[56:59], a[220:223], v[156:159]
    ds_read_b64_tr_b16 v[46:47], v221 offset:2400
    v_mfma_f32_16x16x32_bf16 v[124:127], v[60:63], a[216:219], v[124:127]
    ds_read_b64_tr_b16 v[48:49], v221 offset:128
    v_mfma_f32_16x16x32_bf16 v[160:163], v[60:63], a[220:223], v[160:163]
    ds_read_b64_tr_b16 v[50:51], v221 offset:2432
    v_mfma_f32_16x16x32_bf16 v[128:131], v[64:67], a[216:219], v[128:131]
    ds_read_b64_tr_b16 v[52:53], v221 offset:160
    v_mfma_f32_16x16x32_bf16 v[164:167], v[64:67], a[220:223], v[164:167]
    ds_read_b64_tr_b16 v[54:55], v221 offset:2464
    v_mov_b32 v220, v221
    s_mov_b32 s46, s62
    s_mov_b32 s62, s63
    s_mov_b32 s63, s64
    s_mov_b32 s64, s68
    s_mov_b32 s68, s46
    s_add_u32 s60, s60, 147456
    s_lshl_b32 s60, s55, 3
    s_lshl_b32 s46, s42, 1
    s_add_u32 s60, s60, s46
    s_mul_i32 s60, s60, 20736
    v_add_u32 v221, s63, v219
    s_waitcnt lgkmcnt(6)
    v_mfma_f32_16x16x32_bf16 v[96:99], v[32:35], a[224:227], v[96:99]
    ds_read_b64_tr_b16 v[56:57], v220 offset:192
    v_mfma_f32_16x16x32_bf16 v[132:135], v[32:35], a[228:231], v[132:135]
    ds_read_b64_tr_b16 v[58:59], v220 offset:2496
    v_mfma_f32_16x16x32_bf16 v[100:103], v[36:39], a[224:227], v[100:103]
    s_mul_i32 s48, s42, 9216
    s_add_u32 s48, s48, s64
    s_add_u32 s61, s60, 2304
    s_add_u32 m0, s48, 0
    ds_read_b64_tr_b16 v[60:61], v220 offset:224
    v_mfma_f32_16x16x32_bf16 v[136:139], v[36:39], a[228:231], v[136:139]
    ds_read_b64_tr_b16 v[62:63], v220 offset:2528
    buffer_load_dwordx4 v192, s[32:35], s60 offen lds
    v_mfma_f32_16x16x32_bf16 v[104:107], v[40:43], a[224:227], v[104:107]
    ds_read_b64_tr_b16 v[64:65], v220 offset:256
    v_mfma_f32_16x16x32_bf16 v[140:143], v[40:43], a[228:231], v[140:143]
    ds_read_b64_tr_b16 v[66:67], v220 offset:2560
    s_waitcnt lgkmcnt(6)
    v_mfma_f32_16x16x32_bf16 v[108:111], v[44:47], a[224:227], v[108:111]
    ds_read_b64_tr_b16 v[32:33], v220 offset:9216
    v_mfma_f32_16x16x32_bf16 v[144:147], v[44:47], a[228:231], v[144:147]
    ds_read_b64_tr_b16 v[34:35], v220 offset:11520
    v_mfma_f32_16x16x32_bf16 v[112:115], v[48:51], a[224:227], v[112:115]
    s_add_u32 m0, s48, 1024
    ds_read_b64_tr_b16 v[36:37], v220 offset:9248
    v_mfma_f32_16x16x32_bf16 v[148:151], v[48:51], a[228:231], v[148:151]
    ds_read_b64_tr_b16 v[38:39], v220 offset:11552
    buffer_load_dwordx4 v193, s[32:35], s60 offen lds
    v_mfma_f32_16x16x32_bf16 v[116:119], v[52:55], a[224:227], v[116:119]
    ds_read_b64_tr_b16 v[40:41], v220 offset:9280
    v_mfma_f32_16x16x32_bf16 v[152:155], v[52:55], a[228:231], v[152:155]
    ds_read_b64_tr_b16 v[42:43], v220 offset:11584
    s_waitcnt lgkmcnt(6)
    v_mfma_f32_16x16x32_bf16 v[120:123], v[56:59], a[224:227], v[120:123]
    ds_read_b64_tr_b16 v[44:45], v220 offset:9312
    v_mfma_f32_16x16x32_bf16 v[156:159], v[56:59], a[228:231], v[156:159]
    ds_read_b64_tr_b16 v[46:47], v220 offset:11616
    v_mfma_f32_16x16x32_bf16 v[124:127], v[60:63], a[224:227], v[124:127]
    s_add_u32 m0, s48, 2048
    ds_read_b64_tr_b16 v[48:49], v220 offset:9344
    v_mfma_f32_16x16x32_bf16 v[160:163], v[60:63], a[228:231], v[160:163]
    ds_read_b64_tr_b16 v[50:51], v220 offset:11648
    buffer_load_dwordx4 v194, s[32:35], s60 offen lds
    v_mfma_f32_16x16x32_bf16 v[128:131], v[64:67], a[224:227], v[128:131]
    ds_read_b64_tr_b16 v[52:53], v220 offset:9376
    v_mfma_f32_16x16x32_bf16 v[164:167], v[64:67], a[228:231], v[164:167]
    ds_read_b64_tr_b16 v[54:55], v220 offset:11680
    s_waitcnt lgkmcnt(6)
    v_mfma_f32_16x16x32_bf16 v[96:99], v[32:35], a[232:235], v[96:99]
    ds_read_b64_tr_b16 v[56:57], v220 offset:9408
    v_mfma_f32_16x16x32_bf16 v[132:135], v[32:35], a[236:239], v[132:135]
    ds_read_b64_tr_b16 v[58:59], v220 offset:11712
    v_mfma_f32_16x16x32_bf16 v[100:103], v[36:39], a[232:235], v[100:103]
    s_add_u32 m0, s48, 3072
    ds_read_b64_tr_b16 v[60:61], v220 offset:9440
    v_mfma_f32_16x16x32_bf16 v[136:139], v[36:39], a[236:239], v[136:139]
    ds_read_b64_tr_b16 v[62:63], v220 offset:11744
    buffer_load_dwordx4 v195, s[32:35], s60 offen lds
    v_mfma_f32_16x16x32_bf16 v[104:107], v[40:43], a[232:235], v[104:107]
    ds_read_b64_tr_b16 v[64:65], v220 offset:9472
    v_mfma_f32_16x16x32_bf16 v[140:143], v[40:43], a[236:239], v[140:143]
    ds_read_b64_tr_b16 v[66:67], v220 offset:11776
    s_waitcnt lgkmcnt(6)
    v_mfma_f32_16x16x32_bf16 v[108:111], v[44:47], a[232:235], v[108:111]
    ds_read_b64_tr_b16 v[32:33], v220 offset:18432
    v_mfma_f32_16x16x32_bf16 v[144:147], v[44:47], a[236:239], v[144:147]
    ds_read_b64_tr_b16 v[34:35], v220 offset:20736
    v_mfma_f32_16x16x32_bf16 v[112:115], v[48:51], a[232:235], v[112:115]
    s_add_u32 m0, s48, 4096
    ds_read_b64_tr_b16 v[36:37], v220 offset:18464
    v_mfma_f32_16x16x32_bf16 v[148:151], v[48:51], a[236:239], v[148:151]
    ds_read_b64_tr_b16 v[38:39], v220 offset:20768
    buffer_load_dwordx4 v201, s[32:35], s60 offen lds
    v_mfma_f32_16x16x32_bf16 v[116:119], v[52:55], a[232:235], v[116:119]
    ds_read_b64_tr_b16 v[40:41], v220 offset:18496
    v_mfma_f32_16x16x32_bf16 v[152:155], v[52:55], a[236:239], v[152:155]
    ds_read_b64_tr_b16 v[42:43], v220 offset:20800
    s_waitcnt lgkmcnt(6)
    v_mfma_f32_16x16x32_bf16 v[120:123], v[56:59], a[232:235], v[120:123]
    ds_read_b64_tr_b16 v[44:45], v220 offset:18528
    v_mfma_f32_16x16x32_bf16 v[156:159], v[56:59], a[236:239], v[156:159]
    ds_read_b64_tr_b16 v[46:47], v220 offset:20832
    v_mfma_f32_16x16x32_bf16 v[124:127], v[60:63], a[232:235], v[124:127]
    s_add_u32 m0, s48, 5120
    ds_read_b64_tr_b16 v[48:49], v220 offset:18560
    v_mfma_f32_16x16x32_bf16 v[160:163], v[60:63], a[236:239], v[160:163]
    ds_read_b64_tr_b16 v[50:51], v220 offset:20864
    buffer_load_dwordx4 v197, s[32:35], s61 offen lds
    v_mfma_f32_16x16x32_bf16 v[128:131], v[64:67], a[232:235], v[128:131]
    ds_read_b64_tr_b16 v[52:53], v220 offset:18592
    v_mfma_f32_16x16x32_bf16 v[164:167], v[64:67], a[236:239], v[164:167]
    ds_read_b64_tr_b16 v[54:55], v220 offset:20896
    s_waitcnt lgkmcnt(6)
    v_mfma_f32_16x16x32_bf16 v[96:99], v[32:35], a[240:243], v[96:99]
    ds_read_b64_tr_b16 v[56:57], v220 offset:18624
    v_mfma_f32_16x16x32_bf16 v[132:135], v[32:35], a[244:247], v[132:135]
    ds_read_b64_tr_b16 v[58:59], v220 offset:20928
    v_mfma_f32_16x16x32_bf16 v[100:103], v[36:39], a[240:243], v[100:103]
    s_add_u32 m0, s48, 6144
    ds_read_b64_tr_b16 v[60:61], v220 offset:18656
    v_mfma_f32_16x16x32_bf16 v[136:139], v[36:39], a[244:247], v[136:139]
    ds_read_b64_tr_b16 v[62:63], v220 offset:20960
    buffer_load_dwordx4 v198, s[32:35], s61 offen lds
    v_mfma_f32_16x16x32_bf16 v[104:107], v[40:43], a[240:243], v[104:107]
    ds_read_b64_tr_b16 v[64:65], v220 offset:18688
    v_mfma_f32_16x16x32_bf16 v[140:143], v[40:43], a[244:247], v[140:143]
    ds_read_b64_tr_b16 v[66:67], v220 offset:20992
    s_waitcnt lgkmcnt(6)
    v_mfma_f32_16x16x32_bf16 v[108:111], v[44:47], a[240:243], v[108:111]
    ds_read_b64_tr_b16 v[32:33], v220 offset:27648
    v_mfma_f32_16x16x32_bf16 v[144:147], v[44:47], a[244:247], v[144:147]
    ds_read_b64_tr_b16 v[34:35], v220 offset:29952
    v_mfma_f32_16x16x32_bf16 v[112:115], v[48:51], a[240:243], v[112:115]
    s_add_u32 m0, s48, 7168
    ds_read_b64_tr_b16 v[36:37], v220 offset:27680
    v_mfma_f32_16x16x32_bf16 v[148:151], v[48:51], a[244:247], v[148:151]
    ds_read_b64_tr_b16 v[38:39], v220 offset:29984
    buffer_load_dwordx4 v199, s[32:35], s61 offen lds
    v_mfma_f32_16x16x32_bf16 v[116:119], v[52:55], a[240:243], v[116:119]
    ds_read_b64_tr_b16 v[40:41], v220 offset:27712
    v_mfma_f32_16x16x32_bf16 v[152:155], v[52:55], a[244:247], v[152:155]
    ds_read_b64_tr_b16 v[42:43], v220 offset:30016
    s_waitcnt lgkmcnt(6)
    v_mfma_f32_16x16x32_bf16 v[120:123], v[56:59], a[240:243], v[120:123]
    ds_read_b64_tr_b16 v[44:45], v220 offset:27744
    v_mfma_f32_16x16x32_bf16 v[156:159], v[56:59], a[244:247], v[156:159]
    ds_read_b64_tr_b16 v[46:47], v220 offset:30048
    v_mfma_f32_16x16x32_bf16 v[124:127], v[60:63], a[240:243], v[124:127]
    s_add_u32 m0, s48, 8192
    ds_read_b64_tr_b16 v[48:49], v220 offset:27776
    v_mfma_f32_16x16x32_bf16 v[160:163], v[60:63], a[244:247], v[160:163]
    ds_read_b64_tr_b16 v[50:51], v220 offset:30080
    buffer_load_dwordx4 v200, s[32:35], s61 offen lds
    v_mfma_f32_16x16x32_bf16 v[128:131], v[64:67], a[240:243], v[128:131]
    ds_read_b64_tr_b16 v[52:53], v220 offset:27808
    v_mfma_f32_16x16x32_bf16 v[164:167], v[64:67], a[244:247], v[164:167]
    ds_read_b64_tr_b16 v[54:55], v220 offset:30112
    s_waitcnt lgkmcnt(6)
    v_mfma_f32_16x16x32_bf16 v[96:99], v[32:35], a[248:251], v[96:99]
    ds_read_b64_tr_b16 v[56:57], v220 offset:27840
    v_mfma_f32_16x16x32_bf16 v[132:135], v[32:35], a[252:255], v[132:135]
    ds_read_b64_tr_b16 v[58:59], v220 offset:30144
    v_mfma_f32_16x16x32_bf16 v[100:103], v[36:39], a[248:251], v[100:103]
    ds_read_b64_tr_b16 v[60:61], v220 offset:27872
    v_mfma_f32_16x16x32_bf16 v[136:139], v[36:39], a[252:255], v[136:139]
    ds_read_b64_tr_b16 v[62:63], v220 offset:30176
    v_mfma_f32_16x16x32_bf16 v[104:107], v[40:43], a[248:251], v[104:107]
    ds_read_b64_tr_b16 v[64:65], v220 offset:27904
    v_mfma_f32_16x16x32_bf16 v[140:143], v[40:43], a[252:255], v[140:143]
    ds_read_b64_tr_b16 v[66:67], v220 offset:30208
    s_waitcnt vmcnt(9)
    s_barrier
    s_waitcnt lgkmcnt(6)
    v_mfma_f32_16x16x32_bf16 v[108:111], v[44:47], a[248:251], v[108:111]
    ds_read_b64_tr_b16 v[32:33], v221 offset:0
    v_mfma_f32_16x16x32_bf16 v[144:147], v[44:47], a[252:255], v[144:147]
    ds_read_b64_tr_b16 v[34:35], v221 offset:2304
    v_mfma_f32_16x16x32_bf16 v[112:115], v[48:51], a[248:251], v[112:115]
    ds_read_b64_tr_b16 v[36:37], v221 offset:32
    v_mfma_f32_16x16x32_bf16 v[148:151], v[48:51], a[252:255], v[148:151]
    ds_read_b64_tr_b16 v[38:39], v221 offset:2336
    v_mfma_f32_16x16x32_bf16 v[116:119], v[52:55], a[248:251], v[116:119]
    ds_read_b64_tr_b16 v[40:41], v221 offset:64
    v_mfma_f32_16x16x32_bf16 v[152:155], v[52:55], a[252:255], v[152:155]
    ds_read_b64_tr_b16 v[42:43], v221 offset:2368
    s_waitcnt lgkmcnt(6)
    v_mfma_f32_16x16x32_bf16 v[120:123], v[56:59], a[248:251], v[120:123]
    ds_read_b64_tr_b16 v[44:45], v221 offset:96
    v_mfma_f32_16x16x32_bf16 v[156:159], v[56:59], a[252:255], v[156:159]
    ds_read_b64_tr_b16 v[46:47], v221 offset:2400
    v_mfma_f32_16x16x32_bf16 v[124:127], v[60:63], a[248:251], v[124:127]
    ds_read_b64_tr_b16 v[48:49], v221 offset:128
    v_mfma_f32_16x16x32_bf16 v[160:163], v[60:63], a[252:255], v[160:163]
    ds_read_b64_tr_b16 v[50:51], v221 offset:2432
    v_mfma_f32_16x16x32_bf16 v[128:131], v[64:67], a[248:251], v[128:131]
    ds_read_b64_tr_b16 v[52:53], v221 offset:160
    v_mfma_f32_16x16x32_bf16 v[164:167], v[64:67], a[252:255], v[164:167]
    ds_read_b64_tr_b16 v[54:55], v221 offset:2464
    v_mov_b32 v220, v221
    s_mov_b32 s46, s62
    s_mov_b32 s62, s63
    s_mov_b32 s63, s64
    s_mov_b32 s64, s68
    s_mov_b32 s68, s46
    s_mul_i32 s60, s55, 165888
    s_mul_i32 s59, s58, 36864
    s_lshl_b32 s46, s55, 13
    s_add_u32 s59, s59, s46
    s_add_u32 s59, s59, 28606464
    s_mov_b64 exec, 255
    v_cmp_ne_u32 vcc, s44, v8
    v_cmp_ne_u32 s[48:49], s45, v9
    s_nop 0
    s_or_b64 vcc, vcc, s[48:49]
    s_nop 1
    s_cbranch_vccnz L_pslow_22
L_pback_23:
    s_mov_b64 exec, -1
    v_add_u32 v221, s63, v219
    s_waitcnt lgkmcnt(6)
    v_mfma_f32_16x16x32_bf16 v[96:99], v[32:35], a[0:3], v[96:99]
    ds_read_b64_tr_b16 v[56:57], v220 offset:192
    v_mfma_f32_16x16x32_bf16 v[132:135], v[32:35], a[4:7], v[132:135]
    ds_read_b64_tr_b16 v[58:59], v220 offset:2496
    v_mfma_f32_16x16x32_bf16 v[100:103], v[36:39], a[0:3], v[100:103]
    s_mul_i32 s48, s42, 9216
    s_add_u32 s48, s48, s64
    s_add_u32 m0, s48, 0
    ds_read_b64_tr_b16 v[60:61], v220 offset:224
    v_mfma_f32_16x16x32_bf16 v[136:139], v[36:39], a[4:7], v[136:139]
    ds_read_b64_tr_b16 v[62:63], v220 offset:2528
    buffer_load_dwordx4 v210, s[32:35], s60 offen lds
    v_mfma_f32_16x16x32_bf16 v[104:107], v[40:43], a[0:3], v[104:107]
    ds_read_b64_tr_b16 v[64:65], v220 offset:256
    v_mfma_f32_16x16x32_bf16 v[140:143], v[40:43], a[4:7], v[140:143]
    ds_read_b64_tr_b16 v[66:67], v220 offset:2560
    s_waitcnt lgkmcnt(6)
    v_mfma_f32_16x16x32_bf16 v[108:111], v[44:47], a[0:3], v[108:111]
    ds_read_b64_tr_b16 v[32:33], v220 offset:9216
    v_mfma_f32_16x16x32_bf16 v[144:147], v[44:47], a[4:7], v[144:147]
    ds_read_b64_tr_b16 v[34:35], v220 offset:11520
    buffer_load_dwordx4 a[32:35], v222, s[24:27], s59 offen offset:0 sc1
    v_mfma_f32_16x16x32_bf16 v[112:115], v[48:51], a[0:3], v[112:115]
    s_add_u32 m0, s48, 1024
    ds_read_b64_tr_b16 v[36:37], v220 offset:9248
    v_mfma_f32_16x16x32_bf16 v[148:151], v[48:51], a[4:7], v[148:151]
    ds_read_b64_tr_b16 v[38:39], v220 offset:11552
    buffer_load_dwordx4 v211, s[32:35], s60 offen lds
    v_mfma_f32_16x16x32_bf16 v[116:119], v[52:55], a[0:3], v[116:119]
    ds_read_b64_tr_b16 v[40:41], v220 offset:9280
    v_mfma_f32_16x16x32_bf16 v[152:155], v[52:55], a[4:7], v[152:155]
    ds_read_b64_tr_b16 v[42:43], v220 offset:11584
    s_waitcnt lgkmcnt(6)
    v_mfma_f32_16x16x32_bf16 v[120:123], v[56:59], a[0:3], v[120:123]
    ds_read_b64_tr_b16 v[44:45], v220 offset:9312
    v_mfma_f32_16x16x32_bf16 v[156:159], v[56:59], a[4:7], v[156:159]
    ds_read_b64_tr_b16 v[46:47], v220 offset:11616
    v_mfma_f32_16x16x32_bf16 v[124:127], v[60:63], a[0:3], v[124:127]
    s_add_u32 m0, s48, 2048
    ds_read_b64_tr_b16 v[48:49], v220 offset:9344
    v_mfma_f32_16x16x32_bf16 v[160:163], v[60:63], a[4:7], v[160:163]
    ds_read_b64_tr_b16 v[50:51], v220 offset:11648
    buffer_load_dwordx4 v212, s[32:35], s60 offen lds
    buffer_load_dwordx4 a[36:39], v222, s[24:27], s59 offen offset:256 sc1
    v_mfma_f32_16x16x32_bf16 v[128:131], v[64:67], a[0:3], v[128:131]
    ds_read_b64_tr_b16 v[52:53], v220 offset:9376
    v_mfma_f32_16x16x32_bf16 v[164:167], v[64:67], a[4:7], v[164:167]
    ds_read_b64_tr_b16 v[54:55], v220 offset:11680
    s_waitcnt lgkmcnt(6)
    v_mfma_f32_16x16x32_bf16 v[96:99], v[32:35], a[8:11], v[96:99]
    ds_read_b64_tr_b16 v[56:57], v220 offset:9408
    v_mfma_f32_16x16x32_bf16 v[132:135], v[32:35], a[12:15], v[132:135]
    ds_read_b64_tr_b16 v[58:59], v220 offset:11712
    v_mfma_f32_16x16x32_bf16 v[100:103], v[36:39], a[8:11], v[100:103]
    s_add_u32 m0, s48, 3072
    ds_read_b64_tr_b16 v[60:61], v220 offset:9440
    v_mfma_f32_16x16x32_bf16 v[136:139], v[36:39], a[12:15], v[136:139]
    ds_read_b64_tr_b16 v[62:63], v220 offset:11744
    buffer_load_dwordx4 v213, s[32:35], s60 offen lds
    v_mfma_f32_16x16x32_bf16 v[104:107], v[40:43], a[8:11], v[104:107]
    ds_read_b64_tr_b16 v[64:65], v220 offset:9472
    v_mfma_f32_16x16x32_bf16 v[140:143], v[40:43], a[12:15], v[140:143]
    ds_read_b64_tr_b16 v[66:67], v220 offset:11776
    buffer_load_dwordx4 a[40:43], v222, s[24:27], s59 offen offset:2048 sc1
    s_waitcnt lgkmcnt(6)
    v_mfma_f32_16x16x32_bf16 v[108:111], v[44:47], a[8:11], v[108:111]
    ds_read_b64_tr_b16 v[32:33], v220 offset:18432
    v_mfma_f32_16x16x32_bf16 v[144:147], v[44:47], a[12:15], v[144:147]
    ds_read_b64_tr_b16 v[34:35], v220 offset:20736
    v_mfma_f32_16x16x32_bf16 v[112:115], v[48:51], a[8:11], v[112:115]
    s_add_u32 m0, s48, 4096
    ds_read_b64_tr_b16 v[36:37], v220 offset:18464
    v_mfma_f32_16x16x32_bf16 v[148:151], v[48:51], a[12:15], v[148:151]
    ds_read_b64_tr_b16 v[38:39], v220 offset:20768
    buffer_load_dwordx4 v214, s[32:35], s60 offen lds
    v_mfma_f32_16x16x32_bf16 v[116:119], v[52:55], a[8:11], v[116:119]
    ds_read_b64_tr_b16 v[40:41], v220 offset:18496
    v_mfma_f32_16x16x32_bf16 v[152:155], v[52:55], a[12:15], v[152:155]
    ds_read_b64_tr_b16 v[42:43], v220 offset:20800
    s_waitcnt lgkmcnt(6)
    v_mfma_f32_16x16x32_bf16 v[120:123], v[56:59], a[8:11], v[120:123]
    ds_read_b64_tr_b16 v[44:45], v220 offset:18528
    v_mfma_f32_16x16x32_bf16 v[156:159], v[56:59], a[12:15], v[156:159]
    ds_read_b64_tr_b16 v[46:47], v220 offset:20832
    buffer_load_dwordx4 a[44:47], v222, s[24:27], s59 offen offset:2304 sc1
    v_mfma_f32_16x16x32_bf16 v[124:127], v[60:63], a[8:11], v[124:127]
    s_add_u32 m0, s48, 5120
    ds_read_b64_tr_b16 v[48:49], v220 offset:18560
    v_mfma_f32_16x16x32_bf16 v[160:163], v[60:63], a[12:15], v[160:163]
    ds_read_b64_tr_b16 v[50:51], v220 offset:20864
    buffer_load_dwordx4 v215, s[32:35], s60 offen lds
    v_mfma_f32_16x16x32_bf16 v[128:131], v[64:67], a[8:11], v[128:131]
    ds_read_b64_tr_b16 v[52:53], v220 offset:18592
    v_mfma_f32_16x16x32_bf16 v[164:167], v[64:67], a[12:15], v[164:167]
    ds_read_b64_tr_b16 v[54:55], v220 offset:20896
    s_waitcnt lgkmcnt(6)
    v_mfma_f32_16x16x32_bf16 v[96:99], v[32:35], a[16:19], v[96:99]
    ds_read_b64_tr_b16 v[56:57], v220 offset:18624
    v_mfma_f32_16x16x32_bf16 v[132:135], v[32:35], a[20:23], v[132:135]
    ds_read_b64_tr_b16 v[58:59], v220 offset:20928
    v_mfma_f32_16x16x32_bf16 v[100:103], v[36:39], a[16:19], v[100:103]
    s_add_u32 m0, s48, 6144
    ds_read_b64_tr_b16 v[60:61], v220 offset:18656
    v_mfma_f32_16x16x32_bf16 v[136:139], v[36:39], a[20:23], v[136:139]
    ds_read_b64_tr_b16 v[62:63], v220 offset:20960
    buffer_load_dwordx4 v216, s[32:35], s60 offen lds
    s_add_u32 s59, s59, 4096
    buffer_load_dwordx4 a[48:51], v222, s[24:27], s59 offen offset:0 sc1
    v_mfma_f32_16x16x32_bf16 v[104:107], v[40:43], a[16:19], v[104:107]
    ds_read_b64_tr_b16 v[64:65], v220 offset:18688
    v_mfma_f32_16x16x32_bf16 v[140:143], v[40:43], a[20:23], v[140:143]
    ds_read_b64_tr_b16 v[66:67], v220 offset:20992
    s_waitcnt lgkmcnt(6)
    v_mfma_f32_16x16x32_bf16 v[108:111], v[44:47], a[16:19], v[108:111]
    ds_read_b64_tr_b16 v[32:33], v220 offset:27648
    v_mfma_f32_16x16x32_bf16 v[144:147], v[44:47], a[20:23], v[144:147]
    ds_read_b64_tr_b16 v[34:35], v220 offset:29952
    v_mfma_f32_16x16x32_bf16 v[112:115], v[48:51], a[16:19], v[112:115]
    s_add_u32 m0, s48, 7168
    ds_read_b64_tr_b16 v[36:37], v220 offset:27680
    v_mfma_f32_16x16x32_bf16 v[148:151], v[48:51], a[20:23], v[148:151]
    ds_read_b64_tr_b16 v[38:39], v220 offset:29984
    buffer_load_dwordx4 v217, s[32:35], s60 offen lds
    v_mfma_f32_16x16x32_bf16 v[116:119], v[52:55], a[16:19], v[116:119]
    ds_read_b64_tr_b16 v[40:41], v220 offset:27712
    v_mfma_f32_16x16x32_bf16 v[152:155], v[52:55], a[20:23], v[152:155]
    ds_read_b64_tr_b16 v[42:43], v220 offset:30016
    buffer_load_dwordx4 a[52:55], v222, s[24:27], s59 offen offset:256 sc1
    s_waitcnt lgkmcnt(6)
    v_mfma_f32_16x16x32_bf16 v[120:123], v[56:59], a[16:19], v[120:123]
    ds_read_b64_tr_b16 v[44:45], v220 offset:27744
    v_mfma_f32_16x16x32_bf16 v[156:159], v[56:59], a[20:23], v[156:159]
    ds_read_b64_tr_b16 v[46:47], v220 offset:30048
    v_mfma_f32_16x16x32_bf16 v[124:127], v[60:63], a[16:19], v[124:127]
    s_add_u32 m0, s48, 8192
    ds_read_b64_tr_b16 v[48:49], v220 offset:27776
    v_mfma_f32_16x16x32_bf16 v[160:163], v[60:63], a[20:23], v[160:163]
    ds_read_b64_tr_b16 v[50:51], v220 offset:30080
    buffer_load_dwordx4 v218, s[32:35], s60 offen lds
    v_mfma_f32_16x16x32_bf16 v[128:131], v[64:67], a[16:19], v[128:131]
    ds_read_b64_tr_b16 v[52:53], v220 offset:27808
    v_mfma_f32_16x16x32_bf16 v[164:167], v[64:67], a[20:23], v[164:167]
    ds_read_b64_tr_b16 v[54:55], v220 offset:30112
    s_waitcnt lgkmcnt(6)
    v_mfma_f32_16x16x32_bf16 v[96:99], v[32:35], a[24:27], v[96:99]
    ds_read_b64_tr_b16 v[56:57], v220 offset:27840
    v_mfma_f32_16x16x32_bf16 v[132:135], v[32:35], a[28:31], v[132:135]
    ds_read_b64_tr_b16 v[58:59], v220 offset:30144
    buffer_load_dwordx4 a[56:59], v222, s[24:27], s59 offen offset:2048 sc1
    v_mfma_f32_16x16x32_bf16 v[100:103], v[36:39], a[24:27], v[100:103]
    ds_read_b64_tr_b16 v[60:61], v220 offset:27872
    v_mfma_f32_16x16x32_bf16 v[136:139], v[36:39], a[28:31], v[136:139]
    ds_read_b64_tr_b16 v[62:63], v220 offset:30176
    v_mfma_f32_16x16x32_bf16 v[104:107], v[40:43], a[24:27], v[104:107]
    ds_read_b64_tr_b16 v[64:65], v220 offset:27904
    v_mfma_f32_16x16x32_bf16 v[140:143], v[40:43], a[28:31], v[140:143]
    ds_read_b64_tr_b16 v[66:67], v220 offset:30208
    s_waitcnt vmcnt(16)
    s_barrier
    s_waitcnt lgkmcnt(6)
    v_mfma_f32_16x16x32_bf16 v[108:111], v[44:47], a[24:27], v[108:111]
    ds_read_b64_tr_b16 v[32:33], v221 offset:0
    v_mfma_f32_16x16x32_bf16 v[144:147], v[44:47], a[28:31], v[144:147]
    ds_read_b64_tr_b16 v[34:35], v221 offset:2304
    v_mfma_f32_16x16x32_bf16 v[112:115], v[48:51], a[24:27], v[112:115]
    ds_read_b64_tr_b16 v[36:37], v221 offset:32
    v_mfma_f32_16x16x32_bf16 v[148:151], v[48:51], a[28:31], v[148:151]
    ds_read_b64_tr_b16 v[38:39], v221 offset:2336
    buffer_load_dwordx4 a[60:63], v222, s[24:27], s59 offen offset:2304 sc1
    s_add_u32 s59, s59, 4096
    v_mfma_f32_16x16x32_bf16 v[116:119], v[52:55], a[24:27], v[116:119]
    ds_read_b64_tr_b16 v[40:41], v221 offset:64
    v_mfma_f32_16x16x32_bf16 v[152:155], v[52:55], a[28:31], v[152:155]
    ds_read_b64_tr_b16 v[42:43], v221 offset:2368
    s_waitcnt lgkmcnt(6)
    v_mfma_f32_16x16x32_bf16 v[120:123], v[56:59], a[24:27], v[120:123]
    ds_read_b64_tr_b16 v[44:45], v221 offset:96
    v_mfma_f32_16x16x32_bf16 v[156:159], v[56:59], a[28:31], v[156:159]
    ds_read_b64_tr_b16 v[46:47], v221 offset:2400
    v_mfma_f32_16x16x32_bf16 v[124:127], v[60:63], a[24:27], v[124:127]
    ds_read_b64_tr_b16 v[48:49], v221 offset:128
    v_mfma_f32_16x16x32_bf16 v[160:163], v[60:63], a[28:31], v[160:163]
    ds_read_b64_tr_b16 v[50:51], v221 offset:2432
    v_mfma_f32_16x16x32_bf16 v[128:131], v[64:67], a[24:27], v[128:131]
    ds_read_b64_tr_b16 v[52:53], v221 offset:160
    v_mfma_f32_16x16x32_bf16 v[164:167], v[64:67], a[28:31], v[164:167]
    ds_read_b64_tr_b16 v[54:55], v221 offset:2464
    v_mov_b32 v220, v221
    s_mov_b32 s46, s62
    s_mov_b32 s62, s63
    s_mov_b32 s63, s64
    s_mov_b32 s64, s68
    s_mov_b32 s68, s46
    s_mul_i32 s59, s58, 36864
    s_add_u32 s46, s55, 32
    s_lshl_b32 s46, s46, 10
    s_add_u32 s59, s59, s46
    s_add_u32 s59, s59, 28606464
    v_mov_b32 v12, 0x7ff00000
    v_cmp_gt_u32 vcc, 32, v0
    s_nop 1
    v_cndmask_b32 v12, v12, v222, vcc
    v_add_u32 v221, s63, v219
    s_waitcnt lgkmcnt(6)
    s_waitcnt vmcnt(15)
    v_mfma_f32_16x16x32_bf16 v[96:99], v[32:35], a[32:35], v[96:99]
    ds_read_b64_tr_b16 v[56:57], v220 offset:192
    s_waitcnt vmcnt(12)
    v_mfma_f32_16x16x32_bf16 v[132:135], v[32:35], a[36:39], v[132:135]
    ds_read_b64_tr_b16 v[58:59], v220 offset:2496
    v_mfma_f32_16x16x32_bf16 v[100:103], v[36:39], a[32:35], v[100:103]
    ds_read_b64_tr_b16 v[60:61], v220 offset:224
    v_mfma_f32_16x16x32_bf16 v[136:139], v[36:39], a[36:39], v[136:139]
    ds_read_b64_tr_b16 v[62:63], v220 offset:2528
    v_mfma_f32_16x16x32_bf16 v[104:107], v[40:43], a[32:35], v[104:107]
    ds_read_b64_tr_b16 v[64:65], v220 offset:256
    v_mfma_f32_16x16x32_bf16 v[140:143], v[40:43], a[36:39], v[140:143]
    ds_read_b64_tr_b16 v[66:67], v220 offset:2560
    s_waitcnt lgkmcnt(6)
    v_mfma_f32_16x16x32_bf16 v[108:111], v[44:47], a[32:35], v[108:111]
    ds_read_b64_tr_b16 v[32:33], v220 offset:9216
    v_mfma_f32_16x16x32_bf16 v[144:147], v[44:47], a[36:39], v[144:147]
    ds_read_b64_tr_b16 v[34:35], v220 offset:11520
    buffer_load_dwordx4 a[64:67], v12, s[24:27], s59 offen offset:0 sc1
    v_mfma_f32_16x16x32_bf16 v[112:115], v[48:51], a[32:35], v[112:115]
    ds_read_b64_tr_b16 v[36:37], v220 offset:9248
    v_mfma_f32_16x16x32_bf16 v[148:151], v[48:51], a[36:39], v[148:151]
    ds_read_b64_tr_b16 v[38:39], v220 offset:11552
    v_mfma_f32_16x16x32_bf16 v[116:119], v[52:55], a[32:35], v[116:119]
    ds_read_b64_tr_b16 v[40:41], v220 offset:9280
    v_mfma_f32_16x16x32_bf16 v[152:155], v[52:55], a[36:39], v[152:155]
    ds_read_b64_tr_b16 v[42:43], v220 offset:11584
    s_waitcnt lgkmcnt(6)
    v_mfma_f32_16x16x32_bf16 v[120:123], v[56:59], a[32:35], v[120:123]
    ds_read_b64_tr_b16 v[44:45], v220 offset:9312
    v_mfma_f32_16x16x32_bf16 v[156:159], v[56:59], a[36:39], v[156:159]
    ds_read_b64_tr_b16 v[46:47], v220 offset:11616
    v_mfma_f32_16x16x32_bf16 v[124:127], v[60:63], a[32:35], v[124:127]
    ds_read_b64_tr_b16 v[48:49], v220 offset:9344
    v_mfma_f32_16x16x32_bf16 v[160:163], v[60:63], a[36:39], v[160:163]
    ds_read_b64_tr_b16 v[50:51], v220 offset:11648
    buffer_load_dwordx4 a[68:71], v12, s[24:27], s59 offen offset:256 sc1
    v_mfma_f32_16x16x32_bf16 v[128:131], v[64:67], a[32:35], v[128:131]
    ds_read_b64_tr_b16 v[52:53], v220 offset:9376
    v_mfma_f32_16x16x32_bf16 v[164:167], v[64:67], a[36:39], v[164:167]
    ds_read_b64_tr_b16 v[54:55], v220 offset:11680
    s_waitcnt lgkmcnt(6)
    s_waitcnt vmcnt(12)
    v_mfma_f32_16x16x32_bf16 v[96:99], v[32:35], a[40:43], v[96:99]
    ds_read_b64_tr_b16 v[56:57], v220 offset:9408
    s_waitcnt vmcnt(10)
    v_mfma_f32_16x16x32_bf16 v[132:135], v[32:35], a[44:47], v[132:135]
    ds_read_b64_tr_b16 v[58:59], v220 offset:11712
    v_mfma_f32_16x16x32_bf16 v[100:103], v[36:39], a[40:43], v[100:103]
    ds_read_b64_tr_b16 v[60:61], v220 offset:9440
    v_mfma_f32_16x16x32_bf16 v[136:139], v[36:39], a[44:47], v[136:139]
    ds_read_b64_tr_b16 v[62:63], v220 offset:11744
    v_mfma_f32_16x16x32_bf16 v[104:107], v[40:43], a[40:43], v[104:107]
    ds_read_b64_tr_b16 v[64:65], v220 offset:9472
    v_mfma_f32_16x16x32_bf16 v[140:143], v[40:43], a[44:47], v[140:143]
    ds_read_b64_tr_b16 v[66:67], v220 offset:11776
    s_waitcnt lgkmcnt(6)
    v_mfma_f32_16x16x32_bf16 v[108:111], v[44:47], a[40:43], v[108:111]
    ds_read_b64_tr_b16 v[32:33], v220 offset:18432
    v_mfma_f32_16x16x32_bf16 v[144:147], v[44:47], a[44:47], v[144:147]
    ds_read_b64_tr_b16 v[34:35], v220 offset:20736
    v_mfma_f32_16x16x32_bf16 v[112:115], v[48:51], a[40:43], v[112:115]
    ds_read_b64_tr_b16 v[36:37], v220 offset:18464
    v_mfma_f32_16x16x32_bf16 v[148:151], v[48:51], a[44:47], v[148:151]
    ds_read_b64_tr_b16 v[38:39], v220 offset:20768
    v_mfma_f32_16x16x32_bf16 v[116:119], v[52:55], a[40:43], v[116:119]
    ds_read_b64_tr_b16 v[40:41], v220 offset:18496
    v_mfma_f32_16x16x32_bf16 v[152:155], v[52:55], a[44:47], v[152:155]
    ds_read_b64_tr_b16 v[42:43], v220 offset:20800
    s_waitcnt lgkmcnt(6)
    v_mfma_f32_16x16x32_bf16 v[120:123], v[56:59], a[40:43], v[120:123]
    ds_read_b64_tr_b16 v[44:45], v220 offset:18528
    v_mfma_f32_16x16x32_bf16 v[156:159], v[56:59], a[44:47], v[156:159]
    ds_read_b64_tr_b16 v[46:47], v220 offset:20832
    v_mfma_f32_16x16x32_bf16 v[124:127], v[60:63], a[40:43], v[124:127]
    ds_read_b64_tr_b16 v[48:49], v220 offset:18560
    v_mfma_f32_16x16x32_bf16 v[160:163], v[60:63], a[44:47], v[160:163]
    ds_read_b64_tr_b16 v[50:51], v220 offset:20864
    v_mfma_f32_16x16x32_bf16 v[128:131], v[64:67], a[40:43], v[128:131]
    ds_read_b64_tr_b16 v[52:53], v220 offset:18592
    v_mfma_f32_16x16x32_bf16 v[164:167], v[64:67], a[44:47], v[164:167]
    ds_read_b64_tr_b16 v[54:55], v220 offset:20896
    s_waitcnt lgkmcnt(6)
    s_waitcnt vmcnt(7)
    v_mfma_f32_16x16x32_bf16 v[96:99], v[32:35], a[48:51], v[96:99]
    ds_read_b64_tr_b16 v[56:57], v220 offset:18624
    s_waitcnt vmcnt(5)
    v_mfma_f32_16x16x32_bf16 v[132:135], v[32:35], a[52:55], v[132:135]
    ds_read_b64_tr_b16 v[58:59], v220 offset:20928
    v_mfma_f32_16x16x32_bf16 v[100:103], v[36:39], a[48:51], v[100:103]
    ds_read_b64_tr_b16 v[60:61], v220 offset:18656
    v_mfma_f32_16x16x32_bf16 v[136:139], v[36:39], a[52:55], v[136:139]
    ds_read_b64_tr_b16 v[62:63], v220 offset:20960
    v_mfma_f32_16x16x32_bf16 v[104:107], v[40:43], a[48:51], v[104:107]
    ds_read_b64_tr_b16 v[64:65], v220 offset:18688
    v_mfma_f32_16x16x32_bf16 v[140:143], v[40:43], a[52:55], v[140:143]
    ds_read_b64_tr_b16 v[66:67], v220 offset:20992
    s_waitcnt lgkmcnt(6)
    v_mfma_f32_16x16x32_bf16 v[108:111], v[44:47], a[48:51], v[108:111]
    ds_read_b64_tr_b16 v[32:33], v220 offset:27648
    v_mfma_f32_16x16x32_bf16 v[144:147], v[44:47], a[52:55], v[144:147]
    ds_read_b64_tr_b16 v[34:35], v220 offset:29952
    v_mfma_f32_16x16x32_bf16 v[112:115], v[48:51], a[48:51], v[112:115]
    ds_read_b64_tr_b16 v[36:37], v220 offset:27680
    v_mfma_f32_16x16x32_bf16 v[148:151], v[48:51], a[52:55], v[148:151]
    ds_read_b64_tr_b16 v[38:39], v220 offset:29984
    v_mfma_f32_16x16x32_bf16 v[116:119], v[52:55], a[48:51], v[116:119]
    ds_read_b64_tr_b16 v[40:41], v220 offset:27712
    v_mfma_f32_16x16x32_bf16 v[152:155], v[52:55], a[52:55], v[152:155]
    ds_read_b64_tr_b16 v[42:43], v220 offset:30016
    s_waitcnt lgkmcnt(6)
    v_mfma_f32_16x16x32_bf16 v[120:123], v[56:59], a[48:51], v[120:123]
    ds_read_b64_tr_b16 v[44:45], v220 offset:27744
    v_mfma_f32_16x16x32_bf16 v[156:159], v[56:59], a[52:55], v[156:159]
    ds_read_b64_tr_b16 v[46:47], v220 offset:30048
    v_mfma_f32_16x16x32_bf16 v[124:127], v[60:63], a[48:51], v[124:127]
    ds_read_b64_tr_b16 v[48:49], v220 offset:27776
    v_mfma_f32_16x16x32_bf16 v[160:163], v[60:63], a[52:55], v[160:163]
    ds_read_b64_tr_b16 v[50:51], v220 offset:30080
    v_mfma_f32_16x16x32_bf16 v[128:131], v[64:67], a[48:51], v[128:131]
    ds_read_b64_tr_b16 v[52:53], v220 offset:27808
    v_mfma_f32_16x16x32_bf16 v[164:167], v[64:67], a[52:55], v[164:167]
    ds_read_b64_tr_b16 v[54:55], v220 offset:30112
    s_waitcnt lgkmcnt(6)
    s_waitcnt vmcnt(3)
    v_mfma_f32_16x16x32_bf16 v[96:99], v[32:35], a[56:59], v[96:99]
    ds_read_b64_tr_b16 v[56:57], v220 offset:27840
    s_waitcnt vmcnt(2)
    v_mfma_f32_16x16x32_bf16 v[132:135], v[32:35], a[60:63], v[132:135]
    ds_read_b64_tr_b16 v[58:59], v220 offset:30144
    v_mfma_f32_16x16x32_bf16 v[100:103], v[36:39], a[56:59], v[100:103]
    ds_read_b64_tr_b16 v[60:61], v220 offset:27872
    v_mfma_f32_16x16x32_bf16 v[136:139], v[36:39], a[60:63], v[136:139]
    ds_read_b64_tr_b16 v[62:63], v220 offset:30176
    v_mfma_f32_16x16x32_bf16 v[104:107], v[40:43], a[56:59], v[104:107]
    ds_read_b64_tr_b16 v[64:65], v220 offset:27904
    v_mfma_f32_16x16x32_bf16 v[140:143], v[40:43], a[60:63], v[140:143]
    ds_read_b64_tr_b16 v[66:67], v220 offset:30208
    s_barrier
    s_waitcnt lgkmcnt(6)
    v_mfma_f32_16x16x32_bf16 v[108:111], v[44:47], a[56:59], v[108:111]
    ds_read_b64_tr_b16 v[32:33], v221 offset:0
    v_mfma_f32_16x16x32_bf16 v[144:147], v[44:47], a[60:63], v[144:147]
    ds_read_b64_tr_b16 v[34:35], v221 offset:2304
    v_mfma_f32_16x16x32_bf16 v[112:115], v[48:51], a[56:59], v[112:115]
    ds_read_b64_tr_b16 v[36:37], v221 offset:32
    v_mfma_f32_16x16x32_bf16 v[148:151], v[48:51], a[60:63], v[148:151]
    ds_read_b64_tr_b16 v[38:39], v221 offset:2336
    v_mfma_f32_16x16x32_bf16 v[116:119], v[52:55], a[56:59], v[116:119]
    ds_read_b64_tr_b16 v[40:41], v221 offset:64
    v_mfma_f32_16x16x32_bf16 v[152:155], v[52:55], a[60:63], v[152:155]
    ds_read_b64_tr_b16 v[42:43], v221 offset:2368
    s_waitcnt lgkmcnt(6)
    v_mfma_f32_16x16x32_bf16 v[120:123], v[56:59], a[56:59], v[120:123]
    ds_read_b64_tr_b16 v[44:45], v221 offset:96
    v_mfma_f32_16x16x32_bf16 v[156:159], v[56:59], a[60:63], v[156:159]
    ds_read_b64_tr_b16 v[46:47], v221 offset:2400
    v_mfma_f32_16x16x32_bf16 v[124:127], v[60:63], a[56:59], v[124:127]
    ds_read_b64_tr_b16 v[48:49], v221 offset:128
    v_mfma_f32_16x16x32_bf16 v[160:163], v[60:63], a[60:63], v[160:163]
    ds_read_b64_tr_b16 v[50:51], v221 offset:2432
    v_mfma_f32_16x16x32_bf16 v[128:131], v[64:67], a[56:59], v[128:131]
    ds_read_b64_tr_b16 v[52:53], v221 offset:160
    v_mfma_f32_16x16x32_bf16 v[164:167], v[64:67], a[60:63], v[164:167]
    ds_read_b64_tr_b16 v[54:55], v221 offset:2464
    v_mov_b32 v220, v221
    s_mov_b32 s46, s62
    s_mov_b32 s62, s63
    s_mov_b32 s63, s64
    s_mov_b32 s64, s68
    s_mov_b32 s68, s46
    v_add_u32 v221, s63, v219
    s_waitcnt lgkmcnt(6)
    s_waitcnt vmcnt(1)
    v_mfma_f32_16x16x32_bf16 v[96:99], v[32:35], a[64:67], v[96:99]
    ds_read_b64_tr_b16 v[56:57], v220 offset:192
    s_waitcnt vmcnt(0)
    v_mfma_f32_16x16x32_bf16 v[132:135], v[32:35], a[68:71], v[132:135]
    ds_read_b64_tr_b16 v[58:59], v220 offset:2496
    v_mfma_f32_16x16x32_bf16 v[100:103], v[36:39], a[64:67], v[100:103]
    ds_read_b64_tr_b16 v[60:61], v220 offset:224
    v_mfma_f32_16x16x32_bf16 v[136:139], v[36:39], a[68:71], v[136:139]
    ds_read_b64_tr_b16 v[62:63], v220 offset:2528
    v_mfma_f32_16x16x32_bf16 v[104:107], v[40:43], a[64:67], v[104:107]
    ds_read_b64_tr_b16 v[64:65], v220 offset:256
    v_mfma_f32_16x16x32_bf16 v[140:143], v[40:43], a[68:71], v[140:143]
    ds_read_b64_tr_b16 v[66:67], v220 offset:2560
    s_waitcnt lgkmcnt(6)
    v_mfma_f32_16x16x32_bf16 v[108:111], v[44:47], a[64:67], v[108:111]
    v_mfma_f32_16x16x32_bf16 v[144:147], v[44:47], a[68:71], v[144:147]
    v_mfma_f32_16x16x32_bf16 v[112:115], v[48:51], a[64:67], v[112:115]
    v_mfma_f32_16x16x32_bf16 v[148:151], v[48:51], a[68:71], v[148:151]
    v_mfma_f32_16x16x32_bf16 v[116:119], v[52:55], a[64:67], v[116:119]
    v_mfma_f32_16x16x32_bf16 v[152:155], v[52:55], a[68:71], v[152:155]
    s_waitcnt lgkmcnt(0)
    v_mfma_f32_16x16x32_bf16 v[120:123], v[56:59], a[64:67], v[120:123]
    v_mfma_f32_16x16x32_bf16 v[156:159], v[56:59], a[68:71], v[156:159]
    v_mfma_f32_16x16x32_bf16 v[124:127], v[60:63], a[64:67], v[124:127]
    v_mfma_f32_16x16x32_bf16 v[160:163], v[60:63], a[68:71], v[160:163]
    v_mfma_f32_16x16x32_bf16 v[128:131], v[64:67], a[64:67], v[128:131]
    v_mfma_f32_16x16x32_bf16 v[164:167], v[64:67], a[68:71], v[164:167]
    v_mov_b32 v220, v221
    s_mov_b32 s46, s62
    s_mov_b32 s62, s63
    s_mov_b32 s63, s64
    s_mov_b32 s64, s68
    s_mov_b32 s68, s46
    s_mul_i32 s46, s55, 2359296
    s_mul_i32 s47, s58, 36864
    s_add_u32 s46, s46, s47
    s_mul_i32 s47, s57, 9216
    s_add_u32 s46, s46, s47
    s_add_u32 s46, s46, 30965760
    v_cvt_pk_bf16_f32 v168, v96, v97
    v_cvt_pk_bf16_f32 v169, v98, v99
    v_cvt_pk_bf16_f32 v170, v132, v133
    v_cvt_pk_bf16_f32 v171, v134, v135
    buffer_store_dwordx4 v[168:171], v2, s[24:27], s46 offen offset:0 sc1
    v_cvt_pk_bf16_f32 v172, v100, v101
    v_cvt_pk_bf16_f32 v173, v102, v103
    v_cvt_pk_bf16_f32 v174, v136, v137
    v_cvt_pk_bf16_f32 v175, v138, v139
    buffer_store_dwordx4 v[172:175], v2, s[24:27], s46 offen offset:1024 sc1
    v_cvt_pk_bf16_f32 v176, v104, v105
    v_cvt_pk_bf16_f32 v177, v106, v107
    v_cvt_pk_bf16_f32 v178, v140, v141
    v_cvt_pk_bf16_f32 v179, v142, v143
    buffer_store_dwordx4 v[176:179], v2, s[24:27], s46 offen offset:2048 sc1
    v_cvt_pk_bf16_f32 v180, v108, v109
    v_cvt_pk_bf16_f32 v181, v110, v111
    v_cvt_pk_bf16_f32 v182, v144, v145
    v_cvt_pk_bf16_f32 v183, v146, v147
    buffer_store_dwordx4 v[180:183], v2, s[24:27], s46 offen offset:3072 sc1
    v_cvt_pk_bf16_f32 v184, v112, v113
    v_cvt_pk_bf16_f32 v185, v114, v115
    v_cvt_pk_bf16_f32 v186, v148, v149
    v_cvt_pk_bf16_f32 v187, v150, v151
    s_add_u32 s46, s46, 4096
    buffer_store_dwordx4 v[184:187], v2, s[24:27], s46 offen offset:0 sc1
    v_cvt_pk_bf16_f32 v188, v116, v117
    v_cvt_pk_bf16_f32 v189, v118, v119
    v_cvt_pk_bf16_f32 v190, v152, v153
    v_cvt_pk_bf16_f32 v191, v154, v155
    buffer_store_dwordx4 v[188:191], v2, s[24:27], s46 offen offset:1024 sc1
    v_cvt_pk_bf16_f32 v168, v120, v121
    v_cvt_pk_bf16_f32 v169, v122, v123
    v_cvt_pk_bf16_f32 v170, v156, v157
    v_cvt_pk_bf16_f32 v171, v158, v159
    buffer_store_dwordx4 v[168:171], v2, s[24:27], s46 offen offset:2048 sc1
    v_cvt_pk_bf16_f32 v172, v124, v125
    v_cvt_pk_bf16_f32 v173, v126, v127
    v_cvt_pk_bf16_f32 v174, v160, v161
    v_cvt_pk_bf16_f32 v175, v162, v163
    buffer_store_dwordx4 v[172:175], v2, s[24:27], s46 offen offset:3072 sc1
    v_cvt_pk_bf16_f32 v176, v128, v129
    v_cvt_pk_bf16_f32 v177, v130, v131
    v_cvt_pk_bf16_f32 v178, v164, v165
    v_cvt_pk_bf16_f32 v179, v166, v167
    s_add_u32 s46, s46, 4096
    buffer_store_dwordx4 v[176:179], v2, s[24:27], s46 offen offset:0 sc1
    s_mov_b32 s28, s4
    s_and_b32 s29, s5, 0xffff
    s_mov_b32 s30, 2359296
    s_mov_b32 s31, 0x00020000
    s_mov_b32 s32, s18
    s_and_b32 s33, s19, 0xffff
    s_mov_b32 s34, 2359296
    s_mov_b32 s35, 0x00020000
    s_lshl_b32 s50, s56, 2
    s_add_u32 s50, s50, s55
    s_mul_i32 s51, s50, 36864
    s_mul_i32 s46, s57, 288
    s_add_u32 s51, s51, s46
    s_mul_i32 s52, s50, 36864
    s_mul_i32 s46, s57, 9216
    s_add_u32 s52, s52, s46
    s_add_u32 s52, s52, 30965760
    v_and_b32 v14, 15, v0
    v_mul_u32_u24 v14, 1152, v14
    v_lshrrev_b32 v15, 4, v0
    v_lshl_add_u32 v16, v15, 3, v14
    v_and_b32 v17, 1, v15
    v_mul_u32_u24 v17, 18432, v17
    v_add_u32 v17, v17, v14
    v_lshrrev_b32 v15, 1, v15
    v_lshl_add_u32 v17, v15, 4, v17
    s_add_u32 s53, s42, 0
    s_cmp_lt_u32 s53, 9
    s_cselect_b32 s66, 0, 0x70000000
    s_lshl_b32 s46, s53, 5
    s_add_u32 s46, s46, s51
    s_add_u32 s46, s46, s66
    v_add_u32 v8, s46, v16
    v_add_u32 v11, s46, v17
    s_lshl_b32 s53, s53, 10
    s_add_u32 s53, s53, s52
    s_add_u32 s53, s53, s66
    s_add_u32 s54, s42, 4
    s_cmp_lt_u32 s54, 9
    s_cselect_b32 s67, 0, 0x70000000
    s_lshl_b32 s46, s54, 5
    s_add_u32 s46, s46, s51
    s_add_u32 s46, s46, s67
    v_add_u32 v9, s46, v16
    v_add_u32 v12, s46, v17
    s_lshl_b32 s54, s54, 10
    s_add_u32 s54, s54, s52
    s_add_u32 s54, s54, s67
    s_add_u32 s55, s42, 8
    s_cmp_lt_u32 s55, 9
    s_cselect_b32 s68, 0, 0x70000000
    s_lshl_b32 s46, s55, 5
    s_add_u32 s46, s46, s51
    s_add_u32 s46, s46, s68
    v_add_u32 v10, s46, v16
    v_add_u32 v13, s46, v17
    s_lshl_b32 s55, s55, 10
    s_add_u32 s55, s55, s52
    s_add_u32 s55, s55, s68
    buffer_load_dwordx2 v[20:21], v8, s[28:31], 0 offen
    s_mov_b32 s46, 18432
    buffer_load_dwordx2 v[22:23], v8, s[28:31], s46 offen
    buffer_load_dwordx2 v[24:25], v9, s[28:31], 0 offen
    s_mov_b32 s46, 18432
    buffer_load_dwordx2 v[26:27], v9, s[28:31], s46 offen
    buffer_load_dwordx2 v[28:29], v10, s[28:31], 0 offen
    s_mov_b32 s46, 18432
    buffer_load_dwordx2 v[30:31], v10, s[28:31], s46 offen
    s_waitcnt vmcnt(6)
    s_barrier
    s_cmp_lg_u32 s42, 0
    s_cbranch_scc1 L_pub_24
    s_lshl_b32 s49, s2, 7
    s_add_u32 s49, s49, 32
    v_mov_b32 v4, s44
    v_mov_b32 v5, s45
    v_mov_b32 v6, 0
    s_mov_b64 exec, 1
    buffer_store_dwordx2 v[4:5], v6, s[24:27], s49 offen sc1
    s_mov_b64 exec, -1
L_pub_24:
    v_and_b32 v3, 3, v0
    v_lshlrev_b32 v3, 1, v3
    s_and_b32 s46, s2, 0xf9
    v_add_u32 v3, s46, v3
    v_lshlrev_b32 v6, 7, v3
    v_add_u32 v6, 32, v6
    s_mov_b64 exec, 15
    s_mov_b32 s69, 400000
L_poll_25:
    s_sub_u32 s69, s69, 1
    s_cbranch_scc1 L_pollok_26
    buffer_load_dwordx2 v[4:5], v6, s[24:27], 0 offen sc1
    s_waitcnt vmcnt(0)
    v_cmp_ne_u32 vcc, s44, v4
    v_cmp_ne_u32 s[48:49], s45, v5
    s_nop 4
    s_or_b64 vcc, vcc, s[48:49]
    s_nop 4
    s_cbranch_vccz L_pollok_26
    s_sleep 1
    s_branch L_poll_25
L_pollok_26:
    s_mov_b64 exec, -1
    buffer_load_dwordx4 v[64:67], v2, s[24:27], s53 offen sc1
    s_add_u32 s53, s53, 2359296
    buffer_load_dwordx4 v[68:71], v2, s[24:27], s53 offen sc1
    s_add_u32 s53, s53, 2359296
    buffer_load_dwordx4 v[72:75], v2, s[24:27], s53 offen sc1
    s_add_u32 s53, s53, 2359296
    buffer_load_dwordx4 v[76:79], v2, s[24:27], s53 offen sc1
    buffer_load_dwordx4 v[80:83], v2, s[24:27], s54 offen sc1
    s_add_u32 s54, s54, 2359296
    buffer_load_dwordx4 v[84:87], v2, s[24:27], s54 offen sc1
    s_add_u32 s54, s54, 2359296
    buffer_load_dwordx4 v[88:91], v2, s[24:27], s54 offen sc1
    s_add_u32 s54, s54, 2359296
    buffer_load_dwordx4 v[92:95], v2, s[24:27], s54 offen sc1
    buffer_load_dwordx4 v[96:99], v2, s[24:27], s55 offen sc1
    s_add_u32 s55, s55, 2359296
    buffer_load_dwordx4 v[100:103], v2, s[24:27], s55 offen sc1
    s_add_u32 s55, s55, 2359296
    buffer_load_dwordx4 v[104:107], v2, s[24:27], s55 offen sc1
    s_add_u32 s55, s55, 2359296
    buffer_load_dwordx4 v[108:111], v2, s[24:27], s55 offen sc1
    s_mov_b32 s48, 0x00003f80
    s_mov_b32 s49, 0x3f800000
    v_lshlrev_b32 v128, 16, v20
    v_and_b32 v129, 0xffff0000, v20
    v_lshlrev_b32 v130, 16, v21
    v_and_b32 v131, 0xffff0000, v21
    v_lshlrev_b32 v132, 16, v22
    v_and_b32 v133, 0xffff0000, v22
    v_lshlrev_b32 v134, 16, v23
    v_and_b32 v135, 0xffff0000, v23
    s_waitcnt vmcnt(11)
    v_dot2_f32_bf16 v128, v64, s48, v128
    v_dot2_f32_bf16 v129, v64, s49, v129
    v_dot2_f32_bf16 v130, v65, s48, v130
    v_dot2_f32_bf16 v131, v65, s49, v131
    v_dot2_f32_bf16 v132, v66, s48, v132
    v_dot2_f32_bf16 v133, v66, s49, v133
    v_dot2_f32_bf16 v134, v67, s48, v134
    v_dot2_f32_bf16 v135, v67, s49, v135
    s_waitcnt vmcnt(10)
    v_dot2_f32_bf16 v128, v68, s48, v128
    v_dot2_f32_bf16 v129, v68, s49, v129
    v_dot2_f32_bf16 v130, v69, s48, v130
    v_dot2_f32_bf16 v131, v69, s49, v131
    v_dot2_f32_bf16 v132, v70, s48, v132
    v_dot2_f32_bf16 v133, v70, s49, v133
    v_dot2_f32_bf16 v134, v71, s48, v134
    v_dot2_f32_bf16 v135, v71, s49, v135
    s_waitcnt vmcnt(9)
    v_dot2_f32_bf16 v128, v72, s48, v128
    v_dot2_f32_bf16 v129, v72, s49, v129
    v_dot2_f32_bf16 v130, v73, s48, v130
    v_dot2_f32_bf16 v131, v73, s49, v131
    v_dot2_f32_bf16 v132, v74, s48, v132
    v_dot2_f32_bf16 v133, v74, s49, v133
    v_dot2_f32_bf16 v134, v75, s48, v134
    v_dot2_f32_bf16 v135, v75, s49, v135
    s_waitcnt vmcnt(8)
    v_dot2_f32_bf16 v128, v76, s48, v128
    v_dot2_f32_bf16 v129, v76, s49, v129
    v_dot2_f32_bf16 v130, v77, s48, v130
    v_dot2_f32_bf16 v131, v77, s49, v131
    v_dot2_f32_bf16 v132, v78, s48, v132
    v_dot2_f32_bf16 v133, v78, s49, v133
    v_dot2_f32_bf16 v134, v79, s48, v134
    v_dot2_f32_bf16 v135, v79, s49, v135
    v_cvt_pk_bf16_f32 v40, v128, v129
    v_cvt_pk_bf16_f32 v41, v130, v131
    v_cvt_pk_bf16_f32 v42, v132, v133
    v_cvt_pk_bf16_f32 v43, v134, v135
    s_nop 0
    v_permlane16_swap_b32 v40, v42
    v_permlane16_swap_b32 v41, v43
    buffer_store_dwordx4 v[40:43], v11, s[32:35], 0 offen
    v_lshlrev_b32 v144, 16, v24
    v_and_b32 v145, 0xffff0000, v24
    v_lshlrev_b32 v146, 16, v25
    v_and_b32 v147, 0xffff0000, v25
    v_lshlrev_b32 v148, 16, v26
    v_and_b32 v149, 0xffff0000, v26
    v_lshlrev_b32 v150, 16, v27
    v_and_b32 v151, 0xffff0000, v27
    s_waitcnt vmcnt(8)
    v_dot2_f32_bf16 v144, v80, s48, v144
    v_dot2_f32_bf16 v145, v80, s49, v145
    v_dot2_f32_bf16 v146, v81, s48, v146
    v_dot2_f32_bf16 v147, v81, s49, v147
    v_dot2_f32_bf16 v148, v82, s48, v148
    v_dot2_f32_bf16 v149, v82, s49, v149
    v_dot2_f32_bf16 v150, v83, s48, v150
    v_dot2_f32_bf16 v151, v83, s49, v151
    s_waitcnt vmcnt(7)
    v_dot2_f32_bf16 v144, v84, s48, v144
    v_dot2_f32_bf16 v145, v84, s49, v145
    v_dot2_f32_bf16 v146, v85, s48, v146
    v_dot2_f32_bf16 v147, v85, s49, v147
    v_dot2_f32_bf16 v148, v86, s48, v148
    v_dot2_f32_bf16 v149, v86, s49, v149
    v_dot2_f32_bf16 v150, v87, s48, v150
    v_dot2_f32_bf16 v151, v87, s49, v151
    s_waitcnt vmcnt(6)
    v_dot2_f32_bf16 v144, v88, s48, v144
    v_dot2_f32_bf16 v145, v88, s49, v145
    v_dot2_f32_bf16 v146, v89, s48, v146
    v_dot2_f32_bf16 v147, v89, s49, v147
    v_dot2_f32_bf16 v148, v90, s48, v148
    v_dot2_f32_bf16 v149, v90, s49, v149
    v_dot2_f32_bf16 v150, v91, s48, v150
    v_dot2_f32_bf16 v151, v91, s49, v151
    s_waitcnt vmcnt(5)
    v_dot2_f32_bf16 v144, v92, s48, v144
    v_dot2_f32_bf16 v145, v92, s49, v145
    v_dot2_f32_bf16 v146, v93, s48, v146
    v_dot2_f32_bf16 v147, v93, s49, v147
    v_dot2_f32_bf16 v148, v94, s48, v148
    v_dot2_f32_bf16 v149, v94, s49, v149
    v_dot2_f32_bf16 v150, v95, s48, v150
    v_dot2_f32_bf16 v151, v95, s49, v151
    v_cvt_pk_bf16_f32 v44, v144, v145
    v_cvt_pk_bf16_f32 v45, v146, v147
    v_cvt_pk_bf16_f32 v46, v148, v149
    v_cvt_pk_bf16_f32 v47, v150, v151
    s_nop 0
    v_permlane16_swap_b32 v44, v46
    v_permlane16_swap_b32 v45, v47
    buffer_store_dwordx4 v[44:47], v12, s[32:35], 0 offen
    v_lshlrev_b32 v160, 16, v28
    v_and_b32 v161, 0xffff0000, v28
    v_lshlrev_b32 v162, 16, v29
    v_and_b32 v163, 0xffff0000, v29
    v_lshlrev_b32 v164, 16, v30
    v_and_b32 v165, 0xffff0000, v30
    v_lshlrev_b32 v166, 16, v31
    v_and_b32 v167, 0xffff0000, v31
    s_waitcnt vmcnt(5)
    v_dot2_f32_bf16 v160, v96, s48, v160
    v_dot2_f32_bf16 v161, v96, s49, v161
    v_dot2_f32_bf16 v162, v97, s48, v162
    v_dot2_f32_bf16 v163, v97, s49, v163
    v_dot2_f32_bf16 v164, v98, s48, v164
    v_dot2_f32_bf16 v165, v98, s49, v165
    v_dot2_f32_bf16 v166, v99, s48, v166
    v_dot2_f32_bf16 v167, v99, s49, v167
    s_waitcnt vmcnt(4)
    v_dot2_f32_bf16 v160, v100, s48, v160
    v_dot2_f32_bf16 v161, v100, s49, v161
    v_dot2_f32_bf16 v162, v101, s48, v162
    v_dot2_f32_bf16 v163, v101, s49, v163
    v_dot2_f32_bf16 v164, v102, s48, v164
    v_dot2_f32_bf16 v165, v102, s49, v165
    v_dot2_f32_bf16 v166, v103, s48, v166
    v_dot2_f32_bf16 v167, v103, s49, v167
    s_waitcnt vmcnt(3)
    v_dot2_f32_bf16 v160, v104, s48, v160
    v_dot2_f32_bf16 v161, v104, s49, v161
    v_dot2_f32_bf16 v162, v105, s48, v162
    v_dot2_f32_bf16 v163, v105, s49, v163
    v_dot2_f32_bf16 v164, v106, s48, v164
    v_dot2_f32_bf16 v165, v106, s49, v165
    v_dot2_f32_bf16 v166, v107, s48, v166
    v_dot2_f32_bf16 v167, v107, s49, v167
    s_waitcnt vmcnt(2)
    v_dot2_f32_bf16 v160, v108, s48, v160
    v_dot2_f32_bf16 v161, v108, s49, v161
    v_dot2_f32_bf16 v162, v109, s48, v162
    v_dot2_f32_bf16 v163, v109, s49, v163
    v_dot2_f32_bf16 v164, v110, s48, v164
    v_dot2_f32_bf16 v165, v110, s49, v165
    v_dot2_f32_bf16 v166, v111, s48, v166
    v_dot2_f32_bf16 v167, v111, s49, v167
    v_cvt_pk_bf16_f32 v48, v160, v161
    v_cvt_pk_bf16_f32 v49, v162, v163
    v_cvt_pk_bf16_f32 v50, v164, v165
    v_cvt_pk_bf16_f32 v51, v166, v167
    s_nop 0
    v_permlane16_swap_b32 v48, v50
    v_permlane16_swap_b32 v49, v51
    buffer_store_dwordx4 v[48:51], v13, s[32:35], 0 offen
    s_endpgm
parallel_sum__softmax_full_mha__swiglu_ffn__prompt_kernel_p2slow:
    s_waitcnt vmcnt(0) lgkmcnt(0)
    s_barrier
    v_mov_b32 v19, 0
    s_lshl_b32 s47, s42, 2
    s_add_u32 s47, s47, 163600
    v_mov_b32 v20, s47
    ds_write_b32 v20, v19
    s_add_u32 s47, s42, 0
    s_lshl_b32 s46, s47, 10
    s_add_u32 m0, s46, 0
    s_add_u32 s46, s46, s65
    buffer_load_dwordx4 v2, s[24:27], s46 offen sc1 lds
    s_add_u32 s47, s42, 0
    s_lshl_b32 s46, s47, 10
    s_add_u32 m0, s46, 73728
    s_add_u32 s46, s46, s67
    buffer_load_dwordx4 v2, s[24:27], s46 offen sc1 lds
    s_add_u32 s47, s42, 4
    s_lshl_b32 s46, s47, 10
    s_add_u32 m0, s46, 0
    s_add_u32 s46, s46, s65
    buffer_load_dwordx4 v2, s[24:27], s46 offen sc1 lds
    s_add_u32 s47, s42, 4
    s_lshl_b32 s46, s47, 10
    s_add_u32 m0, s46, 73728
    s_add_u32 s46, s46, s67
    buffer_load_dwordx4 v2, s[24:27], s46 offen sc1 lds
    s_add_u32 s47, s42, 8
    s_lshl_b32 s46, s47, 10
    s_add_u32 m0, s46, 0
    s_add_u32 s46, s46, s65
    buffer_load_dwordx4 v2, s[24:27], s46 offen sc1 lds
    s_add_u32 s47, s42, 8
    s_lshl_b32 s46, s47, 10
    s_add_u32 m0, s46, 73728
    s_add_u32 s46, s46, s67
    buffer_load_dwordx4 v2, s[24:27], s46 offen sc1 lds
    s_add_u32 s47, s42, 12
    s_lshl_b32 s46, s47, 10
    s_add_u32 m0, s46, 0
    s_add_u32 s46, s46, s65
    buffer_load_dwordx4 v2, s[24:27], s46 offen sc1 lds
    s_add_u32 s47, s42, 12
    s_lshl_b32 s46, s47, 10
    s_add_u32 m0, s46, 73728
    s_add_u32 s46, s46, s67
    buffer_load_dwordx4 v2, s[24:27], s46 offen sc1 lds
    s_add_u32 s47, s42, 16
    s_lshl_b32 s46, s47, 10
    s_add_u32 m0, s46, 0
    s_add_u32 s46, s46, s65
    buffer_load_dwordx4 v2, s[24:27], s46 offen sc1 lds
    s_add_u32 s47, s42, 16
    s_lshl_b32 s46, s47, 10
    s_add_u32 m0, s46, 73728
    s_add_u32 s46, s46, s67
    buffer_load_dwordx4 v2, s[24:27], s46 offen sc1 lds
    s_add_u32 s47, s42, 20
    s_lshl_b32 s46, s47, 10
    s_add_u32 m0, s46, 0
    s_add_u32 s46, s46, s65
    buffer_load_dwordx4 v2, s[24:27], s46 offen sc1 lds
    s_add_u32 s47, s42, 20
    s_lshl_b32 s46, s47, 10
    s_add_u32 m0, s46, 73728
    s_add_u32 s46, s46, s67
    buffer_load_dwordx4 v2, s[24:27], s46 offen sc1 lds
    s_add_u32 s47, s42, 24
    s_lshl_b32 s46, s47, 10
    s_add_u32 m0, s46, 0
    s_add_u32 s46, s46, s65
    buffer_load_dwordx4 v2, s[24:27], s46 offen sc1 lds
    s_add_u32 s47, s42, 24
    s_lshl_b32 s46, s47, 10
    s_add_u32 m0, s46, 73728
    s_add_u32 s46, s46, s67
    buffer_load_dwordx4 v2, s[24:27], s46 offen sc1 lds
    s_add_u32 s47, s42, 28
    s_lshl_b32 s46, s47, 10
    s_add_u32 m0, s46, 0
    s_add_u32 s46, s46, s65
    buffer_load_dwordx4 v2, s[24:27], s46 offen sc1 lds
    s_add_u32 s47, s42, 28
    s_lshl_b32 s46, s47, 10
    s_add_u32 m0, s46, 73728
    s_add_u32 s46, s46, s67
    buffer_load_dwordx4 v2, s[24:27], s46 offen sc1 lds
    s_add_u32 s47, s42, 32
    s_lshl_b32 s46, s47, 10
    s_add_u32 m0, s46, 0
    s_add_u32 s46, s46, s65
    buffer_load_dwordx4 v2, s[24:27], s46 offen sc1 lds
    s_add_u32 s47, s42, 32
    s_lshl_b32 s46, s47, 10
    s_add_u32 m0, s46, 73728
    s_add_u32 s46, s46, s67
    buffer_load_dwordx4 v2, s[24:27], s46 offen sc1 lds
    s_waitcnt vmcnt(0) lgkmcnt(0)
    s_barrier
    v_mov_b32 v33, 0
    v_mov_b32 v160, 0xff7fffff
    v_mov_b32 v96, 0
    v_mov_b32 v97, 0
    v_mov_b32 v98, 0
    v_mov_b32 v99, 0
    v_mov_b32 v100, 0
    v_mov_b32 v101, 0
    v_mov_b32 v102, 0
    v_mov_b32 v103, 0
    v_mov_b32 v104, 0
    v_mov_b32 v105, 0
    v_mov_b32 v106, 0
    v_mov_b32 v107, 0
    v_mov_b32 v108, 0
    v_mov_b32 v109, 0
    v_mov_b32 v110, 0
    v_mov_b32 v111, 0
    v_mov_b32 v33, 0
    v_mov_b32 v161, 0xff7fffff
    v_mov_b32 v112, 0
    v_mov_b32 v113, 0
    v_mov_b32 v114, 0
    v_mov_b32 v115, 0
    v_mov_b32 v116, 0
    v_mov_b32 v117, 0
    v_mov_b32 v118, 0
    v_mov_b32 v119, 0
    v_mov_b32 v120, 0
    v_mov_b32 v121, 0
    v_mov_b32 v122, 0
    v_mov_b32 v123, 0
    v_mov_b32 v124, 0
    v_mov_b32 v125, 0
    v_mov_b32 v126, 0
    v_mov_b32 v127, 0
    v_subrev_u32 v8, 65536, v8
    v_subrev_u32 v9, 8192, v9
    v_subrev_u32 v10, 81920, v10
    s_mov_b32 s54, 0
parallel_sum__softmax_full_mha__swiglu_ffn__prompt_kernel_p2slowloop:
    ds_read_b128 v[48:51], v8 offset:0
    ds_read_b32 v56, v9 offset:0
    ds_read_b128 v[64:67], v10 offset:0
    ds_read_b128 v[68:71], v10 offset:640
    s_waitcnt lgkmcnt(3)
    v_mfma_f32_32x32x16_bf16 v[128:143], v[48:51], v[24:27], 0
    v_mfma_f32_32x32x16_bf16 v[144:159], v[48:51], v[28:31], 0
    s_waitcnt lgkmcnt(2)
    s_nop 8
    v_mfma_f32_32x32x4_2b_bf16 v[128:159], v[56:57], v[32:33], v[128:159]
    s_nop 15
    s_nop 3
    v_max3_f32 v163, v128, v129, v130
    v_max3_f32 v163, v163, v131, v132
    v_max3_f32 v163, v163, v133, v134
    v_max3_f32 v163, v163, v135, v136
    v_max3_f32 v163, v163, v137, v138
    v_max3_f32 v163, v163, v139, v140
    v_max3_f32 v163, v163, v141, v142
    v_max_f32 v163, v163, v143
    v_mov_b32 v164, v163
    s_nop 1
    v_permlane32_swap_b32 v163, v164
    v_max3_f32 v163, v163, v164, v160
    v_sub_f32 v162, v160, v163
    v_exp_f32 v162, v162
    v_mov_b32 v160, v163
    v_sub_f32 v128, v128, v163
    v_sub_f32 v129, v129, v163
    v_sub_f32 v130, v130, v163
    v_sub_f32 v131, v131, v163
    v_sub_f32 v132, v132, v163
    v_sub_f32 v133, v133, v163
    v_sub_f32 v134, v134, v163
    v_sub_f32 v135, v135, v163
    v_sub_f32 v136, v136, v163
    v_sub_f32 v137, v137, v163
    v_sub_f32 v138, v138, v163
    v_sub_f32 v139, v139, v163
    v_sub_f32 v140, v140, v163
    v_sub_f32 v141, v141, v163
    v_sub_f32 v142, v142, v163
    v_sub_f32 v143, v143, v163
    v_exp_f32 v128, v128
    v_exp_f32 v129, v129
    v_exp_f32 v130, v130
    v_exp_f32 v131, v131
    v_exp_f32 v132, v132
    v_exp_f32 v133, v133
    v_exp_f32 v134, v134
    v_exp_f32 v135, v135
    v_exp_f32 v136, v136
    v_exp_f32 v137, v137
    v_exp_f32 v138, v138
    v_exp_f32 v139, v139
    v_exp_f32 v140, v140
    v_exp_f32 v141, v141
    v_exp_f32 v142, v142
    v_exp_f32 v143, v143
    v_mul_f32 v96, v96, v162
    v_mul_f32 v97, v97, v162
    v_mul_f32 v98, v98, v162
    v_mul_f32 v99, v99, v162
    v_mul_f32 v100, v100, v162
    v_mul_f32 v101, v101, v162
    v_mul_f32 v102, v102, v162
    v_mul_f32 v103, v103, v162
    v_mul_f32 v104, v104, v162
    v_mul_f32 v105, v105, v162
    v_mul_f32 v106, v106, v162
    v_mul_f32 v107, v107, v162
    v_mul_f32 v108, v108, v162
    v_mul_f32 v109, v109, v162
    v_mul_f32 v110, v110, v162
    v_mul_f32 v111, v111, v162
    v_cvt_pk_bf16_f32 v80, v128, v129
    v_cvt_pk_bf16_f32 v81, v130, v131
    v_cvt_pk_bf16_f32 v82, v132, v133
    v_cvt_pk_bf16_f32 v83, v134, v135
    v_cvt_pk_bf16_f32 v84, v136, v137
    v_cvt_pk_bf16_f32 v85, v138, v139
    v_cvt_pk_bf16_f32 v86, v140, v141
    v_cvt_pk_bf16_f32 v87, v142, v143
    s_waitcnt lgkmcnt(1)
    v_mfma_f32_32x32x16_bf16 v[96:111], v[64:67], v[80:83], v[96:111]
    s_waitcnt lgkmcnt(0)
    v_mfma_f32_32x32x16_bf16 v[96:111], v[68:71], v[84:87], v[96:111]
    v_max3_f32 v163, v144, v145, v146
    v_max3_f32 v163, v163, v147, v148
    v_max3_f32 v163, v163, v149, v150
    v_max3_f32 v163, v163, v151, v152
    v_max3_f32 v163, v163, v153, v154
    v_max3_f32 v163, v163, v155, v156
    v_max3_f32 v163, v163, v157, v158
    v_max_f32 v163, v163, v159
    v_mov_b32 v164, v163
    s_nop 1
    v_permlane32_swap_b32 v163, v164
    v_max3_f32 v163, v163, v164, v161
    v_sub_f32 v162, v161, v163
    v_exp_f32 v162, v162
    v_mov_b32 v161, v163
    v_sub_f32 v144, v144, v163
    v_sub_f32 v145, v145, v163
    v_sub_f32 v146, v146, v163
    v_sub_f32 v147, v147, v163
    v_sub_f32 v148, v148, v163
    v_sub_f32 v149, v149, v163
    v_sub_f32 v150, v150, v163
    v_sub_f32 v151, v151, v163
    v_sub_f32 v152, v152, v163
    v_sub_f32 v153, v153, v163
    v_sub_f32 v154, v154, v163
    v_sub_f32 v155, v155, v163
    v_sub_f32 v156, v156, v163
    v_sub_f32 v157, v157, v163
    v_sub_f32 v158, v158, v163
    v_sub_f32 v159, v159, v163
    v_exp_f32 v144, v144
    v_exp_f32 v145, v145
    v_exp_f32 v146, v146
    v_exp_f32 v147, v147
    v_exp_f32 v148, v148
    v_exp_f32 v149, v149
    v_exp_f32 v150, v150
    v_exp_f32 v151, v151
    v_exp_f32 v152, v152
    v_exp_f32 v153, v153
    v_exp_f32 v154, v154
    v_exp_f32 v155, v155
    v_exp_f32 v156, v156
    v_exp_f32 v157, v157
    v_exp_f32 v158, v158
    v_exp_f32 v159, v159
    v_mul_f32 v112, v112, v162
    v_mul_f32 v113, v113, v162
    v_mul_f32 v114, v114, v162
    v_mul_f32 v115, v115, v162
    v_mul_f32 v116, v116, v162
    v_mul_f32 v117, v117, v162
    v_mul_f32 v118, v118, v162
    v_mul_f32 v119, v119, v162
    v_mul_f32 v120, v120, v162
    v_mul_f32 v121, v121, v162
    v_mul_f32 v122, v122, v162
    v_mul_f32 v123, v123, v162
    v_mul_f32 v124, v124, v162
    v_mul_f32 v125, v125, v162
    v_mul_f32 v126, v126, v162
    v_mul_f32 v127, v127, v162
    v_cvt_pk_bf16_f32 v88, v144, v145
    v_cvt_pk_bf16_f32 v89, v146, v147
    v_cvt_pk_bf16_f32 v90, v148, v149
    v_cvt_pk_bf16_f32 v91, v150, v151
    v_cvt_pk_bf16_f32 v92, v152, v153
    v_cvt_pk_bf16_f32 v93, v154, v155
    v_cvt_pk_bf16_f32 v94, v156, v157
    v_cvt_pk_bf16_f32 v95, v158, v159
    v_mfma_f32_32x32x16_bf16 v[112:127], v[64:67], v[88:91], v[112:127]
    s_nop 0
    v_mfma_f32_32x32x16_bf16 v[112:127], v[68:71], v[92:95], v[112:127]
    v_add_u32 v8, 1024, v8
    v_add_u32 v9, 128, v9
    v_add_u32 v10, 1280, v10
    s_nop 15
    s_add_u32 s54, s54, 1
    s_cmp_lt_u32 s54, 64
    s_cbranch_scc1 parallel_sum__softmax_full_mha__swiglu_ffn__prompt_kernel_p2slowloop
    s_nop 15
    s_waitcnt lgkmcnt(0)
    s_barrier
    s_sub_u32 s60, s60, 294912
    s_mul_i32 s48, s42, 9216
    s_add_u32 s48, s48, s62
    s_add_u32 m0, s48, 0
    s_nop 0
    buffer_load_dwordx4 v192, s[28:31], s60 offen lds
    s_add_u32 m0, s48, 1024
    s_nop 0
    buffer_load_dwordx4 v193, s[28:31], s60 offen lds
    s_add_u32 m0, s48, 2048
    s_nop 0
    buffer_load_dwordx4 v194, s[28:31], s60 offen lds
    s_add_u32 m0, s48, 3072
    s_nop 0
    buffer_load_dwordx4 v195, s[28:31], s60 offen lds
    s_add_u32 m0, s48, 4096
    s_nop 0
    buffer_load_dwordx4 v196, s[28:31], s60 offen lds
    s_add_u32 m0, s48, 5120
    s_nop 0
    buffer_load_dwordx4 v197, s[28:31], s60 offen lds
    s_add_u32 m0, s48, 6144
    s_nop 0
    buffer_load_dwordx4 v198, s[28:31], s60 offen lds
    s_add_u32 m0, s48, 7168
    s_nop 0
    buffer_load_dwordx4 v199, s[28:31], s60 offen lds
    s_add_u32 m0, s48, 8192
    s_nop 0
    buffer_load_dwordx4 v200, s[28:31], s60 offen lds
    s_add_u32 s60, s60, 147456
    s_mul_i32 s48, s42, 9216
    s_add_u32 s48, s48, s63
    s_add_u32 m0, s48, 0
    s_nop 0
    buffer_load_dwordx4 v192, s[28:31], s60 offen lds
    s_add_u32 m0, s48, 1024
    s_nop 0
    buffer_load_dwordx4 v193, s[28:31], s60 offen lds
    s_add_u32 m0, s48, 2048
    s_nop 0
    buffer_load_dwordx4 v194, s[28:31], s60 offen lds
    s_add_u32 m0, s48, 3072
    s_nop 0
    buffer_load_dwordx4 v195, s[28:31], s60 offen lds
    s_add_u32 m0, s48, 4096
    s_nop 0
    buffer_load_dwordx4 v196, s[28:31], s60 offen lds
    s_add_u32 m0, s48, 5120
    s_nop 0
    buffer_load_dwordx4 v197, s[28:31], s60 offen lds
    s_add_u32 m0, s48, 6144
    s_nop 0
    buffer_load_dwordx4 v198, s[28:31], s60 offen lds
    s_add_u32 m0, s48, 7168
    s_nop 0
    buffer_load_dwordx4 v199, s[28:31], s60 offen lds
    s_add_u32 m0, s48, 8192
    s_nop 0
    buffer_load_dwordx4 v200, s[28:31], s60 offen lds
    s_add_u32 s60, s60, 147456
    v_mov_b32 v12, v106
    v_mov_b32 v14, v106
    s_nop 1
    v_permlane32_swap_b32 v12, v14
    v_mov_b32 v13, v122
    v_mov_b32 v15, v122
    s_nop 1
    v_permlane32_swap_b32 v13, v15
    s_branch parallel_sum__softmax_full_mha__swiglu_ffn__prompt_kernel_p2fin
L_pslow_16:
    s_mov_b32 s69, 400000
L_psl_27:
    s_sub_u32 s69, s69, 1
    s_cbranch_scc1 L_pback_17
    s_sleep 1
    buffer_load_dwordx2 v[4:5], v6, s[24:27], 0 offen sc1
    s_waitcnt vmcnt(0)
    v_cmp_ne_u32 vcc, s44, v4
    v_cmp_ne_u32 s[48:49], s45, v5
    s_nop 4
    s_or_b64 vcc, vcc, s[48:49]
    s_nop 4
    s_cbranch_vccnz L_psl_27
    s_branch L_pback_17
L_pslow_19:
    s_mov_b32 s69, 400000
L_psl_28:
    s_sub_u32 s69, s69, 1
    s_cbranch_scc1 L_pback_20
    s_sleep 1
    buffer_load_dwordx2 v[4:5], v6, s[24:27], 0 offen sc1
    s_waitcnt vmcnt(0)
    v_cmp_ne_u32 vcc, s44, v4
    v_cmp_ne_u32 s[48:49], s45, v5
    s_nop 4
    s_or_b64 vcc, vcc, s[48:49]
    s_nop 4
    s_cbranch_vccnz L_psl_28
    s_branch L_pback_20
L_pslow_22:
    s_mov_b32 s69, 400000
L_psl_29:
    s_sub_u32 s69, s69, 1
    s_cbranch_scc1 L_pback_23
    s_sleep 1
    buffer_load_dwordx2 v[8:9], v10, s[24:27], 0 offen sc1
    s_waitcnt vmcnt(0)
    v_cmp_ne_u32 vcc, s44, v8
    v_cmp_ne_u32 s[48:49], s45, v9
    s_nop 4
    s_or_b64 vcc, vcc, s[48:49]
    s_nop 4
    s_cbranch_vccnz L_psl_29
    s_branch L_pback_23
parallel_sum__softmax_full_mha__swiglu_ffn__prompt_kernel_end:
    s_endpgm
.section .rodata,"a"

.p2align 6
.amdhsa_kernel parallel_sum__softmax_full_mha__swiglu_ffn__prompt_kernel
  .amdhsa_next_free_vgpr 512
  .amdhsa_next_free_sgpr 102
  .amdhsa_accum_offset 256
  .amdhsa_group_segment_fixed_size 0
  .amdhsa_kernarg_size 80
  .amdhsa_user_sgpr_count 2
  .amdhsa_user_sgpr_kernarg_segment_ptr 1
  .amdhsa_system_sgpr_workgroup_id_x 1
  .amdhsa_float_denorm_mode_32 3
  .amdhsa_float_denorm_mode_16_64 3
  .amdhsa_ieee_mode 0
  .amdhsa_dx10_clamp 0
.end_amdhsa_kernel
```
